```python
import torch

def _softmax(x, axis=-1):
    return torch.softmax(x, dim=axis)
def _gelu(x):
    return torch.nn.functional.gelu(x, approximate="tanh")
def _silu(x):
    return torch.nn.functional.silu(x)
def _sigmoid(x):
    return torch.sigmoid(x)
def _layernorm(x, axis=-1, eps=1e-5):
    m = x.mean(dim=axis, keepdim=True)
    v = x.var(dim=axis, keepdim=True, unbiased=False)
    return (x - m) / torch.sqrt(v + eps)
def _scatter_add(tgt, idx, src, axis=0):
    return tgt.clone().index_add_(axis, idx, src)
def _segment_sum(src, seg, n):
    out = torch.zeros((n,) + src.shape[1:], dtype=src.dtype)
    return out.index_add_(0, seg, src)
def _pad(x, pw):
    flat = tuple(v for pair in reversed(pw) for v in pair)
    return torch.nn.functional.pad(x, flat)

kernel_name = 'interleave_layers__ssm_conv_h3__glu_gated_glu__prompt'

def setup_inputs():

    _w = (lambda a: (lambda t: t.to(torch.bfloat16) if t.is_floating_point() else t)(torch.as_tensor(a)))
    def _A_setup():
        B, S, D = 1, 2048, 512
        ks = 4
        return {
            "q": _w((lambda *s: torch.randn(*s, dtype=torch.bfloat16) * 0.05)(B, S, D)),
            "k": _w((lambda *s: torch.randn(*s, dtype=torch.bfloat16) * 0.4)(B, S, D)),
            "v": _w((lambda *s: torch.randn(*s, dtype=torch.bfloat16) * 0.4)(B, S, D)),
            "shift_k": _w((lambda *s: torch.randn(*s, dtype=torch.bfloat16) * 0.4)(D, ks) * 0.5),
            "ssm_k": _w((lambda *s: torch.randn(*s, dtype=torch.bfloat16) * 0.4)(D, S) * (1.0 / S ** 0.5)),
            "ssm_D": _w((lambda *s: torch.randn(*s, dtype=torch.bfloat16) * 0.4)(D)),
        }
    _A_in = _A_setup()

    def _B_setup():
        B, S, D, F = 1, 2048, 512, 1792
        return {
            "x": _w((lambda *s: torch.randn(*s, dtype=torch.bfloat16) * 0.05)(B, S, D)),
            "w_gate": _w((lambda *s: torch.randn(*s, dtype=torch.bfloat16) * 0.05)(D, F)),
            "w_up": _w((lambda *s: torch.randn(*s, dtype=torch.bfloat16) * 0.05)(D, F)),
            "w_down": _w((lambda *s: torch.randn(*s, dtype=torch.bfloat16) * 0.05)(F, D)),
        }
    _B_in = _B_setup()

    return {
        "A_q": _A_in["q"],
        "A_k": _A_in["k"],
        "A_v": _A_in["v"],
        "A_shift_k": _A_in["shift_k"],
        "A_ssm_k": _A_in["ssm_k"],
        "A_ssm_D": _A_in["ssm_D"],
        "B_x": _B_in["x"],
        "B_w_gate": _B_in["w_gate"],
        "B_w_up": _B_in["w_up"],
        "B_w_down": _B_in["w_down"],
    }

def reference(A_q, A_k, A_v, A_shift_k, A_ssm_k, A_ssm_D, B_x, B_w_gate, B_w_up, B_w_down):
    def _A_ref(q, k, v, shift_k, ssm_k, ssm_D):
        B, S, D = q.shape
        ks = shift_k.shape[-1]
        k_pad = _pad(k, ((0, 0), (ks - 1, 0), (0, 0)))
        k_shift = torch.zeros_like(k)
        for t in range(ks):
            k_shift = k_shift + k_pad[:, t:t + S, :] * shift_k[:, ks - 1 - t][None, None, :]
        kv = k_shift * v
        L = 2 * S
        kv_pad = _pad(kv, ((0, 0), (0, S), (0, 0)))
        kf_pad = _pad(ssm_k, ((0, 0), (0, S)))
        kv_f = (lambda x, axes=(-2,-1): torch.fft.rfft2(x.float(), dim=axes))(kv_pad[:, None, :, :], axes=(1, 2))
        kf_f = (lambda x, axes=(-2,-1): torch.fft.rfft2(x.float(), dim=axes))(kf_pad[:, None, :], axes=(1, 2))
        kf_f = (lambda x, *d: x.permute(*d))(kf_f, 1, 2, 0)
        y_f = kv_f * kf_f[None, :, :, :]
        y = (lambda x, s, axes=(-2,-1): torch.fft.irfft2(x, s=s, dim=axes).to(torch.bfloat16))(y_f, (1, L), axes=(1, 2))[:, 0, :S, :]
        y = y + kv * ssm_D[None, None, :]
        return q * y

    def _B_ref(x, w_gate, w_up, w_down):
        g = torch.einsum("bsd,df->bsf", x, w_gate)
        u = torch.einsum("bsd,df->bsf", x, w_up)
        h = _sigmoid(g) * u
        return torch.einsum("bsf,fd->bsd", h, w_down)

    x = A_q
    x = x + _A_ref(_layernorm(x, axis=-1), A_k, A_v, A_shift_k, A_ssm_k, A_ssm_D)
    x = x + _B_ref(_layernorm(x, axis=-1), B_w_gate, B_w_up, B_w_down)
    x = x + _A_ref(_layernorm(x, axis=-1), A_k, A_v, A_shift_k, A_ssm_k, A_ssm_D)
    x = x + _B_ref(_layernorm(x, axis=-1), B_w_gate, B_w_up, B_w_down)
    return x
```

```asm
; @launch grid=(256,1,1) block=(256,1,1) lds=163840
.amdgcn_target "amdgcn-amd-amdhsa--gfx950"
.text
.globl interleave_layers__ssm_conv_h3__glu_gated_glu__prompt_kernel
.p2align 8
.type interleave_layers__ssm_conv_h3__glu_gated_glu__prompt_kernel,@function
interleave_layers__ssm_conv_h3__glu_gated_glu__prompt_kernel:
s_cmp_ge_u32 s2, 256
s_cbranch_scc1 L_end
s_load_dwordx16 s[4:19], s[0:1], 0
s_load_dwordx8 s[20:27], s[0:1], 64
s_load_dwordx2 s[28:29], s[0:1], 96
s_getpc_b64 s[68:69]
L_pc:
s_lshr_b32 s31, s2, 3
v_lshrrev_b32 v3, 6, v0
v_and_b32 v1, 63, v0
v_lshl_add_u32 v2, s31, 2, v3
v_mul_u32_u24 v2, ((L_kend-L_pc+8191)>>13), v2
v_min_u32 v4, ((L_kend-L_pc+8191)>>13)-1, v1
v_add_lshl_u32 v2, v2, v4, 6
v_min_u32 v2, L_kend-L_pc-4, v2
global_load_dword v255, v2, s[68:69]
s_and_b32 s30, s2, 7
v_readfirstlane_b32 s52, v3
v_lshlrev_b32 v8, 4, v1
v_and_b32 v2, 31, v1
v_lshrrev_b32 v3, 5, v1
s_lshl_b32 s54, s52, 1
v_add_u32 v3, s54, v3
s_lshl_b32 s54, s30, 7
s_lshl_b32 s55, s31, 16
s_add_u32 s54, s54, s55
v_lshl_add_u32 v4, v2, 2, s54
v_lshl_add_u32 v4, v3, 13, v4
v_subrev_u32 v5, 0xc00, v4
s_lshl_b32 s57, s30, 9
v_lshl_add_u32 v6, v2, 4, s57
s_mul_i32 s57, s30, 262144
s_lshl_b32 s58, s31, 7
s_add_u32 s57, s57, s58
v_lshlrev_b32 v7, 13, v2
v_lshl_add_u32 v7, v3, 4, v7
v_add_u32 v7, s57, v7
s_movk_i32 s56, 0x1000
s_waitcnt lgkmcnt(0)
s_mov_b32 s32, s28
s_and_b32 s33, s29, 0xffff
s_mov_b32 s34, 0x10000000
s_mov_b32 s35, 0x00020000
s_mov_b32 s36, s6
s_and_b32 s37, s7, 0xffff
s_mov_b32 s38, 0x200000
s_mov_b32 s39, 0x00020000
s_mov_b32 s40, s8
s_and_b32 s41, s9, 0xffff
s_mov_b32 s42, 0x200000
s_mov_b32 s43, 0x00020000
s_mov_b32 s44, s10
s_and_b32 s45, s11, 0xffff
s_mov_b32 s46, 0x1000
s_mov_b32 s47, 0x00020000
buffer_load_dwordx4 v[30:33], v6, s[44:47], 0 offen
buffer_load_dword v10, v5, s[36:39], 0 offen offset:0
buffer_load_dword v11, v5, s[36:39], 0 offen offset:1024
buffer_load_dword v12, v5, s[36:39], 0 offen offset:2048
buffer_load_dword v13, v4, s[36:39], 0 offen offset:0
buffer_load_dword v14, v4, s[36:39], 0 offen offset:1024
buffer_load_dword v15, v4, s[36:39], 0 offen offset:2048
buffer_load_dword v16, v4, s[36:39], 0 offen offset:3072
buffer_load_dword v17, v4, s[36:39], s56 offen offset:0
buffer_load_dword v18, v4, s[36:39], s56 offen offset:1024
buffer_load_dword v19, v4, s[36:39], s56 offen offset:2048
buffer_load_dword v20, v4, s[36:39], s56 offen offset:3072
buffer_load_dword v22, v4, s[40:43], 0 offen offset:0
buffer_load_dword v23, v4, s[40:43], 0 offen offset:1024
buffer_load_dword v24, v4, s[40:43], 0 offen offset:2048
buffer_load_dword v25, v4, s[40:43], 0 offen offset:3072
buffer_load_dword v26, v4, s[40:43], s56 offen offset:0
buffer_load_dword v27, v4, s[40:43], s56 offen offset:1024
buffer_load_dword v28, v4, s[40:43], s56 offen offset:2048
buffer_load_dword v29, v4, s[40:43], s56 offen offset:3072
s_lshl_b32 s79, s30, 7
s_add_u32 s79, s79, 20971520
s_lshl_b32 s101, s31, 2
s_add_u32 s101, s101, s79
s_cmp_lg_u32 s52, 0
s_cbranch_scc1 W0_1
s_mov_b32 s40, s26
s_and_b32 s41, s27, 0xffff
s_mov_b32 s42, 0x100
s_mov_b32 s43, 0x00020000
s_getreg_b32 s99, hwreg(HW_REG_XCC_ID, 0, 4)
s_or_b32 s99, s99, 0x80
s_lshl_b32 s67, s30, 5
s_add_u32 s67, s67, s31
v_mov_b32 v2, s99
s_mov_b64 exec, 1
buffer_store_byte v2, off, s[40:43], s67
s_mov_b32 s67, 20979712
buffer_load_dword v222, off, s[32:35], s67 sc1
s_mov_b64 exec, -1
s_mul_i32 s99, s99, 0x01010101
W0_1:
s_lshr_b32 s88, s52, 1
s_and_b32 s89, s52, 1
s_lshl_b32 s90, s30, 6
s_lshl_b32 s96, s31, 1
s_add_u32 s90, s90, s96
s_add_u32 s90, s90, s88
s_lshl_b32 s91, s90, 12
s_lshl_b32 s96, s90, 1
s_and_b32 s96, s96, 0xfffffffc
s_load_dword s92, s[14:15], s96
s_lshl_b32 s96, s89, 6
v_add_u32 v130, s96, v1
v_lshlrev_b32 v130, 4, v130
v_add_u32 v131, 0xfc, v1
v_add_u32 v132, -4, v1
v_cmp_gt_u32 vcc, 4, v1
s_nop 1
v_cndmask_b32 v131, v131, v132, vcc
v_lshlrev_b32 v131, 4, v131
v_add_u32 v132, 16, v131
s_mul_i32 s94, s88, 17152
s_add_u32 s94, s94, 120320
s_add_u32 s96, s94, 64
v_add_u32 v133, s96, v130
v_add_u32 v134, s96, v131
s_mul_i32 s93, s88, 4608
s_add_u32 s93, s93, 154624
s_lshr_b32 s54, s2, 1
s_min_u32 s54, s54, 111
s_and_b32 s55, s2, 1
s_lshl_b32 s55, s55, 2
s_add_u32 s55, s55, s52
s_mul_i32 s56, s54, 2341
s_lshr_b32 s56, s56, 16
s_mul_i32 s57, s56, 28
s_sub_u32 s57, s54, s57
s_lshl_b32 s86, s55, 2
s_add_u32 s86, s86, s56
s_mul_i32 s86, s86, 57344
s_lshr_b32 s60, s57, 1
s_lshl_b32 s60, s60, 12
s_add_u32 s86, s86, s60
s_and_b32 s60, s57, 1
s_lshl_b32 s60, s60, 9
s_add_u32 s86, s86, s60
v_bfe_u32 v2, v1, 4, 1
v_lshlrev_b32 v2, 10, v2
v_lshrrev_b32 v3, 5, v1
v_lshl_add_u32 v2, v3, 8, v2
v_and_b32 v3, 15, v1
v_lshl_add_u32 v239, v3, 4, v2
s_add_u32 s86, s86, 23068672
v_lshrrev_b32 v2, 3, v1
v_bfe_u32 v3, v1, 1, 2
v_bfe_u32 v4, v1, 4, 1
v_lshlrev_b32 v4, 1, v4
v_xor_b32 v3, v3, v4
v_lshlrev_b32 v3, 5, v3
v_and_b32 v4, 1, v1
v_lshl_add_u32 v3, v4, 4, v3
v_lshl_add_u32 v238, v2, 10, v3
s_lshl_b32 s16, s54, 14
s_lshl_b32 s59, s55, 7
s_add_u32 s16, s16, s59
s_lshl_b32 s59, s52, 11
s_add_u32 s59, s59, 110592
s_mov_b32 s17, s59
v_bfe_u32 v2, v1, 4, 1
v_lshlrev_b32 v2, 4, v2
v_and_b32 v3, 3, v1
v_lshl_add_u32 v2, v3, 2, v2
s_mov_b32 s60, 0
v_add_u32 v2, s60, v2
v_and_b32 v2, 31, v2
v_lshrrev_b32 v3, 5, v1
v_bfe_u32 v4, v1, 2, 2
v_lshl_add_u32 v3, v3, 2, v4
v_lshrrev_b32 v4, 4, v2
v_bfe_u32 v5, v3, 1, 1
v_lshlrev_b32 v5, 1, v5
v_xor_b32 v4, v4, v5
v_and_b32 v2, 15, v2
v_lshlrev_b32 v2, 1, v2
v_lshl_add_u32 v2, v3, 7, v2
v_add_u32 v2, s59, v2
v_xor_b32 v5, 2, v4
v_lshl_add_u32 v209, v4, 5, v2
v_lshl_add_u32 v210, v5, 5, v2
s_and_b32 s59, s31, 1
s_lshr_b32 s54, s31, 1
s_mul_i32 s54, s54, 112
s_mul_i32 s55, s59, 48
s_add_u32 s54, s54, s55
s_lshl_b32 s54, s54, 1
s_mul_i32 s55, s59, 3
v_lshrrev_b32 v2, 3, v1
v_bfe_u32 v3, v1, 1, 2
v_bfe_u32 v4, v1, 4, 1
v_lshlrev_b32 v4, 1, v4
v_xor_b32 v3, v3, v4
v_xor_b32 v3, s55, v3
s_and_b32 s55, s52, 1
v_xor_b32 v3, s55, v3
v_mov_b32 v4, v3
v_mul_u32_u24 v2, 3584, v2
v_and_b32 v5, 1, v1
v_lshl_add_u32 v2, v5, 4, v2
v_add_u32 v2, s54, v2
v_lshl_add_u32 v220, v3, 5, v2
v_lshl_add_u32 v221, v4, 5, v2
s_mov_b32 s44, s18
s_and_b32 s45, s19, 0xffff
s_mov_b32 s46, 0x1c0000
s_mov_b32 s47, 0x00020000
s_mov_b32 s48, s20
s_and_b32 s49, s21, 0xffff
s_mov_b32 s50, 0x1c0000
s_mov_b32 s51, 0x00020000
s_mul_i32 s63, s52, 28672
s_lshl_b32 s64, s52, 10
v_and_b32 v4, 7, v1
v_lshrrev_b32 v5, 3, v1
v_lshlrev_b32 v4, 10, v4
v_lshrrev_b32 v6, 2, v5
v_lshl_add_u32 v4, v6, 7, v4
v_and_b32 v6, 3, v5
v_lshl_add_u32 v4, v6, 4, v4
s_lshl_b32 s58, s30, 18
s_lshl_b32 s59, s31, 13
s_add_u32 s58, s58, s59
s_lshl_b32 s59, s52, 8
s_add_u32 s58, s58, s59
v_add_u32 v232, s58, v4
v_lshrrev_b32 v2, 4, v1
v_bfe_u32 v3, v1, 2, 2
v_and_b32 v4, 3, v1
v_sub_u32 v5, 4, v3
v_and_b32 v5, 3, v5
v_mul_u32_u24 v5, 4288, v5
v_lshl_add_u32 v5, v4, 3, v5
v_lshlrev_b32 v6, 4, v2
v_sub_u32 v5, v5, v6
v_min_u32 v6, 1, v3
v_lshlrev_b32 v6, 3, v6
v_sub_u32 v5, v5, v6
s_add_u32 s96, s94, 56
v_add_u32 v233, s96, v5
v_and_b32 v5, 15, v1
v_lshlrev_b32 v6, 5, v5
v_lshl_add_u32 v6, v2, 4, v6
v_add_u32 v234, s93, v6
v_lshlrev_b32 v6, 5, v5
v_lshl_add_u32 v6, v2, 3, v6
v_add_u32 v235, s93, v6
v_lshrrev_b32 v6, 1, v5
v_lshlrev_b32 v6, 15, v6
v_and_b32 v3, 1, v5
v_lshl_add_u32 v6, v3, 5, v6
v_lshl_add_u32 v236, v2, 3, v6
s_lshl_b32 s95, s90, 6
s_add_u32 s95, s95, 2097152
v_add_u32 v237, s94, v8
s_add_u32 s36, s12, s91
s_addc_u32 s37, s13, 0
s_and_b32 s37, s37, 0xffff
s_mov_b32 s38, 0x1000
s_mov_b32 s39, 0x00020000
buffer_load_dwordx4 v[112:115], v130, s[36:39], 0 offen
buffer_load_dwordx2 v[116:117], v130, s[36:39], 0 offen offset:16
buffer_load_dwordx4 v[118:121], v130, s[36:39], 0 offen offset:2048
buffer_load_dwordx2 v[122:123], v130, s[36:39], 0 offen offset:2064
buffer_load_dwordx4 v[124:127], v131, s[36:39], 0 offen
buffer_load_dwordx2 v[128:129], v132, s[36:39], 0 offen
s_mul_i32 s59, s30, 262144
s_lshl_b32 s60, s31, 7
s_add_u32 s59, s59, s60
s_lshl_b32 s60, s52, 16
s_add_u32 s59, s59, s60
s_add_u32 s59, s59, 6291456
v_min_u32 v2, 15, v1
v_lshlrev_b32 v2, 12, v2
buffer_load_dword v254, v2, s[32:35], s59 offen
s_waitcnt vmcnt(15)
s_cmp_lg_u32 s52, 0
s_cbranch_scc1 W0_2
s_mov_b32 s40, s26
s_and_b32 s41, s27, 0xffff
s_mov_b32 s42, 0x100
s_mov_b32 s43, 0x00020000
s_lshl_b32 s67, s30, 5
v_and_b32 v3, 7, v1
v_lshl_add_u32 v3, v3, 2, s67
buffer_load_dword v223, v3, s[40:43], 0 offen sc1
W0_2:
s_mov_b32 s40, s22
s_and_b32 s41, s23, 0xffff
s_mov_b32 s42, 0x1c0000
s_mov_b32 s43, 0x00020000
s_mov_b32 m0, s17
s_add_u32 s60, s16, 8192
buffer_load_dwordx4 v238, s[40:43], s16 offen lds
s_add_u32 m0, m0, 1024
s_nop 0
buffer_load_dwordx4 v238, s[40:43], s60 offen lds
s_add_u32 m0, s64, 0
s_add_u32 s65, s63, 0
buffer_load_dwordx4 v220, s[44:47], s65 offen lds
s_mov_b32 s58, 6291456
s_mov_b32 s59, 6295552
s_mov_b32 s60, 0xffff0000
v_lshlrev_b32 v62, 16, v30
v_lshlrev_b32 v63, 16, v32
v_and_b32 v64, s60, v30
v_and_b32 v65, s60, v32
v_lshlrev_b32 v66, 16, v31
v_lshlrev_b32 v67, 16, v33
v_and_b32 v68, s60, v31
v_and_b32 v69, s60, v33
v_lshlrev_b32 v40, 16, v10
v_and_b32 v41, s60, v10
v_lshlrev_b32 v42, 16, v11
v_and_b32 v43, s60, v11
v_lshlrev_b32 v44, 16, v12
v_and_b32 v45, s60, v12
v_lshlrev_b32 v46, 16, v13
v_and_b32 v47, s60, v13
v_lshlrev_b32 v48, 16, v14
v_and_b32 v49, s60, v14
v_lshlrev_b32 v50, 16, v15
v_and_b32 v51, s60, v15
v_lshlrev_b32 v52, 16, v16
v_and_b32 v53, s60, v16
v_lshlrev_b32 v54, 16, v17
v_and_b32 v55, s60, v17
v_lshlrev_b32 v56, 16, v18
v_and_b32 v57, s60, v18
v_lshlrev_b32 v58, 16, v19
v_and_b32 v59, s60, v19
v_lshlrev_b32 v60, 16, v20
v_and_b32 v61, s60, v20
v_pk_mul_f32 v[70:71], v[46:47], v[62:63]
v_pk_mul_f32 v[72:73], v[48:49], v[62:63]
v_pk_mul_f32 v[74:75], v[50:51], v[62:63]
v_pk_mul_f32 v[76:77], v[52:53], v[62:63]
v_pk_mul_f32 v[78:79], v[54:55], v[62:63]
v_pk_mul_f32 v[80:81], v[56:57], v[62:63]
v_pk_mul_f32 v[82:83], v[58:59], v[62:63]
v_pk_mul_f32 v[84:85], v[60:61], v[62:63]
v_pk_fma_f32 v[70:71], v[44:45], v[64:65], v[70:71]
v_pk_fma_f32 v[72:73], v[46:47], v[64:65], v[72:73]
v_pk_fma_f32 v[74:75], v[48:49], v[64:65], v[74:75]
v_pk_fma_f32 v[76:77], v[50:51], v[64:65], v[76:77]
v_pk_fma_f32 v[78:79], v[52:53], v[64:65], v[78:79]
v_pk_fma_f32 v[80:81], v[54:55], v[64:65], v[80:81]
v_pk_fma_f32 v[82:83], v[56:57], v[64:65], v[82:83]
v_pk_fma_f32 v[84:85], v[58:59], v[64:65], v[84:85]
v_pk_fma_f32 v[70:71], v[42:43], v[66:67], v[70:71]
v_pk_fma_f32 v[72:73], v[44:45], v[66:67], v[72:73]
v_pk_fma_f32 v[74:75], v[46:47], v[66:67], v[74:75]
v_pk_fma_f32 v[76:77], v[48:49], v[66:67], v[76:77]
v_pk_fma_f32 v[78:79], v[50:51], v[66:67], v[78:79]
v_pk_fma_f32 v[80:81], v[52:53], v[66:67], v[80:81]
v_pk_fma_f32 v[82:83], v[54:55], v[66:67], v[82:83]
v_pk_fma_f32 v[84:85], v[56:57], v[66:67], v[84:85]
v_pk_fma_f32 v[70:71], v[40:41], v[68:69], v[70:71]
v_pk_fma_f32 v[72:73], v[42:43], v[68:69], v[72:73]
v_pk_fma_f32 v[74:75], v[44:45], v[68:69], v[74:75]
v_pk_fma_f32 v[76:77], v[46:47], v[68:69], v[76:77]
v_pk_fma_f32 v[78:79], v[48:49], v[68:69], v[78:79]
v_pk_fma_f32 v[80:81], v[50:51], v[68:69], v[80:81]
v_pk_fma_f32 v[82:83], v[52:53], v[68:69], v[82:83]
v_pk_fma_f32 v[84:85], v[54:55], v[68:69], v[84:85]
s_waitcnt vmcnt(10)
v_lshlrev_b32 v86, 16, v22
v_and_b32 v87, s60, v22
v_lshlrev_b32 v88, 16, v23
v_and_b32 v89, s60, v23
v_lshlrev_b32 v90, 16, v24
v_and_b32 v91, s60, v24
v_lshlrev_b32 v92, 16, v25
v_and_b32 v93, s60, v25
v_lshlrev_b32 v94, 16, v26
v_and_b32 v95, s60, v26
v_lshlrev_b32 v96, 16, v27
v_and_b32 v97, s60, v27
v_lshlrev_b32 v98, 16, v28
v_and_b32 v99, s60, v28
v_lshlrev_b32 v100, 16, v29
v_and_b32 v101, s60, v29
v_pk_mul_f32 v[70:71], v[70:71], v[86:87]
v_pk_mul_f32 v[72:73], v[72:73], v[88:89]
v_pk_mul_f32 v[74:75], v[74:75], v[90:91]
v_pk_mul_f32 v[76:77], v[76:77], v[92:93]
v_pk_mul_f32 v[78:79], v[78:79], v[94:95]
v_pk_mul_f32 v[80:81], v[80:81], v[96:97]
v_pk_mul_f32 v[82:83], v[82:83], v[98:99]
v_pk_mul_f32 v[84:85], v[84:85], v[100:101]
v_cvt_pk_bf16_f32 v104, v70, v72
v_cvt_pk_bf16_f32 v105, v74, v76
v_cvt_pk_bf16_f32 v106, v78, v80
v_cvt_pk_bf16_f32 v107, v82, v84
v_cvt_pk_bf16_f32 v108, v71, v73
v_cvt_pk_bf16_f32 v109, v75, v77
v_cvt_pk_bf16_f32 v110, v79, v81
v_cvt_pk_bf16_f32 v111, v83, v85
buffer_store_dwordx4 v[104:107], v7, s[32:35], s58 offen
buffer_store_dwordx4 v[108:111], v7, s[32:35], s59 offen
s_waitcnt lgkmcnt(0)
v_and_b32 v135, 31, v1
v_lshlrev_b32 v135, 4, v135
v_add_u32 v135, s93, v135
v_mov_b32 v148, 0
v_mov_b32 v149, 0
v_mov_b32 v150, 0
v_mov_b32 v151, 0
ds_write_b128 v135, v[148:151]
s_waitcnt vmcnt(6)
v_alignbit_b32 v136, v113, v112, 16
v_alignbit_b32 v137, v114, v113, 16
v_alignbit_b32 v138, v115, v114, 16
v_alignbit_b32 v139, v116, v115, 16
v_mov_b32 v140, v113
v_mov_b32 v141, v114
v_mov_b32 v142, v115
v_mov_b32 v143, v116
v_alignbit_b32 v144, v114, v113, 16
v_alignbit_b32 v145, v115, v114, 16
v_alignbit_b32 v146, v116, v115, 16
v_alignbit_b32 v147, v117, v116, 16
ds_write_b128 v133, v[112:115] offset:0
ds_write_b128 v133, v[136:139] offset:4288
ds_write_b128 v133, v[140:143] offset:8576
ds_write_b128 v133, v[144:147] offset:12864
v_alignbit_b32 v136, v119, v118, 16
v_alignbit_b32 v137, v120, v119, 16
v_alignbit_b32 v138, v121, v120, 16
v_alignbit_b32 v139, v122, v121, 16
v_mov_b32 v140, v119
v_mov_b32 v141, v120
v_mov_b32 v142, v121
v_mov_b32 v143, v122
v_alignbit_b32 v144, v120, v119, 16
v_alignbit_b32 v145, v121, v120, 16
v_alignbit_b32 v146, v122, v121, 16
v_alignbit_b32 v147, v123, v122, 16
ds_write_b128 v133, v[118:121] offset:2048
ds_write_b128 v133, v[136:139] offset:6336
ds_write_b128 v133, v[140:143] offset:10624
ds_write_b128 v133, v[144:147] offset:14912
v_cmp_gt_u32 vcc, 6, v1
s_nop 0
s_and_saveexec_b64 s[96:97], vcc
v_alignbit_b32 v136, v125, v124, 16
v_alignbit_b32 v137, v126, v125, 16
v_alignbit_b32 v138, v127, v126, 16
v_alignbit_b32 v139, v128, v127, 16
v_mov_b32 v140, v125
v_mov_b32 v141, v126
v_mov_b32 v142, v127
v_mov_b32 v143, v128
v_alignbit_b32 v144, v126, v125, 16
v_alignbit_b32 v145, v127, v126, 16
v_alignbit_b32 v146, v128, v127, 16
v_alignbit_b32 v147, v129, v128, 16
ds_write_b128 v134, v[124:127] offset:0
ds_write_b128 v134, v[136:139] offset:4288
ds_write_b128 v134, v[140:143] offset:8576
ds_write_b128 v134, v[144:147] offset:12864
s_mov_b64 exec, s[96:97]
s_lshl_b32 s96, s92, 16
s_and_b32 s97, s92, 0xffff0000
s_bitcmp1_b32 s90, 0
s_cselect_b32 s92, s97, s96
s_waitcnt vmcnt(0)
s_cmp_lg_u32 s52, 0
s_cbranch_scc1 W0_3
s_mov_b32 s40, s26
s_and_b32 s41, s27, 0xffff
s_mov_b32 s42, 0x100
s_mov_b32 s43, 0x00020000
v_readfirstlane_b32 s53, v222
s_mov_b32 s67, 0
s_andn2_b32 s53, s53, 7
s_add_u32 s53, s53, 8
PU_4:
v_cmp_eq_u32 vcc, s99, v223
s_nop 0
s_cmp_eq_u64 vcc, exec
s_cbranch_scc1 PUy_5
s_add_u32 s67, s67, 1
s_cmp_ge_u32 s67, 24
s_cbranch_scc1 PUd_6
buffer_load_dword v223, v3, s[40:43], 0 offen sc1
s_waitcnt vmcnt(0)
s_branch PU_4
PUy_5:
s_mov_b32 s67, -1
PUd_6:
s_cmp_eq_u32 s67, -1
s_cselect_b32 s71, 1, 0
W0_3:
s_cmp_lg_u32 s52, 0
s_cbranch_scc1 W0_7
v_mov_b32 v2, s53
v_mov_b32 v3, s71
v_mov_b32 v4, 118784
ds_write_b64 v4, v[2:3]
s_waitcnt lgkmcnt(0)
W0_7:
s_waitcnt lgkmcnt(0)
s_barrier
s_cmp_lg_u32 s52, 0
s_cbranch_scc1 W0_8
s_add_u32 s66, s53, 1
v_mov_b32 v2, s66
s_mov_b64 exec, 1
s_cmp_eq_u32 s71, 1
s_cbranch_scc1 SGf_9
buffer_wbl2 sc1
s_waitcnt vmcnt(0)
buffer_store_dword v2, off, s[32:35], s101 sc1
s_branch SGs_10
SGf_9:
buffer_store_dword v2, off, s[32:35], s101
SGs_10:
s_mov_b64 exec, -1
W0_8:
v_mov_b32 v4, 118784
ds_read_b64 v[2:3], v4
s_waitcnt lgkmcnt(0)
v_readfirstlane_b32 s53, v2
v_readfirstlane_b32 s71, v3
s_cmp_lg_u32 s52, 0
s_cbranch_scc1 W0_11
s_mov_b32 exec_lo, 0xffffffff
s_mov_b32 exec_hi, 0
v_lshlrev_b32 v3, 2, v1
s_mov_b32 s67, 0
PL_12:
buffer_load_dword v2, v3, s[32:35], s79 offen sc1
s_waitcnt vmcnt(0)
v_subrev_u32 v2, s66, v2
v_cmp_ge_u32 vcc, 6, v2
s_nop 0
s_cmp_eq_u32 vcc_lo, 0xffffffff
s_cbranch_scc1 PLd_13
s_add_u32 s67, s67, 1
s_cmp_lt_u32 s67, 65536
s_cbranch_scc1 PL_12
PLd_13:
s_mov_b64 exec, -1
W0_11:
s_barrier
s_lshl_b32 s96, s89, 11
s_add_u32 s97, s93, s96
s_add_u32 m0, s97, 512
s_and_b32 s97, s91, 0x3ffff
s_add_u32 s97, s97, s96
s_mul_i32 s96, s30, 262144
s_add_u32 s97, s97, s96
s_add_u32 s97, s97, 6291456
buffer_load_dwordx4 v8, s[32:35], s97 offen sc1 lds
buffer_load_dwordx4 v8, s[32:35], s97 offen offset:1024 sc1 lds
ds_read_b64_tr_b16 v[212:213], v209
ds_read_b64_tr_b16 v[214:215], v209 offset:1024
ds_read_b64_tr_b16 v[216:217], v210
ds_read_b64_tr_b16 v[218:219], v210 offset:1024
s_waitcnt vmcnt(0)
s_barrier
s_waitcnt lgkmcnt(0)
buffer_store_dwordx4 v[212:215], v239, s[32:35], s86 offen offset:0 sc1
buffer_store_dwordx4 v[216:219], v239, s[32:35], s86 offen offset:2048 sc1
s_cmp_eq_u32 s89, 1
s_cbranch_scc1 C_hf1_14
ds_read_b64_tr_b16 v[48:49], v233 offset:8
ds_read_b64_tr_b16 v[50:51], v233 offset:0
ds_read_b128 v[52:55], v234 offset:512
ds_read_b64_tr_b16 v[56:57], v233 offset:520
ds_read_b64_tr_b16 v[58:59], v233 offset:512
ds_read_b128 v[60:63], v234 offset:0
ds_read_b128 v[64:67], v234 offset:1024
ds_read_b64_tr_b16 v[68:69], v233 offset:1032
s_waitcnt lgkmcnt(5)
v_mfma_f32_16x16x32_bf16 v[16:19], v[48:51], v[52:55], 0
ds_read_b64_tr_b16 v[70:71], v233 offset:1024
ds_read_b128 v[72:75], v234 offset:1536
s_mov_b32 s40, s4
s_and_b32 s41, s5, 0xffff
s_mov_b32 s42, 0x200000
s_mov_b32 s43, 0x00020000
buffer_load_dwordx4 v[224:227], v232, s[40:43], 0 offen
buffer_load_dwordx4 v[228:231], v232, s[40:43], 0 offen offset:64
s_waitcnt lgkmcnt(4)
v_mfma_f32_16x16x32_bf16 v[16:19], v[56:59], v[60:63], v[16:19]
ds_read_b64_tr_b16 v[76:77], v233 offset:1544
ds_read_b64_tr_b16 v[78:79], v233 offset:1536
v_mfma_f32_16x16x32_bf16 v[20:23], v[56:59], v[52:55], 0
ds_read_b128 v[80:83], v234 offset:2048
ds_read_b64_tr_b16 v[84:85], v233 offset:2056
s_waitcnt lgkmcnt(7)
v_mfma_f32_16x16x32_bf16 v[20:23], v[48:51], v[64:67], v[20:23]
ds_read_b64_tr_b16 v[86:87], v233 offset:2048
ds_read_b128 v[88:91], v234 offset:2560
v_mfma_f32_16x16x32_bf16 v[24:27], v[56:59], v[64:67], 0
ds_read_b64_tr_b16 v[92:93], v233 offset:2568
ds_read_b64_tr_b16 v[94:95], v233 offset:2560
s_waitcnt lgkmcnt(9)
v_mfma_f32_16x16x32_bf16 v[20:23], v[68:71], v[60:63], v[20:23]
ds_read_b128 v[96:99], v234 offset:3072
ds_read_b64_tr_b16 v[100:101], v233 offset:3080
v_mfma_f32_16x16x32_bf16 v[24:27], v[68:71], v[52:55], v[24:27]
ds_read_b64_tr_b16 v[102:103], v233 offset:3072
ds_read_b128 v[104:107], v234 offset:3584
v_mfma_f32_16x16x32_bf16 v[28:31], v[68:71], v[64:67], 0
ds_read_b64_tr_b16 v[108:109], v233 offset:3592
ds_read_b64_tr_b16 v[110:111], v233 offset:3584
s_waitcnt lgkmcnt(4)
v_mfma_f32_16x16x32_bf16 v[24:27], v[48:51], v[72:75], v[24:27]
ds_read_b128 v[112:115], v234 offset:4096
ds_read_b64_tr_b16 v[116:117], v233 offset:4104
s_lshl_b32 s59, s30, 2
s_and_b32 s60, s31, 3
s_add_u32 s59, s59, s60
s_lshl_b32 s59, s59, 2
s_add_u32 s59, s59, s52
s_lshl_b32 s59, s59, 12
s_add_u32 s59, s59, 21037056
s_lshr_b32 s60, s31, 2
s_lshl_b32 s60, s60, 7
s_add_u32 s59, s59, s60
v_and_b32 v2, 7, v1
v_lshlrev_b32 v2, 4, v2
v_bfe_u32 v3, v1, 3, 2
v_lshl_add_u32 v2, v3, 10, v2
v_mov_b32 v3, 0
buffer_store_dword v3, v2, s[32:35], s59 offen offset:12 sc1
v_mfma_f32_16x16x32_bf16 v[28:31], v[56:59], v[72:75], v[28:31]
ds_read_b64_tr_b16 v[118:119], v233 offset:4096
ds_read_b64_tr_b16 v[120:121], v233 offset:72
v_mfma_f32_16x16x32_bf16 v[32:35], v[68:71], v[72:75], 0
ds_read_b64_tr_b16 v[122:123], v233 offset:64
ds_read_b128 v[124:127], v234 offset:448
v_mfma_f32_16x16x32_bf16 v[24:27], v[76:79], v[60:63], v[24:27]
ds_read_b128 v[128:131], v234 offset:960
ds_read_b64_tr_b16 v[132:133], v233 offset:584
v_mfma_f32_16x16x32_bf16 v[28:31], v[76:79], v[52:55], v[28:31]
ds_read_b64_tr_b16 v[134:135], v233 offset:576
v_mfma_f32_16x16x32_bf16 v[32:35], v[76:79], v[64:67], v[32:35]
ds_read_b128 v[136:139], v234 offset:1472
v_mfma_f32_16x16x32_bf16 v[36:39], v[76:79], v[72:75], 0
ds_read_b64_tr_b16 v[140:141], v233 offset:1096
v_mfma_f32_16x16x32_bf16 v[28:31], v[48:51], v[80:83], v[28:31]
ds_read_b64_tr_b16 v[142:143], v233 offset:1088
v_mfma_f32_16x16x32_bf16 v[32:35], v[56:59], v[80:83], v[32:35]
ds_read_b128 v[144:147], v234 offset:1984
s_lshl_b32 s59, s30, 10
s_lshl_b32 s60, s52, 7
s_add_u32 s59, s59, s60
s_lshl_b32 s60, s31, 2
s_add_u32 s59, s59, s60
s_add_u32 s59, s59, 21020672
v_and_b32 v2, 1, v1
v_lshlrev_b32 v2, 9, v2
v_bfe_u32 v3, v1, 1, 1
v_lshl_add_u32 v2, v3, 13, v2
v_mov_b32 v3, 0
buffer_store_dword v3, v2, s[32:35], s59 offen sc1
v_mfma_f32_16x16x32_bf16 v[36:39], v[68:71], v[80:83], v[36:39]
ds_read_b64_tr_b16 v[148:149], v233 offset:1608
v_mfma_f32_16x16x32_bf16 v[40:43], v[76:79], v[80:83], 0
ds_read_b64_tr_b16 v[150:151], v233 offset:1600
v_mfma_f32_16x16x32_bf16 v[28:31], v[84:87], v[60:63], v[28:31]
ds_read_b128 v[152:155], v234 offset:2496
v_mfma_f32_16x16x32_bf16 v[32:35], v[84:87], v[52:55], v[32:35]
ds_read_b64_tr_b16 v[156:157], v233 offset:2120
v_mfma_f32_16x16x32_bf16 v[36:39], v[84:87], v[64:67], v[36:39]
ds_read_b64_tr_b16 v[158:159], v233 offset:2112
v_mfma_f32_16x16x32_bf16 v[40:43], v[84:87], v[72:75], v[40:43]
ds_read_b128 v[160:163], v234 offset:3008
v_mfma_f32_16x16x32_bf16 v[44:47], v[84:87], v[80:83], 0
ds_read_b64_tr_b16 v[164:165], v233 offset:2632
v_mfma_f32_16x16x32_bf16 v[32:35], v[48:51], v[88:91], v[32:35]
ds_read_b64_tr_b16 v[166:167], v233 offset:2624
s_add_u32 m0, s64, 65536
s_add_u32 s65, s63, 0
buffer_load_dwordx4 v221, s[48:51], s65 offen lds
v_mfma_f32_16x16x32_bf16 v[36:39], v[56:59], v[88:91], v[36:39]
ds_read_b128 v[168:171], v234 offset:3520
v_mfma_f32_16x16x32_bf16 v[40:43], v[68:71], v[88:91], v[40:43]
ds_read_b64_tr_b16 v[172:173], v233 offset:3144
v_mfma_f32_16x16x32_bf16 v[44:47], v[76:79], v[88:91], v[44:47]
ds_read_b64_tr_b16 v[174:175], v233 offset:3136
v_mfma_f32_16x16x32_bf16 v[32:35], v[92:95], v[60:63], v[32:35]
ds_read_b128 v[176:179], v234 offset:4032
v_mfma_f32_16x16x32_bf16 v[36:39], v[92:95], v[52:55], v[36:39]
ds_read_b64_tr_b16 v[180:181], v233 offset:3656
v_mfma_f32_16x16x32_bf16 v[40:43], v[92:95], v[64:67], v[40:43]
ds_read_b64_tr_b16 v[182:183], v233 offset:3648
v_mfma_f32_16x16x32_bf16 v[44:47], v[92:95], v[72:75], v[44:47]
ds_read_b64_tr_b16 v[184:185], v233 offset:136
v_mfma_f32_16x16x32_bf16 v[36:39], v[48:51], v[96:99], v[36:39]
ds_read_b64_tr_b16 v[186:187], v233 offset:128
s_add_u32 m0, s64, 4096
s_add_u32 s65, s63, 114688
buffer_load_dwordx4 v220, s[44:47], s65 offen lds
v_mfma_f32_16x16x32_bf16 v[40:43], v[56:59], v[96:99], v[40:43]
ds_read_b128 v[188:191], v234 offset:384
v_mfma_f32_16x16x32_bf16 v[44:47], v[68:71], v[96:99], v[44:47]
ds_read_b128 v[192:195], v234 offset:896
s_waitcnt lgkmcnt(4)
v_mfma_f32_16x16x32_bf16 v[36:39], v[100:103], v[60:63], v[36:39]
ds_read_b64_tr_b16 v[196:197], v233 offset:648
v_mfma_f32_16x16x32_bf16 v[40:43], v[100:103], v[52:55], v[40:43]
ds_read_b64_tr_b16 v[198:199], v233 offset:640
v_mfma_f32_16x16x32_bf16 v[44:47], v[100:103], v[64:67], v[44:47]
ds_read_b128 v[200:203], v234 offset:1408
v_mfma_f32_16x16x32_bf16 v[40:43], v[48:51], v[104:107], v[40:43]
ds_read_b64_tr_b16 v[204:205], v233 offset:1160
v_mfma_f32_16x16x32_bf16 v[44:47], v[56:59], v[104:107], v[44:47]
ds_read_b64_tr_b16 v[206:207], v233 offset:1152
v_mfma_f32_16x16x32_bf16 v[40:43], v[108:111], v[60:63], v[40:43]
ds_read_b128 v[84:87], v234 offset:1920
s_add_u32 m0, s64, 69632
s_add_u32 s65, s63, 114688
buffer_load_dwordx4 v221, s[48:51], s65 offen lds
v_mfma_f32_16x16x32_bf16 v[44:47], v[108:111], v[52:55], v[44:47]
ds_read_b64_tr_b16 v[80:81], v233 offset:1672
v_mfma_f32_16x16x32_bf16 v[44:47], v[48:51], v[112:115], v[44:47]
ds_read_b64_tr_b16 v[82:83], v233 offset:1664
v_mfma_f32_16x16x32_bf16 v[44:47], v[116:119], v[60:63], v[44:47]
ds_read_b128 v[76:79], v234 offset:2432
v_mfma_f32_16x16x32_bf16 v[16:19], v[120:123], v[124:127], v[16:19]
ds_read_b64_tr_b16 v[88:89], v233 offset:2184
v_mfma_f32_16x16x32_bf16 v[20:23], v[120:123], v[128:131], v[20:23]
ds_read_b64_tr_b16 v[90:91], v233 offset:2176
v_mfma_f32_16x16x32_bf16 v[20:23], v[132:135], v[124:127], v[20:23]
ds_read_b128 v[92:95], v234 offset:2944
v_mfma_f32_16x16x32_bf16 v[24:27], v[132:135], v[128:131], v[24:27]
ds_read_b64_tr_b16 v[72:73], v233 offset:2696
v_mfma_f32_16x16x32_bf16 v[24:27], v[120:123], v[136:139], v[24:27]
ds_read_b64_tr_b16 v[74:75], v233 offset:2688
s_add_u32 m0, s64, 8192
s_add_u32 s65, s63, 229376
buffer_load_dwordx4 v220, s[44:47], s65 offen lds
v_mfma_f32_16x16x32_bf16 v[28:31], v[132:135], v[136:139], v[28:31]
ds_read_b128 v[68:71], v234 offset:3456
v_mfma_f32_16x16x32_bf16 v[24:27], v[140:143], v[124:127], v[24:27]
ds_read_b64_tr_b16 v[96:97], v233 offset:3208
v_mfma_f32_16x16x32_bf16 v[28:31], v[140:143], v[128:131], v[28:31]
ds_read_b64_tr_b16 v[98:99], v233 offset:3200
v_mfma_f32_16x16x32_bf16 v[32:35], v[140:143], v[136:139], v[32:35]
ds_read_b128 v[100:103], v234 offset:3968
v_mfma_f32_16x16x32_bf16 v[28:31], v[120:123], v[144:147], v[28:31]
ds_read_b64_tr_b16 v[64:65], v233 offset:3720
v_mfma_f32_16x16x32_bf16 v[32:35], v[132:135], v[144:147], v[32:35]
ds_read_b64_tr_b16 v[66:67], v233 offset:3712
v_mfma_f32_16x16x32_bf16 v[36:39], v[140:143], v[144:147], v[36:39]
ds_read_b64_tr_b16 v[56:57], v233 offset:200
v_mfma_f32_16x16x32_bf16 v[28:31], v[148:151], v[124:127], v[28:31]
ds_read_b64_tr_b16 v[58:59], v233 offset:192
s_add_u32 m0, s64, 73728
s_add_u32 s65, s63, 229376
buffer_load_dwordx4 v221, s[48:51], s65 offen lds
v_mfma_f32_16x16x32_bf16 v[32:35], v[148:151], v[128:131], v[32:35]
ds_read_b128 v[104:107], v234 offset:320
v_mfma_f32_16x16x32_bf16 v[36:39], v[148:151], v[136:139], v[36:39]
ds_read_b128 v[108:111], v234 offset:832
v_mfma_f32_16x16x32_bf16 v[40:43], v[148:151], v[144:147], v[40:43]
ds_read_b64_tr_b16 v[52:53], v233 offset:712
v_mfma_f32_16x16x32_bf16 v[32:35], v[120:123], v[152:155], v[32:35]
ds_read_b64_tr_b16 v[54:55], v233 offset:704
v_mfma_f32_16x16x32_bf16 v[36:39], v[132:135], v[152:155], v[36:39]
ds_read_b128 v[48:51], v234 offset:1344
v_mfma_f32_16x16x32_bf16 v[40:43], v[140:143], v[152:155], v[40:43]
ds_read_b64_tr_b16 v[112:113], v233 offset:1224
v_mfma_f32_16x16x32_bf16 v[44:47], v[148:151], v[152:155], v[44:47]
ds_read_b64_tr_b16 v[114:115], v233 offset:1216
v_mfma_f32_16x16x32_bf16 v[32:35], v[156:159], v[124:127], v[32:35]
ds_read_b128 v[116:119], v234 offset:1856
s_add_u32 m0, s64, 12288
s_add_u32 s65, s63, 344064
buffer_load_dwordx4 v220, s[44:47], s65 offen lds
v_mfma_f32_16x16x32_bf16 v[36:39], v[156:159], v[128:131], v[36:39]
ds_read_b64_tr_b16 v[60:61], v233 offset:1736
v_mfma_f32_16x16x32_bf16 v[40:43], v[156:159], v[136:139], v[40:43]
ds_read_b64_tr_b16 v[62:63], v233 offset:1728
v_mfma_f32_16x16x32_bf16 v[44:47], v[156:159], v[144:147], v[44:47]
ds_read_b128 v[148:151], v234 offset:2368
v_mfma_f32_16x16x32_bf16 v[36:39], v[120:123], v[160:163], v[36:39]
ds_read_b64_tr_b16 v[152:153], v233 offset:2248
v_mfma_f32_16x16x32_bf16 v[40:43], v[132:135], v[160:163], v[40:43]
ds_read_b64_tr_b16 v[154:155], v233 offset:2240
v_mfma_f32_16x16x32_bf16 v[44:47], v[140:143], v[160:163], v[44:47]
ds_read_b128 v[156:159], v234 offset:2880
v_mfma_f32_16x16x32_bf16 v[36:39], v[164:167], v[124:127], v[36:39]
ds_read_b64_tr_b16 v[144:145], v233 offset:2760
v_mfma_f32_16x16x32_bf16 v[40:43], v[164:167], v[128:131], v[40:43]
ds_read_b64_tr_b16 v[146:147], v233 offset:2752
s_add_u32 m0, s64, 77824
s_add_u32 s65, s63, 344064
buffer_load_dwordx4 v221, s[48:51], s65 offen lds
v_mfma_f32_16x16x32_bf16 v[44:47], v[164:167], v[136:139], v[44:47]
ds_read_b128 v[140:143], v234 offset:3392
v_mfma_f32_16x16x32_bf16 v[40:43], v[120:123], v[168:171], v[40:43]
ds_read_b64_tr_b16 v[160:161], v233 offset:3272
v_mfma_f32_16x16x32_bf16 v[44:47], v[132:135], v[168:171], v[44:47]
ds_read_b64_tr_b16 v[162:163], v233 offset:3264
v_mfma_f32_16x16x32_bf16 v[40:43], v[172:175], v[124:127], v[40:43]
ds_read_b128 v[164:167], v234 offset:3904
v_mfma_f32_16x16x32_bf16 v[44:47], v[172:175], v[128:131], v[44:47]
ds_read_b64_tr_b16 v[136:137], v233 offset:3784
v_mfma_f32_16x16x32_bf16 v[44:47], v[120:123], v[176:179], v[44:47]
ds_read_b64_tr_b16 v[138:139], v233 offset:3776
v_mfma_f32_16x16x32_bf16 v[44:47], v[180:183], v[124:127], v[44:47]
s_waitcnt lgkmcnt(4)
v_mfma_f32_16x16x32_bf16 v[16:19], v[184:187], v[188:191], v[16:19]
s_add_u32 m0, s64, 16384
s_add_u32 s65, s63, 458752
buffer_load_dwordx4 v220, s[44:47], s65 offen lds
v_mfma_f32_16x16x32_bf16 v[20:23], v[184:187], v[192:195], v[20:23]
v_mfma_f32_16x16x32_bf16 v[20:23], v[196:199], v[188:191], v[20:23]
v_mfma_f32_16x16x32_bf16 v[24:27], v[196:199], v[192:195], v[24:27]
v_mfma_f32_16x16x32_bf16 v[24:27], v[184:187], v[200:203], v[24:27]
v_mfma_f32_16x16x32_bf16 v[28:31], v[196:199], v[200:203], v[28:31]
v_mfma_f32_16x16x32_bf16 v[24:27], v[204:207], v[188:191], v[24:27]
v_mfma_f32_16x16x32_bf16 v[28:31], v[204:207], v[192:195], v[28:31]
v_mfma_f32_16x16x32_bf16 v[32:35], v[204:207], v[200:203], v[32:35]
s_add_u32 m0, s64, 81920
s_add_u32 s65, s63, 458752
buffer_load_dwordx4 v221, s[48:51], s65 offen lds
v_mfma_f32_16x16x32_bf16 v[28:31], v[184:187], v[84:87], v[28:31]
v_mfma_f32_16x16x32_bf16 v[32:35], v[196:199], v[84:87], v[32:35]
v_mfma_f32_16x16x32_bf16 v[36:39], v[204:207], v[84:87], v[36:39]
v_mfma_f32_16x16x32_bf16 v[28:31], v[80:83], v[188:191], v[28:31]
v_mfma_f32_16x16x32_bf16 v[32:35], v[80:83], v[192:195], v[32:35]
v_mfma_f32_16x16x32_bf16 v[36:39], v[80:83], v[200:203], v[36:39]
v_mfma_f32_16x16x32_bf16 v[40:43], v[80:83], v[84:87], v[40:43]
v_mfma_f32_16x16x32_bf16 v[32:35], v[184:187], v[76:79], v[32:35]
s_add_u32 m0, s64, 20480
s_add_u32 s65, s63, 573440
buffer_load_dwordx4 v220, s[44:47], s65 offen lds
v_mfma_f32_16x16x32_bf16 v[36:39], v[196:199], v[76:79], v[36:39]
v_mfma_f32_16x16x32_bf16 v[40:43], v[204:207], v[76:79], v[40:43]
v_mfma_f32_16x16x32_bf16 v[44:47], v[80:83], v[76:79], v[44:47]
v_mfma_f32_16x16x32_bf16 v[32:35], v[88:91], v[188:191], v[32:35]
v_mfma_f32_16x16x32_bf16 v[36:39], v[88:91], v[192:195], v[36:39]
v_mfma_f32_16x16x32_bf16 v[40:43], v[88:91], v[200:203], v[40:43]
v_mfma_f32_16x16x32_bf16 v[44:47], v[88:91], v[84:87], v[44:47]
v_mfma_f32_16x16x32_bf16 v[36:39], v[184:187], v[92:95], v[36:39]
s_add_u32 m0, s64, 86016
s_add_u32 s65, s63, 573440
buffer_load_dwordx4 v221, s[48:51], s65 offen lds
v_mfma_f32_16x16x32_bf16 v[40:43], v[196:199], v[92:95], v[40:43]
v_mfma_f32_16x16x32_bf16 v[44:47], v[204:207], v[92:95], v[44:47]
v_mfma_f32_16x16x32_bf16 v[36:39], v[72:75], v[188:191], v[36:39]
v_mfma_f32_16x16x32_bf16 v[40:43], v[72:75], v[192:195], v[40:43]
v_mfma_f32_16x16x32_bf16 v[44:47], v[72:75], v[200:203], v[44:47]
v_mfma_f32_16x16x32_bf16 v[40:43], v[184:187], v[68:71], v[40:43]
v_mfma_f32_16x16x32_bf16 v[44:47], v[196:199], v[68:71], v[44:47]
v_mfma_f32_16x16x32_bf16 v[40:43], v[96:99], v[188:191], v[40:43]
s_add_u32 m0, s64, 24576
s_add_u32 s65, s63, 688128
buffer_load_dwordx4 v220, s[44:47], s65 offen lds
v_mfma_f32_16x16x32_bf16 v[44:47], v[96:99], v[192:195], v[44:47]
v_mfma_f32_16x16x32_bf16 v[44:47], v[184:187], v[100:103], v[44:47]
v_mfma_f32_16x16x32_bf16 v[44:47], v[64:67], v[188:191], v[44:47]
v_mfma_f32_16x16x32_bf16 v[16:19], v[56:59], v[104:107], v[16:19]
v_mfma_f32_16x16x32_bf16 v[20:23], v[56:59], v[108:111], v[20:23]
v_mfma_f32_16x16x32_bf16 v[20:23], v[52:55], v[104:107], v[20:23]
v_mfma_f32_16x16x32_bf16 v[24:27], v[52:55], v[108:111], v[24:27]
v_mfma_f32_16x16x32_bf16 v[24:27], v[56:59], v[48:51], v[24:27]
v_mfma_f32_16x16x32_bf16 v[28:31], v[52:55], v[48:51], v[28:31]
v_mfma_f32_16x16x32_bf16 v[24:27], v[112:115], v[104:107], v[24:27]
v_mfma_f32_16x16x32_bf16 v[28:31], v[112:115], v[108:111], v[28:31]
v_mfma_f32_16x16x32_bf16 v[32:35], v[112:115], v[48:51], v[32:35]
v_mfma_f32_16x16x32_bf16 v[28:31], v[56:59], v[116:119], v[28:31]
v_mfma_f32_16x16x32_bf16 v[32:35], v[52:55], v[116:119], v[32:35]
v_mfma_f32_16x16x32_bf16 v[36:39], v[112:115], v[116:119], v[36:39]
v_mfma_f32_16x16x32_bf16 v[28:31], v[60:63], v[104:107], v[28:31]
v_mfma_f32_16x16x32_bf16 v[32:35], v[60:63], v[108:111], v[32:35]
v_mfma_f32_16x16x32_bf16 v[36:39], v[60:63], v[48:51], v[36:39]
v_mfma_f32_16x16x32_bf16 v[40:43], v[60:63], v[116:119], v[40:43]
v_mfma_f32_16x16x32_bf16 v[32:35], v[56:59], v[148:151], v[32:35]
v_mfma_f32_16x16x32_bf16 v[36:39], v[52:55], v[148:151], v[36:39]
v_mfma_f32_16x16x32_bf16 v[40:43], v[112:115], v[148:151], v[40:43]
v_mfma_f32_16x16x32_bf16 v[44:47], v[60:63], v[148:151], v[44:47]
v_mfma_f32_16x16x32_bf16 v[32:35], v[152:155], v[104:107], v[32:35]
v_mfma_f32_16x16x32_bf16 v[36:39], v[152:155], v[108:111], v[36:39]
v_mfma_f32_16x16x32_bf16 v[40:43], v[152:155], v[48:51], v[40:43]
v_mfma_f32_16x16x32_bf16 v[44:47], v[152:155], v[116:119], v[44:47]
v_mfma_f32_16x16x32_bf16 v[36:39], v[56:59], v[156:159], v[36:39]
v_mfma_f32_16x16x32_bf16 v[40:43], v[52:55], v[156:159], v[40:43]
v_mfma_f32_16x16x32_bf16 v[44:47], v[112:115], v[156:159], v[44:47]
v_mfma_f32_16x16x32_bf16 v[36:39], v[144:147], v[104:107], v[36:39]
v_mfma_f32_16x16x32_bf16 v[40:43], v[144:147], v[108:111], v[40:43]
v_mfma_f32_16x16x32_bf16 v[44:47], v[144:147], v[48:51], v[44:47]
v_mfma_f32_16x16x32_bf16 v[40:43], v[56:59], v[140:143], v[40:43]
v_mfma_f32_16x16x32_bf16 v[44:47], v[52:55], v[140:143], v[44:47]
s_waitcnt lgkmcnt(3)
v_mfma_f32_16x16x32_bf16 v[40:43], v[160:163], v[104:107], v[40:43]
v_mfma_f32_16x16x32_bf16 v[44:47], v[160:163], v[108:111], v[44:47]
s_waitcnt lgkmcnt(2)
v_mfma_f32_16x16x32_bf16 v[44:47], v[56:59], v[164:167], v[44:47]
s_waitcnt lgkmcnt(0)
v_mfma_f32_16x16x32_bf16 v[44:47], v[136:139], v[104:107], v[44:47]
s_barrier
ds_write_b128 v237, v[32:35] offset:0
ds_write_b128 v237, v[36:39] offset:1024
ds_write_b128 v237, v[40:43] offset:2048
s_nop 3
ds_write_b128 v237, v[44:47] offset:3072
ds_read_b64 v[48:49], v235 offset:512
ds_read_b64 v[50:51], v235 offset:1024
ds_read_b64 v[52:53], v235 offset:1536
ds_read_b64 v[54:55], v235 offset:2048
s_waitcnt lgkmcnt(0)
s_barrier
ds_read_b128 v[56:59], v237 offset:4096
ds_read_b128 v[60:63], v237 offset:5120
ds_read_b128 v[64:67], v237 offset:6144
ds_read_b128 v[68:71], v237 offset:7168
v_lshlrev_b32 v72, 16, v48
v_and_b32 v73, 0xffff0000, v48
v_lshlrev_b32 v74, 16, v49
v_and_b32 v75, 0xffff0000, v49
v_lshlrev_b32 v76, 16, v50
v_and_b32 v77, 0xffff0000, v50
v_lshlrev_b32 v78, 16, v51
v_and_b32 v79, 0xffff0000, v51
v_lshlrev_b32 v80, 16, v52
v_and_b32 v81, 0xffff0000, v52
v_lshlrev_b32 v82, 16, v53
v_and_b32 v83, 0xffff0000, v53
v_lshlrev_b32 v84, 16, v54
v_and_b32 v85, 0xffff0000, v54
v_lshlrev_b32 v86, 16, v55
v_and_b32 v87, 0xffff0000, v55
v_fma_f32 v16, v72, s92, v16
v_fma_f32 v17, v73, s92, v17
v_fma_f32 v18, v74, s92, v18
v_fma_f32 v19, v75, s92, v19
v_fma_f32 v20, v76, s92, v20
v_fma_f32 v21, v77, s92, v21
v_fma_f32 v22, v78, s92, v22
v_fma_f32 v23, v79, s92, v23
v_fma_f32 v24, v80, s92, v24
v_fma_f32 v25, v81, s92, v25
v_fma_f32 v26, v82, s92, v26
v_fma_f32 v27, v83, s92, v27
v_fma_f32 v28, v84, s92, v28
v_fma_f32 v29, v85, s92, v29
v_fma_f32 v30, v86, s92, v30
v_fma_f32 v31, v87, s92, v31
s_waitcnt lgkmcnt(0)
v_add_f32 v16, v16, v56
v_add_f32 v17, v17, v57
v_add_f32 v18, v18, v58
v_add_f32 v19, v19, v59
v_cvt_pk_bf16_f32 v48, v16, v17
v_cvt_pk_bf16_f32 v49, v18, v19
s_add_u32 s96, s95, 0
buffer_store_dwordx2 v[48:49], v236, s[32:35], s96 offen sc1
v_add_f32 v20, v20, v60
v_add_f32 v21, v21, v61
v_add_f32 v22, v22, v62
v_add_f32 v23, v23, v63
v_cvt_pk_bf16_f32 v50, v20, v21
v_cvt_pk_bf16_f32 v51, v22, v23
s_add_u32 s96, s95, 262144
buffer_store_dwordx2 v[50:51], v236, s[32:35], s96 offen sc1
v_add_f32 v24, v24, v64
v_add_f32 v25, v25, v65
v_add_f32 v26, v26, v66
v_add_f32 v27, v27, v67
v_cvt_pk_bf16_f32 v52, v24, v25
v_cvt_pk_bf16_f32 v53, v26, v27
s_add_u32 s96, s95, 524288
buffer_store_dwordx2 v[52:53], v236, s[32:35], s96 offen sc1
v_add_f32 v28, v28, v68
v_add_f32 v29, v29, v69
v_add_f32 v30, v30, v70
v_add_f32 v31, v31, v71
v_cvt_pk_bf16_f32 v54, v28, v29
v_cvt_pk_bf16_f32 v55, v30, v31
s_add_u32 s96, s95, 786432
buffer_store_dwordx2 v[54:55], v236, s[32:35], s96 offen sc1
s_branch C_join_15
C_hf1_14:
ds_read_b64_tr_b16 v[48:49], v233 offset:264
ds_read_b64_tr_b16 v[50:51], v233 offset:256
ds_read_b128 v[52:55], v234 offset:256
ds_read_b128 v[56:59], v234 offset:768
ds_read_b64_tr_b16 v[60:61], v233 offset:776
ds_read_b64_tr_b16 v[62:63], v233 offset:768
ds_read_b128 v[64:67], v234 offset:1280
ds_read_b64_tr_b16 v[68:69], v233 offset:1288
s_waitcnt lgkmcnt(5)
v_mfma_f32_16x16x32_bf16 v[16:19], v[48:51], v[52:55], 0
ds_read_b64_tr_b16 v[70:71], v233 offset:1280
ds_read_b128 v[72:75], v234 offset:1792
s_mov_b32 s40, s4
s_and_b32 s41, s5, 0xffff
s_mov_b32 s42, 0x200000
s_mov_b32 s43, 0x00020000
buffer_load_dwordx4 v[224:227], v232, s[40:43], 0 offen
buffer_load_dwordx4 v[228:231], v232, s[40:43], 0 offen offset:64
s_waitcnt lgkmcnt(6)
v_mfma_f32_16x16x32_bf16 v[20:23], v[48:51], v[56:59], 0
ds_read_b64_tr_b16 v[76:77], v233 offset:1800
ds_read_b64_tr_b16 v[78:79], v233 offset:1792
s_waitcnt lgkmcnt(6)
v_mfma_f32_16x16x32_bf16 v[20:23], v[60:63], v[52:55], v[20:23]
ds_read_b128 v[80:83], v234 offset:2304
ds_read_b64_tr_b16 v[84:85], v233 offset:2312
v_mfma_f32_16x16x32_bf16 v[24:27], v[60:63], v[56:59], 0
ds_read_b64_tr_b16 v[86:87], v233 offset:2304
ds_read_b128 v[88:91], v234 offset:2816
s_waitcnt lgkmcnt(9)
v_mfma_f32_16x16x32_bf16 v[24:27], v[48:51], v[64:67], v[24:27]
ds_read_b64_tr_b16 v[92:93], v233 offset:2824
ds_read_b64_tr_b16 v[94:95], v233 offset:2816
v_mfma_f32_16x16x32_bf16 v[28:31], v[60:63], v[64:67], 0
ds_read_b128 v[96:99], v234 offset:3328
ds_read_b64_tr_b16 v[100:101], v233 offset:3336
s_waitcnt lgkmcnt(4)
v_mfma_f32_16x16x32_bf16 v[24:27], v[68:71], v[52:55], v[24:27]
ds_read_b64_tr_b16 v[102:103], v233 offset:3328
ds_read_b128 v[104:107], v234 offset:3840
v_mfma_f32_16x16x32_bf16 v[28:31], v[68:71], v[56:59], v[28:31]
ds_read_b64_tr_b16 v[108:109], v233 offset:3848
ds_read_b64_tr_b16 v[110:111], v233 offset:3840
v_mfma_f32_16x16x32_bf16 v[32:35], v[68:71], v[64:67], 0
ds_read_b64_tr_b16 v[112:113], v233 offset:328
ds_read_b64_tr_b16 v[114:115], v233 offset:320
s_lshl_b32 s59, s30, 2
s_and_b32 s60, s31, 3
s_add_u32 s59, s59, s60
s_lshl_b32 s59, s59, 2
s_add_u32 s59, s59, s52
s_lshl_b32 s59, s59, 12
s_add_u32 s59, s59, 21037056
s_lshr_b32 s60, s31, 2
s_lshl_b32 s60, s60, 7
s_add_u32 s59, s59, s60
v_and_b32 v2, 7, v1
v_lshlrev_b32 v2, 4, v2
v_bfe_u32 v3, v1, 3, 2
v_lshl_add_u32 v2, v3, 10, v2
v_mov_b32 v3, 0
buffer_store_dword v3, v2, s[32:35], s59 offen offset:12 sc1
v_mfma_f32_16x16x32_bf16 v[28:31], v[48:51], v[72:75], v[28:31]
ds_read_b128 v[116:119], v234 offset:192
ds_read_b128 v[120:123], v234 offset:704
v_mfma_f32_16x16x32_bf16 v[32:35], v[60:63], v[72:75], v[32:35]
ds_read_b64_tr_b16 v[124:125], v233 offset:840
ds_read_b64_tr_b16 v[126:127], v233 offset:832
v_mfma_f32_16x16x32_bf16 v[36:39], v[68:71], v[72:75], 0
ds_read_b128 v[128:131], v234 offset:1216
ds_read_b64_tr_b16 v[132:133], v233 offset:1352
v_mfma_f32_16x16x32_bf16 v[28:31], v[76:79], v[52:55], v[28:31]
ds_read_b64_tr_b16 v[134:135], v233 offset:1344
v_mfma_f32_16x16x32_bf16 v[32:35], v[76:79], v[56:59], v[32:35]
ds_read_b128 v[136:139], v234 offset:1728
v_mfma_f32_16x16x32_bf16 v[36:39], v[76:79], v[64:67], v[36:39]
ds_read_b64_tr_b16 v[140:141], v233 offset:1864
v_mfma_f32_16x16x32_bf16 v[40:43], v[76:79], v[72:75], 0
ds_read_b64_tr_b16 v[142:143], v233 offset:1856
v_mfma_f32_16x16x32_bf16 v[32:35], v[48:51], v[80:83], v[32:35]
ds_read_b128 v[144:147], v234 offset:2240
s_lshl_b32 s59, s30, 10
s_lshl_b32 s60, s52, 7
s_add_u32 s59, s59, s60
s_lshl_b32 s60, s31, 2
s_add_u32 s59, s59, s60
s_add_u32 s59, s59, 21020672
v_and_b32 v2, 1, v1
v_lshlrev_b32 v2, 9, v2
v_bfe_u32 v3, v1, 1, 1
v_lshl_add_u32 v2, v3, 13, v2
v_mov_b32 v3, 0
buffer_store_dword v3, v2, s[32:35], s59 offen sc1
v_mfma_f32_16x16x32_bf16 v[36:39], v[60:63], v[80:83], v[36:39]
ds_read_b64_tr_b16 v[148:149], v233 offset:2376
v_mfma_f32_16x16x32_bf16 v[40:43], v[68:71], v[80:83], v[40:43]
ds_read_b64_tr_b16 v[150:151], v233 offset:2368
v_mfma_f32_16x16x32_bf16 v[44:47], v[76:79], v[80:83], 0
ds_read_b128 v[152:155], v234 offset:2752
v_mfma_f32_16x16x32_bf16 v[32:35], v[84:87], v[52:55], v[32:35]
ds_read_b64_tr_b16 v[156:157], v233 offset:2888
v_mfma_f32_16x16x32_bf16 v[36:39], v[84:87], v[56:59], v[36:39]
ds_read_b64_tr_b16 v[158:159], v233 offset:2880
v_mfma_f32_16x16x32_bf16 v[40:43], v[84:87], v[64:67], v[40:43]
ds_read_b128 v[160:163], v234 offset:3264
v_mfma_f32_16x16x32_bf16 v[44:47], v[84:87], v[72:75], v[44:47]
ds_read_b64_tr_b16 v[164:165], v233 offset:3400
v_mfma_f32_16x16x32_bf16 v[36:39], v[48:51], v[88:91], v[36:39]
ds_read_b64_tr_b16 v[166:167], v233 offset:3392
s_add_u32 m0, s64, 65536
s_add_u32 s65, s63, 0
buffer_load_dwordx4 v221, s[48:51], s65 offen lds
v_mfma_f32_16x16x32_bf16 v[40:43], v[60:63], v[88:91], v[40:43]
ds_read_b128 v[168:171], v234 offset:3776
v_mfma_f32_16x16x32_bf16 v[44:47], v[68:71], v[88:91], v[44:47]
ds_read_b64_tr_b16 v[172:173], v233 offset:3912
s_waitcnt lgkmcnt(4)
v_mfma_f32_16x16x32_bf16 v[36:39], v[92:95], v[52:55], v[36:39]
ds_read_b64_tr_b16 v[174:175], v233 offset:3904
v_mfma_f32_16x16x32_bf16 v[40:43], v[92:95], v[56:59], v[40:43]
ds_read_b64_tr_b16 v[176:177], v233 offset:392
v_mfma_f32_16x16x32_bf16 v[44:47], v[92:95], v[64:67], v[44:47]
ds_read_b64_tr_b16 v[178:179], v233 offset:384
v_mfma_f32_16x16x32_bf16 v[40:43], v[48:51], v[96:99], v[40:43]
ds_read_b128 v[180:183], v234 offset:128
v_mfma_f32_16x16x32_bf16 v[44:47], v[60:63], v[96:99], v[44:47]
ds_read_b128 v[184:187], v234 offset:640
v_mfma_f32_16x16x32_bf16 v[40:43], v[100:103], v[52:55], v[40:43]
ds_read_b64_tr_b16 v[188:189], v233 offset:904
s_add_u32 m0, s64, 4096
s_add_u32 s65, s63, 114688
buffer_load_dwordx4 v220, s[44:47], s65 offen lds
v_mfma_f32_16x16x32_bf16 v[44:47], v[100:103], v[56:59], v[44:47]
ds_read_b64_tr_b16 v[190:191], v233 offset:896
v_mfma_f32_16x16x32_bf16 v[44:47], v[48:51], v[104:107], v[44:47]
ds_read_b128 v[192:195], v234 offset:1152
v_mfma_f32_16x16x32_bf16 v[44:47], v[108:111], v[52:55], v[44:47]
ds_read_b64_tr_b16 v[196:197], v233 offset:1416
v_mfma_f32_16x16x32_bf16 v[16:19], v[112:115], v[116:119], v[16:19]
ds_read_b64_tr_b16 v[198:199], v233 offset:1408
v_mfma_f32_16x16x32_bf16 v[20:23], v[112:115], v[120:123], v[20:23]
ds_read_b128 v[200:203], v234 offset:1664
v_mfma_f32_16x16x32_bf16 v[20:23], v[124:127], v[116:119], v[20:23]
ds_read_b64_tr_b16 v[204:205], v233 offset:1928
v_mfma_f32_16x16x32_bf16 v[24:27], v[124:127], v[120:123], v[24:27]
ds_read_b64_tr_b16 v[206:207], v233 offset:1920
v_mfma_f32_16x16x32_bf16 v[24:27], v[112:115], v[128:131], v[24:27]
ds_read_b128 v[76:79], v234 offset:2176
s_add_u32 m0, s64, 69632
s_add_u32 s65, s63, 114688
buffer_load_dwordx4 v221, s[48:51], s65 offen lds
v_mfma_f32_16x16x32_bf16 v[28:31], v[124:127], v[128:131], v[28:31]
ds_read_b64_tr_b16 v[80:81], v233 offset:2440
v_mfma_f32_16x16x32_bf16 v[24:27], v[132:135], v[116:119], v[24:27]
ds_read_b64_tr_b16 v[82:83], v233 offset:2432
v_mfma_f32_16x16x32_bf16 v[28:31], v[132:135], v[120:123], v[28:31]
ds_read_b128 v[84:87], v234 offset:2688
v_mfma_f32_16x16x32_bf16 v[32:35], v[132:135], v[128:131], v[32:35]
ds_read_b64_tr_b16 v[72:73], v233 offset:2952
v_mfma_f32_16x16x32_bf16 v[28:31], v[112:115], v[136:139], v[28:31]
ds_read_b64_tr_b16 v[74:75], v233 offset:2944
v_mfma_f32_16x16x32_bf16 v[32:35], v[124:127], v[136:139], v[32:35]
ds_read_b128 v[68:71], v234 offset:3200
v_mfma_f32_16x16x32_bf16 v[36:39], v[132:135], v[136:139], v[36:39]
ds_read_b64_tr_b16 v[88:89], v233 offset:3464
v_mfma_f32_16x16x32_bf16 v[28:31], v[140:143], v[116:119], v[28:31]
ds_read_b64_tr_b16 v[90:91], v233 offset:3456
s_add_u32 m0, s64, 8192
s_add_u32 s65, s63, 229376
buffer_load_dwordx4 v220, s[44:47], s65 offen lds
v_mfma_f32_16x16x32_bf16 v[32:35], v[140:143], v[120:123], v[32:35]
ds_read_b128 v[92:95], v234 offset:3712
v_mfma_f32_16x16x32_bf16 v[36:39], v[140:143], v[128:131], v[36:39]
ds_read_b64_tr_b16 v[64:65], v233 offset:3976
v_mfma_f32_16x16x32_bf16 v[40:43], v[140:143], v[136:139], v[40:43]
ds_read_b64_tr_b16 v[66:67], v233 offset:3968
v_mfma_f32_16x16x32_bf16 v[32:35], v[112:115], v[144:147], v[32:35]
ds_read_b64_tr_b16 v[60:61], v233 offset:456
v_mfma_f32_16x16x32_bf16 v[36:39], v[124:127], v[144:147], v[36:39]
ds_read_b64_tr_b16 v[62:63], v233 offset:448
v_mfma_f32_16x16x32_bf16 v[40:43], v[132:135], v[144:147], v[40:43]
ds_read_b128 v[96:99], v234 offset:64
v_mfma_f32_16x16x32_bf16 v[44:47], v[140:143], v[144:147], v[44:47]
ds_read_b128 v[100:103], v234 offset:576
v_mfma_f32_16x16x32_bf16 v[32:35], v[148:151], v[116:119], v[32:35]
ds_read_b64_tr_b16 v[56:57], v233 offset:968
s_add_u32 m0, s64, 73728
s_add_u32 s65, s63, 229376
buffer_load_dwordx4 v221, s[48:51], s65 offen lds
v_mfma_f32_16x16x32_bf16 v[36:39], v[148:151], v[120:123], v[36:39]
ds_read_b64_tr_b16 v[58:59], v233 offset:960
v_mfma_f32_16x16x32_bf16 v[40:43], v[148:151], v[128:131], v[40:43]
ds_read_b128 v[48:51], v234 offset:1088
v_mfma_f32_16x16x32_bf16 v[44:47], v[148:151], v[136:139], v[44:47]
ds_read_b64_tr_b16 v[104:105], v233 offset:1480
v_mfma_f32_16x16x32_bf16 v[36:39], v[112:115], v[152:155], v[36:39]
ds_read_b64_tr_b16 v[106:107], v233 offset:1472
v_mfma_f32_16x16x32_bf16 v[40:43], v[124:127], v[152:155], v[40:43]
ds_read_b128 v[108:111], v234 offset:1600
v_mfma_f32_16x16x32_bf16 v[44:47], v[132:135], v[152:155], v[44:47]
ds_read_b64_tr_b16 v[52:53], v233 offset:1992
v_mfma_f32_16x16x32_bf16 v[36:39], v[156:159], v[116:119], v[36:39]
ds_read_b64_tr_b16 v[54:55], v233 offset:1984
v_mfma_f32_16x16x32_bf16 v[40:43], v[156:159], v[120:123], v[40:43]
ds_read_b128 v[140:143], v234 offset:2112
s_add_u32 m0, s64, 12288
s_add_u32 s65, s63, 344064
buffer_load_dwordx4 v220, s[44:47], s65 offen lds
v_mfma_f32_16x16x32_bf16 v[44:47], v[156:159], v[128:131], v[44:47]
ds_read_b64_tr_b16 v[144:145], v233 offset:2504
v_mfma_f32_16x16x32_bf16 v[40:43], v[112:115], v[160:163], v[40:43]
ds_read_b64_tr_b16 v[146:147], v233 offset:2496
v_mfma_f32_16x16x32_bf16 v[44:47], v[124:127], v[160:163], v[44:47]
ds_read_b128 v[148:151], v234 offset:2624
s_waitcnt lgkmcnt(4)
v_mfma_f32_16x16x32_bf16 v[40:43], v[164:167], v[116:119], v[40:43]
ds_read_b64_tr_b16 v[136:137], v233 offset:3016
v_mfma_f32_16x16x32_bf16 v[44:47], v[164:167], v[120:123], v[44:47]
ds_read_b64_tr_b16 v[138:139], v233 offset:3008
v_mfma_f32_16x16x32_bf16 v[44:47], v[112:115], v[168:171], v[44:47]
ds_read_b128 v[132:135], v234 offset:3136
v_mfma_f32_16x16x32_bf16 v[44:47], v[172:175], v[116:119], v[44:47]
ds_read_b64_tr_b16 v[152:153], v233 offset:3528
v_mfma_f32_16x16x32_bf16 v[16:19], v[176:179], v[180:183], v[16:19]
ds_read_b64_tr_b16 v[154:155], v233 offset:3520
s_add_u32 m0, s64, 77824
s_add_u32 s65, s63, 344064
buffer_load_dwordx4 v221, s[48:51], s65 offen lds
v_mfma_f32_16x16x32_bf16 v[20:23], v[176:179], v[184:187], v[20:23]
ds_read_b128 v[156:159], v234 offset:3648
v_mfma_f32_16x16x32_bf16 v[20:23], v[188:191], v[180:183], v[20:23]
ds_read_b64_tr_b16 v[128:129], v233 offset:4040
v_mfma_f32_16x16x32_bf16 v[24:27], v[188:191], v[184:187], v[24:27]
ds_read_b64_tr_b16 v[130:131], v233 offset:4032
v_mfma_f32_16x16x32_bf16 v[24:27], v[176:179], v[192:195], v[24:27]
v_mfma_f32_16x16x32_bf16 v[28:31], v[188:191], v[192:195], v[28:31]
v_mfma_f32_16x16x32_bf16 v[24:27], v[196:199], v[180:183], v[24:27]
v_mfma_f32_16x16x32_bf16 v[28:31], v[196:199], v[184:187], v[28:31]
v_mfma_f32_16x16x32_bf16 v[32:35], v[196:199], v[192:195], v[32:35]
s_add_u32 m0, s64, 16384
s_add_u32 s65, s63, 458752
buffer_load_dwordx4 v220, s[44:47], s65 offen lds
v_mfma_f32_16x16x32_bf16 v[28:31], v[176:179], v[200:203], v[28:31]
v_mfma_f32_16x16x32_bf16 v[32:35], v[188:191], v[200:203], v[32:35]
v_mfma_f32_16x16x32_bf16 v[36:39], v[196:199], v[200:203], v[36:39]
v_mfma_f32_16x16x32_bf16 v[28:31], v[204:207], v[180:183], v[28:31]
v_mfma_f32_16x16x32_bf16 v[32:35], v[204:207], v[184:187], v[32:35]
v_mfma_f32_16x16x32_bf16 v[36:39], v[204:207], v[192:195], v[36:39]
v_mfma_f32_16x16x32_bf16 v[40:43], v[204:207], v[200:203], v[40:43]
v_mfma_f32_16x16x32_bf16 v[32:35], v[176:179], v[76:79], v[32:35]
s_add_u32 m0, s64, 81920
s_add_u32 s65, s63, 458752
buffer_load_dwordx4 v221, s[48:51], s65 offen lds
v_mfma_f32_16x16x32_bf16 v[36:39], v[188:191], v[76:79], v[36:39]
v_mfma_f32_16x16x32_bf16 v[40:43], v[196:199], v[76:79], v[40:43]
v_mfma_f32_16x16x32_bf16 v[44:47], v[204:207], v[76:79], v[44:47]
v_mfma_f32_16x16x32_bf16 v[32:35], v[80:83], v[180:183], v[32:35]
v_mfma_f32_16x16x32_bf16 v[36:39], v[80:83], v[184:187], v[36:39]
v_mfma_f32_16x16x32_bf16 v[40:43], v[80:83], v[192:195], v[40:43]
v_mfma_f32_16x16x32_bf16 v[44:47], v[80:83], v[200:203], v[44:47]
v_mfma_f32_16x16x32_bf16 v[36:39], v[176:179], v[84:87], v[36:39]
s_add_u32 m0, s64, 20480
s_add_u32 s65, s63, 573440
buffer_load_dwordx4 v220, s[44:47], s65 offen lds
v_mfma_f32_16x16x32_bf16 v[40:43], v[188:191], v[84:87], v[40:43]
v_mfma_f32_16x16x32_bf16 v[44:47], v[196:199], v[84:87], v[44:47]
v_mfma_f32_16x16x32_bf16 v[36:39], v[72:75], v[180:183], v[36:39]
v_mfma_f32_16x16x32_bf16 v[40:43], v[72:75], v[184:187], v[40:43]
v_mfma_f32_16x16x32_bf16 v[44:47], v[72:75], v[192:195], v[44:47]
v_mfma_f32_16x16x32_bf16 v[40:43], v[176:179], v[68:71], v[40:43]
v_mfma_f32_16x16x32_bf16 v[44:47], v[188:191], v[68:71], v[44:47]
v_mfma_f32_16x16x32_bf16 v[40:43], v[88:91], v[180:183], v[40:43]
s_add_u32 m0, s64, 86016
s_add_u32 s65, s63, 573440
buffer_load_dwordx4 v221, s[48:51], s65 offen lds
v_mfma_f32_16x16x32_bf16 v[44:47], v[88:91], v[184:187], v[44:47]
v_mfma_f32_16x16x32_bf16 v[44:47], v[176:179], v[92:95], v[44:47]
v_mfma_f32_16x16x32_bf16 v[44:47], v[64:67], v[180:183], v[44:47]
v_mfma_f32_16x16x32_bf16 v[16:19], v[60:63], v[96:99], v[16:19]
v_mfma_f32_16x16x32_bf16 v[20:23], v[60:63], v[100:103], v[20:23]
v_mfma_f32_16x16x32_bf16 v[20:23], v[56:59], v[96:99], v[20:23]
v_mfma_f32_16x16x32_bf16 v[24:27], v[56:59], v[100:103], v[24:27]
v_mfma_f32_16x16x32_bf16 v[24:27], v[60:63], v[48:51], v[24:27]
s_add_u32 m0, s64, 24576
s_add_u32 s65, s63, 688128
buffer_load_dwordx4 v220, s[44:47], s65 offen lds
v_mfma_f32_16x16x32_bf16 v[28:31], v[56:59], v[48:51], v[28:31]
v_mfma_f32_16x16x32_bf16 v[24:27], v[104:107], v[96:99], v[24:27]
v_mfma_f32_16x16x32_bf16 v[28:31], v[104:107], v[100:103], v[28:31]
v_mfma_f32_16x16x32_bf16 v[32:35], v[104:107], v[48:51], v[32:35]
v_mfma_f32_16x16x32_bf16 v[28:31], v[60:63], v[108:111], v[28:31]
v_mfma_f32_16x16x32_bf16 v[32:35], v[56:59], v[108:111], v[32:35]
v_mfma_f32_16x16x32_bf16 v[36:39], v[104:107], v[108:111], v[36:39]
v_mfma_f32_16x16x32_bf16 v[28:31], v[52:55], v[96:99], v[28:31]
v_mfma_f32_16x16x32_bf16 v[32:35], v[52:55], v[100:103], v[32:35]
v_mfma_f32_16x16x32_bf16 v[36:39], v[52:55], v[48:51], v[36:39]
v_mfma_f32_16x16x32_bf16 v[40:43], v[52:55], v[108:111], v[40:43]
s_waitcnt lgkmcnt(4)
v_mfma_f32_16x16x32_bf16 v[32:35], v[60:63], v[140:143], v[32:35]
v_mfma_f32_16x16x32_bf16 v[36:39], v[56:59], v[140:143], v[36:39]
v_mfma_f32_16x16x32_bf16 v[40:43], v[104:107], v[140:143], v[40:43]
v_mfma_f32_16x16x32_bf16 v[44:47], v[52:55], v[140:143], v[44:47]
v_mfma_f32_16x16x32_bf16 v[32:35], v[144:147], v[96:99], v[32:35]
v_mfma_f32_16x16x32_bf16 v[36:39], v[144:147], v[100:103], v[36:39]
v_mfma_f32_16x16x32_bf16 v[40:43], v[144:147], v[48:51], v[40:43]
v_mfma_f32_16x16x32_bf16 v[44:47], v[144:147], v[108:111], v[44:47]
v_mfma_f32_16x16x32_bf16 v[36:39], v[60:63], v[148:151], v[36:39]
v_mfma_f32_16x16x32_bf16 v[40:43], v[56:59], v[148:151], v[40:43]
v_mfma_f32_16x16x32_bf16 v[44:47], v[104:107], v[148:151], v[44:47]
v_mfma_f32_16x16x32_bf16 v[36:39], v[136:139], v[96:99], v[36:39]
v_mfma_f32_16x16x32_bf16 v[40:43], v[136:139], v[100:103], v[40:43]
v_mfma_f32_16x16x32_bf16 v[44:47], v[136:139], v[48:51], v[44:47]
v_mfma_f32_16x16x32_bf16 v[40:43], v[60:63], v[132:135], v[40:43]
v_mfma_f32_16x16x32_bf16 v[44:47], v[56:59], v[132:135], v[44:47]
s_waitcnt lgkmcnt(3)
v_mfma_f32_16x16x32_bf16 v[40:43], v[152:155], v[96:99], v[40:43]
v_mfma_f32_16x16x32_bf16 v[44:47], v[152:155], v[100:103], v[44:47]
s_waitcnt lgkmcnt(2)
v_mfma_f32_16x16x32_bf16 v[44:47], v[60:63], v[156:159], v[44:47]
s_waitcnt lgkmcnt(0)
v_mfma_f32_16x16x32_bf16 v[44:47], v[128:131], v[96:99], v[44:47]
s_barrier
ds_write_b128 v237, v[16:19] offset:4096
ds_write_b128 v237, v[20:23] offset:5120
ds_write_b128 v237, v[24:27] offset:6144
ds_write_b128 v237, v[28:31] offset:7168
ds_read_b64 v[48:49], v235 offset:2560
ds_read_b64 v[50:51], v235 offset:3072
ds_read_b64 v[52:53], v235 offset:3584
ds_read_b64 v[54:55], v235 offset:4096
s_waitcnt lgkmcnt(0)
s_barrier
ds_read_b128 v[56:59], v237 offset:0
ds_read_b128 v[60:63], v237 offset:1024
ds_read_b128 v[64:67], v237 offset:2048
ds_read_b128 v[68:71], v237 offset:3072
v_lshlrev_b32 v72, 16, v48
v_and_b32 v73, 0xffff0000, v48
v_lshlrev_b32 v74, 16, v49
v_and_b32 v75, 0xffff0000, v49
v_lshlrev_b32 v76, 16, v50
v_and_b32 v77, 0xffff0000, v50
v_lshlrev_b32 v78, 16, v51
v_and_b32 v79, 0xffff0000, v51
v_lshlrev_b32 v80, 16, v52
v_and_b32 v81, 0xffff0000, v52
v_lshlrev_b32 v82, 16, v53
v_and_b32 v83, 0xffff0000, v53
v_lshlrev_b32 v84, 16, v54
v_and_b32 v85, 0xffff0000, v54
v_lshlrev_b32 v86, 16, v55
v_and_b32 v87, 0xffff0000, v55
v_fma_f32 v32, v72, s92, v32
v_fma_f32 v33, v73, s92, v33
v_fma_f32 v34, v74, s92, v34
v_fma_f32 v35, v75, s92, v35
v_fma_f32 v36, v76, s92, v36
v_fma_f32 v37, v77, s92, v37
v_fma_f32 v38, v78, s92, v38
v_fma_f32 v39, v79, s92, v39
v_fma_f32 v40, v80, s92, v40
v_fma_f32 v41, v81, s92, v41
v_fma_f32 v42, v82, s92, v42
v_fma_f32 v43, v83, s92, v43
v_fma_f32 v44, v84, s92, v44
v_fma_f32 v45, v85, s92, v45
v_fma_f32 v46, v86, s92, v46
v_fma_f32 v47, v87, s92, v47
s_waitcnt lgkmcnt(0)
v_add_f32 v32, v32, v56
v_add_f32 v33, v33, v57
v_add_f32 v34, v34, v58
v_add_f32 v35, v35, v59
v_cvt_pk_bf16_f32 v48, v32, v33
v_cvt_pk_bf16_f32 v49, v34, v35
s_add_u32 s96, s95, 1048576
buffer_store_dwordx2 v[48:49], v236, s[32:35], s96 offen sc1
v_add_f32 v36, v36, v60
v_add_f32 v37, v37, v61
v_add_f32 v38, v38, v62
v_add_f32 v39, v39, v63
v_cvt_pk_bf16_f32 v50, v36, v37
v_cvt_pk_bf16_f32 v51, v38, v39
s_add_u32 s96, s95, 1310720
buffer_store_dwordx2 v[50:51], v236, s[32:35], s96 offen sc1
v_add_f32 v40, v40, v64
v_add_f32 v41, v41, v65
v_add_f32 v42, v42, v66
v_add_f32 v43, v43, v67
v_cvt_pk_bf16_f32 v52, v40, v41
v_cvt_pk_bf16_f32 v53, v42, v43
s_add_u32 s96, s95, 1572864
buffer_store_dwordx2 v[52:53], v236, s[32:35], s96 offen sc1
v_add_f32 v44, v44, v68
v_add_f32 v45, v45, v69
v_add_f32 v46, v46, v70
v_add_f32 v47, v47, v71
v_cvt_pk_bf16_f32 v54, v44, v45
v_cvt_pk_bf16_f32 v55, v46, v47
s_add_u32 s96, s95, 1835008
buffer_store_dwordx2 v[54:55], v236, s[32:35], s96 offen sc1
C_join_15:
s_waitcnt vmcnt(0) lgkmcnt(0)
s_barrier
s_cmp_lg_u32 s52, 0
s_cbranch_scc1 W0_16
s_add_u32 s66, s53, 2
v_mov_b32 v2, s66
s_mov_b64 exec, 1
s_cmp_eq_u32 s71, 1
s_cbranch_scc1 SGf_17
buffer_wbl2 sc1
s_waitcnt vmcnt(0)
buffer_store_dword v2, off, s[32:35], s101 sc1
s_branch SGs_18
SGf_17:
buffer_store_dword v2, off, s[32:35], s101
SGs_18:
s_mov_b64 exec, -1
W0_16:
s_cmp_lg_u32 s31, 0
s_cbranch_scc1 LD_19
s_cmp_lg_u32 s52, 0
s_cbranch_scc1 W0_20
s_mov_b32 exec_lo, 0xffffffff
s_mov_b32 exec_hi, 0
v_lshlrev_b32 v3, 2, v1
s_mov_b32 s67, 0
PL_21:
buffer_load_dword v2, v3, s[32:35], s79 offen sc1
s_waitcnt vmcnt(0)
v_subrev_u32 v2, s66, v2
v_cmp_ge_u32 vcc, 5, v2
s_nop 0
s_cmp_eq_u32 vcc_lo, 0xffffffff
s_cbranch_scc1 PLd_22
s_add_u32 s67, s67, 1
s_cmp_lt_u32 s67, 65536
s_cbranch_scc1 PL_21
PLd_22:
s_mov_b64 exec, -1
s_lshl_b32 s67, s30, 2
s_add_u32 s67, s67, 20975616
v_mov_b32 v2, s66
s_mov_b64 exec, 1
buffer_store_dword v2, off, s[32:35], s67 sc1
s_mov_b64 exec, -1
W0_20:
s_barrier
LD_19:
s_add_u32 m0, s64, 90112
s_add_u32 s65, s63, 688128
buffer_load_dwordx4 v221, s[48:51], s65 offen lds
s_add_u32 m0, s64, 28672
s_add_u32 s65, s63, 802816
buffer_load_dwordx4 v220, s[44:47], s65 offen lds
s_add_u32 m0, s64, 94208
s_add_u32 s65, s63, 802816
buffer_load_dwordx4 v221, s[48:51], s65 offen lds
s_add_u32 m0, s64, 32768
s_add_u32 s65, s63, 917504
buffer_load_dwordx4 v220, s[44:47], s65 offen lds
s_add_u32 m0, s64, 98304
s_add_u32 s65, s63, 917504
buffer_load_dwordx4 v221, s[48:51], s65 offen lds
s_add_u32 m0, s64, 36864
s_add_u32 s65, s63, 1032192
buffer_load_dwordx4 v220, s[44:47], s65 offen lds
s_add_u32 m0, s64, 102400
s_add_u32 s65, s63, 1032192
buffer_load_dwordx4 v221, s[48:51], s65 offen lds
s_add_u32 m0, s64, 40960
s_add_u32 s65, s63, 1146880
buffer_load_dwordx4 v220, s[44:47], s65 offen lds
s_add_u32 m0, s64, 106496
s_add_u32 s65, s63, 1146880
buffer_load_dwordx4 v221, s[48:51], s65 offen lds
s_add_u32 m0, s64, 45056
s_add_u32 s65, s63, 1261568
buffer_load_dwordx4 v220, s[44:47], s65 offen lds
v_lshrrev_b32 v2, 4, v1
v_lshlrev_b32 v3, 2, v2
v_sub_u32 v3, v1, v3
v_and_b32 v3, 15, v3
v_lshlrev_b32 v3, 6, v3
v_lshl_add_u32 v23, v2, 10, v3
s_lshr_b32 s54, s31, 2
s_lshl_b32 s55, s30, 3
s_add_u32 s54, s54, s55
s_lshl_b32 s54, s54, 15
s_lshl_b32 s55, s52, 13
s_add_u32 s54, s54, s55
s_and_b32 s55, s31, 3
s_lshl_b32 s56, s55, 4
s_add_u32 s91, s54, s56
s_add_u32 s91, s91, 2097152
s_lshl_b32 s56, s55, 7
s_add_u32 s89, s54, s56
s_add_u32 s89, s89, 6291456
v_and_b32 v4, 7, v1
v_lshrrev_b32 v5, 3, v1
v_lshlrev_b32 v6, 4, v4
v_lshrrev_b32 v3, 2, v5
v_lshl_add_u32 v6, v3, 12, v6
v_and_b32 v3, 3, v5
v_lshl_add_u32 v6, v3, 8, v6
s_lshl_b32 s58, s56, 3
s_add_u32 s58, s54, s58
s_add_u32 s88, s58, 0
s_add_u32 s90, s58, 2097152
s_mov_b32 s92, 0xffff0000
v_lshrrev_b32 v2, 4, v1
v_bfe_u32 v3, v1, 1, 1
v_lshl_add_u32 v2, v2, 1, v3
v_bfe_u32 v3, v1, 2, 2
v_lshlrev_b32 v7, 8, v2
v_lshl_add_u32 v7, v3, 4, v7
v_and_b32 v3, 1, v1
v_lshl_add_u32 v7, v3, 3, v7
s_lshl_b32 s60, s52, 11
s_add_u32 s60, s60, 155648
v_add_u32 v7, s60, v7
v_lshlrev_b32 v3, 8, v2
v_sub_u32 v7, v7, v3
v_lshrrev_b32 v3, 2, v2
v_lshlrev_b32 v3, 2, v3
v_bfe_u32 v5, v2, 1, 1
v_add_u32 v3, v3, v5
v_lshl_add_u32 v7, v3, 8, v7
v_and_b32 v5, 1, v2
v_lshl_add_u32 v3, v5, 1, v3
v_add_u32 v5, 0, v3
v_and_b32 v5, 3, v5
v_lshl_add_u32 v16, v5, 6, v7
v_add_u32 v5, 1, v3
v_and_b32 v5, 3, v5
v_lshl_add_u32 v17, v5, 6, v7
v_add_u32 v5, 2, v3
v_and_b32 v5, 3, v5
v_lshl_add_u32 v18, v5, 6, v7
v_add_u32 v18, 512, v18
v_add_u32 v5, 3, v3
v_and_b32 v5, 3, v5
v_lshl_add_u32 v19, v5, 6, v7
v_add_u32 v19, 512, v19
v_lshrrev_b32 v5, 3, v1
v_bfe_u32 v3, v1, 4, 1
v_lshlrev_b32 v20, 5, v4
v_add_u32 v21, 131072, v20
v_lshl_add_u32 v20, v3, 4, v21
s_lshl_b32 s60, s52, 2
v_add_u32 v20, s60, v20
v_lshlrev_b32 v22, 4, v4
v_lshrrev_b32 v3, 2, v5
v_lshl_add_u32 v22, v3, 12, v22
v_and_b32 v3, 3, v5
v_lshl_add_u32 v22, v3, 9, v22
s_lshr_b32 s87, s31, 2
s_lshl_b32 s87, s87, 2
s_add_u32 s87, s87, s52
s_mul_i32 s87, s87, 57344
s_add_u32 s87, s87, 23068672
v_lshlrev_b32 v24, 16, v224
v_and_b32 v25, s92, v224
v_lshlrev_b32 v26, 16, v225
v_and_b32 v27, s92, v225
v_lshlrev_b32 v28, 16, v226
v_and_b32 v29, s92, v226
v_lshlrev_b32 v30, 16, v227
v_and_b32 v31, s92, v227
v_lshlrev_b32 v32, 16, v228
v_and_b32 v33, s92, v228
v_lshlrev_b32 v34, 16, v229
v_and_b32 v35, s92, v229
v_lshlrev_b32 v36, 16, v230
v_and_b32 v37, s92, v230
v_lshlrev_b32 v38, 16, v231
v_and_b32 v39, s92, v231
v_pk_add_f32 v[66:67], v[24:25], v[26:27]
v_pk_mul_f32 v[68:69], v[24:25], v[24:25]
v_pk_fma_f32 v[68:69], v[26:27], v[26:27], v[68:69]
v_pk_add_f32 v[66:67], v[66:67], v[28:29]
v_pk_fma_f32 v[68:69], v[28:29], v[28:29], v[68:69]
v_pk_add_f32 v[66:67], v[66:67], v[30:31]
v_pk_fma_f32 v[68:69], v[30:31], v[30:31], v[68:69]
v_pk_add_f32 v[66:67], v[66:67], v[32:33]
v_pk_fma_f32 v[68:69], v[32:33], v[32:33], v[68:69]
v_pk_add_f32 v[66:67], v[66:67], v[34:35]
v_pk_fma_f32 v[68:69], v[34:35], v[34:35], v[68:69]
v_pk_add_f32 v[66:67], v[66:67], v[36:37]
v_pk_fma_f32 v[68:69], v[36:37], v[36:37], v[68:69]
v_pk_add_f32 v[66:67], v[66:67], v[38:39]
v_pk_fma_f32 v[68:69], v[38:39], v[38:39], v[68:69]
v_add_f32 v66, v66, v67
v_add_f32 v68, v68, v69
s_nop 0
v_add_f32_dpp v66, v66, v66 row_ror:8 row_mask:0xf bank_mask:0xf
v_add_f32_dpp v68, v68, v68 row_ror:8 row_mask:0xf bank_mask:0xf
s_nop 1
v_permlane16_swap_b32 v66, v68
v_add_f32 v66, v66, v68
v_mov_b32 v68, v66
s_nop 1
v_permlane32_swap_b32 v66, v68
v_add_f32 v66, v66, v68
ds_write_b32 v20, v66 offset:0
s_waitcnt lgkmcnt(0)
s_barrier
ds_read_b128 v[66:69], v21 offset:0
ds_read_b128 v[70:73], v21 offset:16
s_waitcnt lgkmcnt(0)
v_pk_add_f32 v[66:67], v[66:67], v[68:69]
v_pk_add_f32 v[70:71], v[70:71], v[72:73]
v_add_f32 v66, v66, v67
v_add_f32 v70, v70, v71
v_mul_f32 v64, 0x3b000000, v66
v_mul_f32 v70, 0x3b000000, v70
v_fma_f32 v70, -v64, v64, v70
v_max_f32 v70, 0, v70
v_add_f32 v70, 0x3727c5ac, v70
v_rsq_f32 v65, v70
s_nop 0
v_mul_f32 v66, v64, v65
v_mov_b32 v64, v65
v_sub_f32 v66, 0, v66
v_mov_b32 v67, v66
v_pk_fma_f32 v[76:77], v[24:25], v[64:65], v[66:67]
v_pk_fma_f32 v[78:79], v[26:27], v[64:65], v[66:67]
v_pk_fma_f32 v[80:81], v[28:29], v[64:65], v[66:67]
v_pk_fma_f32 v[82:83], v[30:31], v[64:65], v[66:67]
v_pk_fma_f32 v[84:85], v[32:33], v[64:65], v[66:67]
v_pk_fma_f32 v[86:87], v[34:35], v[64:65], v[66:67]
v_pk_fma_f32 v[88:89], v[36:37], v[64:65], v[66:67]
v_pk_fma_f32 v[90:91], v[38:39], v[64:65], v[66:67]
s_cmp_lg_u32 s52, 0
s_cbranch_scc1 W0_23
s_mov_b32 s65, 20975616
s_mov_b32 exec_lo, 0xff
s_mov_b32 exec_hi, 0
v_lshlrev_b32 v3, 2, v1
s_mov_b32 s67, 0
PL_24:
buffer_load_dword v2, v3, s[32:35], s65 offen sc1
s_waitcnt vmcnt(0)
v_subrev_u32 v2, s66, v2
v_cmp_ge_u32 vcc, 5, v2
s_nop 0
s_cmp_eq_u32 vcc_lo, 0xff
s_cbranch_scc1 PLd_25
s_add_u32 s67, s67, 1
s_cmp_lt_u32 s67, 65536
s_cbranch_scc1 PL_24
PLd_25:
s_mov_b64 exec, -1
s_cmp_lg_u32 s2, 0
s_cbranch_scc1 EPx_26
s_mov_b32 s65, 20979712
v_mov_b32 v2, s53
s_mov_b64 exec, 1
buffer_store_dword v2, off, s[32:35], s65 sc1
s_mov_b64 exec, -1
EPx_26:
W0_23:
s_barrier
s_lshl_b32 s55, s52, 11
s_add_u32 m0, s55, 155648
s_add_u32 s56, s91, 4096
buffer_load_dwordx4 v23, s[32:35], s91 offen sc1 lds
s_add_u32 m0, m0, 1024
s_nop 0
buffer_load_dwordx4 v23, s[32:35], s56 offen sc1 lds
s_add_u32 m0, s64, 110592
s_add_u32 s65, s63, 1261568
buffer_load_dwordx4 v221, s[48:51], s65 offen lds
s_add_u32 m0, s64, 49152
s_add_u32 s65, s63, 1376256
buffer_load_dwordx4 v220, s[44:47], s65 offen lds
s_add_u32 m0, s64, 114688
s_add_u32 s65, s63, 1376256
buffer_load_dwordx4 v221, s[48:51], s65 offen lds
s_add_u32 m0, s64, 53248
s_add_u32 s65, s63, 1490944
buffer_load_dwordx4 v220, s[44:47], s65 offen lds
s_add_u32 m0, s64, 118784
s_add_u32 s65, s63, 1490944
buffer_load_dwordx4 v221, s[48:51], s65 offen lds
s_waitcnt vmcnt(5)
ds_read_b64_tr_b16 v[40:41], v16
ds_read_b64_tr_b16 v[42:43], v17
ds_read_b64_tr_b16 v[44:45], v18
ds_read_b64_tr_b16 v[46:47], v19
s_waitcnt lgkmcnt(0)
v_lshlrev_b32 v48, 16, v40
v_and_b32 v49, s92, v40
v_lshlrev_b32 v50, 16, v41
v_and_b32 v51, s92, v41
v_lshlrev_b32 v52, 16, v42
v_and_b32 v53, s92, v42
v_lshlrev_b32 v54, 16, v43
v_and_b32 v55, s92, v43
v_lshlrev_b32 v56, 16, v44
v_and_b32 v57, s92, v44
v_lshlrev_b32 v58, 16, v45
v_and_b32 v59, s92, v45
v_lshlrev_b32 v60, 16, v46
v_and_b32 v61, s92, v46
v_lshlrev_b32 v62, 16, v47
v_and_b32 v63, s92, v47
v_pk_fma_f32 v[24:25], v[76:77], v[48:49], v[24:25]
v_pk_fma_f32 v[26:27], v[78:79], v[50:51], v[26:27]
v_pk_fma_f32 v[28:29], v[80:81], v[52:53], v[28:29]
v_pk_fma_f32 v[30:31], v[82:83], v[54:55], v[30:31]
v_pk_fma_f32 v[32:33], v[84:85], v[56:57], v[32:33]
v_pk_fma_f32 v[34:35], v[86:87], v[58:59], v[34:35]
v_pk_fma_f32 v[36:37], v[88:89], v[60:61], v[36:37]
v_pk_fma_f32 v[38:39], v[90:91], v[62:63], v[38:39]
v_cvt_pk_bf16_f32 v96, v24, v25
v_cvt_pk_bf16_f32 v97, v26, v27
v_cvt_pk_bf16_f32 v98, v32, v33
v_cvt_pk_bf16_f32 v99, v34, v35
v_cvt_pk_bf16_f32 v100, v28, v29
v_cvt_pk_bf16_f32 v101, v30, v31
v_cvt_pk_bf16_f32 v102, v36, v37
v_cvt_pk_bf16_f32 v103, v38, v39
v_pk_add_f32 v[66:67], v[24:25], v[26:27]
v_pk_mul_f32 v[68:69], v[24:25], v[24:25]
v_pk_fma_f32 v[68:69], v[26:27], v[26:27], v[68:69]
v_pk_add_f32 v[66:67], v[66:67], v[28:29]
v_pk_fma_f32 v[68:69], v[28:29], v[28:29], v[68:69]
v_pk_add_f32 v[66:67], v[66:67], v[30:31]
v_pk_fma_f32 v[68:69], v[30:31], v[30:31], v[68:69]
v_pk_add_f32 v[66:67], v[66:67], v[32:33]
v_pk_fma_f32 v[68:69], v[32:33], v[32:33], v[68:69]
v_pk_add_f32 v[66:67], v[66:67], v[34:35]
v_pk_fma_f32 v[68:69], v[34:35], v[34:35], v[68:69]
v_pk_add_f32 v[66:67], v[66:67], v[36:37]
v_pk_fma_f32 v[68:69], v[36:37], v[36:37], v[68:69]
v_pk_add_f32 v[66:67], v[66:67], v[38:39]
v_pk_fma_f32 v[68:69], v[38:39], v[38:39], v[68:69]
v_add_f32 v66, v66, v67
v_add_f32 v68, v68, v69
s_nop 0
v_add_f32_dpp v66, v66, v66 row_ror:8 row_mask:0xf bank_mask:0xf
v_add_f32_dpp v68, v68, v68 row_ror:8 row_mask:0xf bank_mask:0xf
s_nop 1
v_permlane16_swap_b32 v66, v68
v_add_f32 v66, v66, v68
v_mov_b32 v68, v66
s_nop 1
v_permlane32_swap_b32 v66, v68
v_add_f32 v66, v66, v68
ds_write_b32 v20, v66 offset:256
s_waitcnt lgkmcnt(0)
s_barrier
ds_read_b128 v[66:69], v21 offset:256
ds_read_b128 v[70:73], v21 offset:272
s_waitcnt lgkmcnt(0)
v_pk_add_f32 v[66:67], v[66:67], v[68:69]
v_pk_add_f32 v[70:71], v[70:71], v[72:73]
v_add_f32 v66, v66, v67
v_add_f32 v70, v70, v71
v_mul_f32 v64, 0x3b000000, v66
v_mul_f32 v70, 0x3b000000, v70
v_fma_f32 v70, -v64, v64, v70
v_max_f32 v70, 0, v70
v_add_f32 v70, 0x3727c5ac, v70
v_rsq_f32 v65, v70
s_nop 0
v_mul_f32 v65, 0x3fb8aa3b, v65
v_mul_f32 v66, v64, v65
v_mov_b32 v64, v65
v_sub_f32 v66, 0, v66
v_mov_b32 v67, v66
v_pk_fma_f32 v[76:77], v[24:25], v[64:65], v[66:67]
v_pk_fma_f32 v[78:79], v[26:27], v[64:65], v[66:67]
v_pk_fma_f32 v[80:81], v[28:29], v[64:65], v[66:67]
v_pk_fma_f32 v[82:83], v[30:31], v[64:65], v[66:67]
v_pk_fma_f32 v[84:85], v[32:33], v[64:65], v[66:67]
v_pk_fma_f32 v[86:87], v[34:35], v[64:65], v[66:67]
v_pk_fma_f32 v[88:89], v[36:37], v[64:65], v[66:67]
v_pk_fma_f32 v[90:91], v[38:39], v[64:65], v[66:67]
v_cvt_pk_bf16_f32 v40, v76, v77
v_cvt_pk_bf16_f32 v41, v78, v79
v_cvt_pk_bf16_f32 v42, v80, v81
v_cvt_pk_bf16_f32 v43, v82, v83
v_cvt_pk_bf16_f32 v44, v84, v85
v_cvt_pk_bf16_f32 v45, v86, v87
v_cvt_pk_bf16_f32 v46, v88, v89
v_cvt_pk_bf16_f32 v47, v90, v91
buffer_store_dwordx4 v[40:43], v22, s[32:35], s89 offen
buffer_store_dwordx4 v[44:47], v22, s[32:35], s89 offen offset:2048
s_and_b32 s54, s31, 3
s_lshl_b32 s54, s54, 0
s_lshl_b32 s55, s30, 3
s_add_u32 s54, s54, s55
s_lshl_b32 s54, s54, 15
s_lshr_b32 s55, s31, 2
s_lshl_b32 s55, s55, 12
s_add_u32 s54, s54, s55
s_lshl_b32 s55, s52, 10
s_add_u32 s54, s54, s55
s_add_u32 m0, s55, 135168
s_add_u32 s54, s54, 2097152
s_add_u32 s55, s54, 131072
buffer_load_dwordx4 v8, s[32:35], s54 offen sc1 lds
s_add_u32 m0, m0, 4096
s_nop 0
buffer_load_dwordx4 v8, s[32:35], s55 offen sc1 lds
s_add_u32 m0, s64, 57344
s_add_u32 s65, s63, 1605632
buffer_load_dwordx4 v220, s[44:47], s65 offen lds
s_add_u32 m0, s64, 122880
s_add_u32 s65, s63, 1605632
buffer_load_dwordx4 v221, s[48:51], s65 offen lds
s_add_u32 m0, s64, 61440
s_add_u32 s65, s63, 1720320
buffer_load_dwordx4 v220, s[44:47], s65 offen lds
s_add_u32 m0, s64, 126976
s_add_u32 s65, s63, 1720320
buffer_load_dwordx4 v221, s[48:51], s65 offen lds
v_mov_b32 v14, v6
s_and_b32 s70, s31, 1
v_lshrrev_b32 v3, 4, v1
v_bfe_u32 v2, v1, 2, 2
v_lshl_add_u32 v3, v3, 3, v2
v_lshlrev_b32 v3, 7, v3
v_and_b32 v2, 1, v1
v_lshl_add_u32 v3, v2, 4, v3
v_bfe_u32 v2, v1, 1, 1
v_lshl_add_u32 v3, v2, 3, v3
v_bfe_u32 v2, v1, 4, 1
v_bfe_u32 v13, v1, 3, 1
v_lshl_add_u32 v2, v13, 1, v2
v_xor_b32 v13, 0, v2
v_lshl_add_u32 v4, v13, 5, v3
v_add_u32 v9, 0x10000, v4
v_xor_b32 v13, 1, v2
v_lshl_add_u32 v5, v13, 5, v3
v_add_u32 v10, 0x10000, v5
v_xor_b32 v13, 2, v2
v_lshl_add_u32 v6, v13, 5, v3
v_add_u32 v11, 0x10000, v6
v_xor_b32 v13, 3, v2
v_lshl_add_u32 v7, v13, 5, v3
v_add_u32 v12, 0x10000, v7
v_lshrrev_b32 v2, 5, v1
v_lshlrev_b32 v2, 10, v2
v_bfe_u32 v3, v1, 4, 1
v_lshl_add_u32 v2, v3, 9, v2
v_and_b32 v3, 15, v1
v_lshl_add_u32 v13, v3, 4, v2
s_lshl_b32 s54, s30, 3
s_add_u32 s54, s54, s52
s_lshl_b32 s80, s54, 15
s_add_u32 s80, s80, 6291456
s_add_u32 s81, s80, 131072
s_lshr_b32 s58, s31, 1
s_mul_i32 s58, s58, 7
s_mul_i32 s59, s70, 3
s_add_u32 s58, s58, s59
s_mul_i32 s56, s54, 114688
s_add_u32 s56, s56, 8388608
s_xor_b32 s60, s59, 0
s_add_u32 s60, s60, s58
s_lshl_b32 s60, s60, 10
s_add_u32 s61, s60, s56
s_xor_b32 s60, s59, 1
s_add_u32 s60, s60, s58
s_lshl_b32 s60, s60, 10
s_add_u32 s62, s60, s56
s_xor_b32 s60, s59, 2
s_add_u32 s60, s60, s58
s_lshl_b32 s60, s60, 10
s_add_u32 s63, s60, s56
s_xor_b32 s60, s59, 3
s_add_u32 s60, s60, s58
s_lshl_b32 s60, s60, 10
s_add_u32 s64, s60, s56
s_mov_b32 s72, s61
s_mov_b32 s73, s62
s_mov_b32 s74, s63
s_add_u32 s60, s61, 458752
s_cmp_eq_u32 s70, 1
s_cselect_b32 s75, s60, s64
s_cselect_b32 s76, s62, s61
s_cselect_b32 s77, s63, s62
s_cselect_b32 s78, s64, s63
s_add_u32 s76, s76, 458752
s_add_u32 s77, s77, 458752
s_add_u32 s78, s78, 458752
s_and_b32 s54, s31, 3
s_lshl_b32 s55, s30, 3
s_lshl_b32 s56, s54, 0
s_add_u32 s55, s55, s56
s_mul_i32 s56, s55, 114688
s_mul_i32 s57, s52, 28672
s_add_u32 s56, s56, s57
s_add_u32 s82, s56, 8388608
s_lshl_b32 s95, s55, 8
s_lshl_b32 s56, s52, 6
s_add_u32 s95, s95, s56
s_add_u32 s95, s95, 21004288
s_lshl_b32 s55, s55, 15
s_lshr_b32 s56, s31, 2
s_lshl_b32 s57, s56, 12
s_add_u32 s98, s55, s57
s_lshl_b32 s57, s52, 10
s_add_u32 s98, s98, s57
s_lshl_b32 s57, s56, 7
s_add_u32 s83, s55, s57
s_lshl_b32 s57, s52, 13
s_add_u32 s83, s83, s57
s_lshl_b32 s93, s30, 2
s_and_b32 s54, s31, 3
s_add_u32 s93, s93, s54
s_lshl_b32 s93, s93, 2
s_add_u32 s93, s93, s52
s_lshl_b32 s93, s93, 12
s_add_u32 s93, s93, 21037056
s_add_u32 s94, s53, 5
s_lshl_b32 s99, s30, 10
s_lshl_b32 s54, s52, 7
s_add_u32 s99, s99, s54
s_lshl_b32 s54, s31, 2
s_add_u32 s99, s99, s54
s_add_u32 s99, s99, 21020672
s_lshl_b32 s54, s30, 10
s_add_u32 s54, s54, 21020672
s_and_b32 s55, s31, 3
s_lshl_b32 s56, s55, 7
s_add_u32 s56, s56, s54
s_lshl_b32 s57, s52, 5
s_add_u32 s56, s56, s57
s_lshl_b32 s55, s55, 4
s_add_u32 s55, s55, s54
v_and_b32 v2, 7, v1
v_lshl_add_u32 v2, v2, 2, s56
v_add_u32 v3, 512, v2
v_accvgpr_write_b32 a245, v3
v_bfe_u32 v3, v1, 3, 2
v_lshlrev_b32 v3, 7, v3
v_and_b32 v15, 3, v1
v_lshl_add_u32 v3, v15, 2, v3
v_bfe_u32 v15, v1, 2, 1
v_lshl_add_u32 v3, v15, 6, v3
v_add_u32 v3, s55, v3
v_cmp_gt_u32 vcc, 32, v1
s_nop 1
v_cndmask_b32 v2, v3, v2, vcc
v_accvgpr_write_b32 a244, v2
s_lshl_b32 s54, s30, 10
s_lshl_b32 s55, s52, 2
s_add_u32 s54, s54, s55
s_add_u32 s54, s54, 21028864
v_bfe_u32 v2, v1, 3, 2
v_lshlrev_b32 v2, 7, v2
v_and_b32 v3, 7, v1
v_lshl_add_u32 v2, v3, 4, v2
v_add_u32 v2, s54, v2
v_add_u32 v3, 512, v2
v_accvgpr_write_b32 a246, v2
v_accvgpr_write_b32 a247, v3
s_waitcnt vmcnt(4) lgkmcnt(0)
s_barrier
s_cmp_lg_u32 s52, 0
s_cbranch_scc1 W0_27
s_add_u32 s66, s53, 3
v_mov_b32 v2, s66
s_mov_b64 exec, 1
s_cmp_eq_u32 s71, 1
s_cbranch_scc1 SGf_28
buffer_wbl2 sc1
s_waitcnt vmcnt(0)
buffer_store_dword v2, off, s[32:35], s101 sc1
s_branch SGs_29
SGf_28:
buffer_store_dword v2, off, s[32:35], s101
SGs_29:
s_mov_b64 exec, -1
W0_27:
v_pk_add_f32 v[66:67], v[48:49], v[50:51]
v_pk_mul_f32 v[68:69], v[48:49], v[48:49]
v_pk_fma_f32 v[68:69], v[50:51], v[50:51], v[68:69]
v_pk_add_f32 v[66:67], v[66:67], v[52:53]
v_pk_fma_f32 v[68:69], v[52:53], v[52:53], v[68:69]
v_pk_add_f32 v[66:67], v[66:67], v[54:55]
v_pk_fma_f32 v[68:69], v[54:55], v[54:55], v[68:69]
v_pk_add_f32 v[66:67], v[66:67], v[56:57]
v_pk_fma_f32 v[68:69], v[56:57], v[56:57], v[68:69]
v_pk_add_f32 v[66:67], v[66:67], v[58:59]
v_pk_fma_f32 v[68:69], v[58:59], v[58:59], v[68:69]
v_pk_add_f32 v[66:67], v[66:67], v[60:61]
v_pk_fma_f32 v[68:69], v[60:61], v[60:61], v[68:69]
v_pk_add_f32 v[66:67], v[66:67], v[62:63]
v_pk_fma_f32 v[68:69], v[62:63], v[62:63], v[68:69]
v_add_f32 v66, v66, v67
v_add_f32 v68, v68, v69
s_nop 0
v_add_f32_dpp v66, v66, v66 row_ror:8 row_mask:0xf bank_mask:0xf
v_add_f32_dpp v68, v68, v68 row_ror:8 row_mask:0xf bank_mask:0xf
s_nop 1
v_permlane16_swap_b32 v66, v68
v_add_f32 v66, v66, v68
v_mov_b32 v68, v66
s_nop 1
v_permlane32_swap_b32 v66, v68
v_add_f32 v66, v66, v68
ds_write_b32 v20, v66 offset:512
s_waitcnt lgkmcnt(0)
s_barrier
ds_read_b128 v[66:69], v21 offset:512
ds_read_b128 v[70:73], v21 offset:528
s_waitcnt lgkmcnt(0)
v_pk_add_f32 v[66:67], v[66:67], v[68:69]
v_pk_add_f32 v[70:71], v[70:71], v[72:73]
v_add_f32 v66, v66, v67
v_add_f32 v67, v70, v71
v_accvgpr_write_b32 a240, v66
v_accvgpr_write_b32 a241, v67
s_waitcnt vmcnt(0)
s_cmp_lg_u32 s52, 0
s_cbranch_scc1 W0_30
s_mov_b32 exec_lo, 0xffffffff
s_mov_b32 exec_hi, 0
v_lshlrev_b32 v3, 2, v1
s_mov_b32 s67, 0
PL_31:
buffer_load_dword v2, v3, s[32:35], s79 offen sc1
s_waitcnt vmcnt(0)
v_subrev_u32 v2, s66, v2
v_cmp_ge_u32 vcc, 4, v2
s_nop 0
s_cmp_eq_u32 vcc_lo, 0xffffffff
s_cbranch_scc1 PLd_32
s_add_u32 s67, s67, 1
s_cmp_lt_u32 s67, 65536
s_cbranch_scc1 PL_31
PLd_32:
s_mov_b64 exec, -1
W0_30:
s_barrier
s_cmp_eq_u32 s70, 1
s_cbranch_scc1 G1o_33
s_mov_b32 s54, s80
buffer_load_dwordx4 v[128:131], v13, s[32:35], s54 offen offset:0 sc1
buffer_load_dwordx4 v[132:135], v13, s[32:35], s54 offen offset:256 sc1
buffer_load_dwordx4 v[136:139], v13, s[32:35], s54 offen offset:2048 sc1
buffer_load_dwordx4 v[140:143], v13, s[32:35], s54 offen offset:2304 sc1
s_add_u32 s54, s54, 4096
buffer_load_dwordx4 v[144:147], v13, s[32:35], s54 offen offset:0 sc1
buffer_load_dwordx4 v[148:151], v13, s[32:35], s54 offen offset:256 sc1
buffer_load_dwordx4 v[152:155], v13, s[32:35], s54 offen offset:2048 sc1
buffer_load_dwordx4 v[156:159], v13, s[32:35], s54 offen offset:2304 sc1
ds_read_b64_tr_b16 v[16:17], v4 offset:0
ds_read_b64_tr_b16 v[18:19], v4 offset:512
ds_read_b64_tr_b16 v[20:21], v9 offset:0
ds_read_b64_tr_b16 v[22:23], v9 offset:512
ds_read_b64_tr_b16 v[24:25], v5 offset:0
ds_read_b64_tr_b16 v[26:27], v5 offset:512
ds_read_b64_tr_b16 v[28:29], v10 offset:0
ds_read_b64_tr_b16 v[30:31], v10 offset:512
ds_read_b64_tr_b16 v[32:33], v6 offset:0
ds_read_b64_tr_b16 v[34:35], v6 offset:512
ds_read_b64_tr_b16 v[36:37], v11 offset:0
ds_read_b64_tr_b16 v[38:39], v11 offset:512
ds_read_b64_tr_b16 v[40:41], v4 offset:4096
ds_read_b64_tr_b16 v[42:43], v4 offset:4608
s_waitcnt vmcnt(6) lgkmcnt(6)
v_mfma_f32_16x16x32_bf16 v[48:51], v[16:19], v[128:131], 0
ds_read_b64_tr_b16 v[44:45], v9 offset:4096
ds_read_b64_tr_b16 v[46:47], v9 offset:4608
v_mfma_f32_16x16x32_bf16 v[52:55], v[16:19], v[132:135], 0
s_add_u32 s54, s54, 4096
buffer_load_dwordx4 v[160:163], v13, s[32:35], s54 offen offset:0 sc1
v_mfma_f32_16x16x32_bf16 v[56:59], v[20:23], v[128:131], 0
ds_read_b64_tr_b16 v[16:17], v5 offset:4096
ds_read_b64_tr_b16 v[18:19], v5 offset:4608
v_mfma_f32_16x16x32_bf16 v[60:63], v[20:23], v[132:135], 0
v_mfma_f32_16x16x32_bf16 v[64:67], v[24:27], v[128:131], 0
ds_read_b64_tr_b16 v[20:21], v10 offset:4096
ds_read_b64_tr_b16 v[22:23], v10 offset:4608
v_mfma_f32_16x16x32_bf16 v[68:71], v[24:27], v[132:135], 0
buffer_load_dwordx4 v[164:167], v13, s[32:35], s54 offen offset:256 sc1
v_mfma_f32_16x16x32_bf16 v[72:75], v[28:31], v[128:131], 0
ds_read_b64_tr_b16 v[24:25], v6 offset:4096
ds_read_b64_tr_b16 v[26:27], v6 offset:4608
v_mfma_f32_16x16x32_bf16 v[76:79], v[28:31], v[132:135], 0
s_waitcnt lgkmcnt(6)
v_mfma_f32_16x16x32_bf16 v[80:83], v[32:35], v[128:131], 0
ds_read_b64_tr_b16 v[28:29], v11 offset:4096
ds_read_b64_tr_b16 v[30:31], v11 offset:4608
v_mfma_f32_16x16x32_bf16 v[84:87], v[32:35], v[132:135], 0
buffer_load_dwordx4 v[168:171], v13, s[32:35], s54 offen offset:2048 sc1
v_mfma_f32_16x16x32_bf16 v[88:91], v[36:39], v[128:131], 0
ds_read_b64_tr_b16 v[32:33], v4 offset:8192
ds_read_b64_tr_b16 v[34:35], v4 offset:8704
v_mfma_f32_16x16x32_bf16 v[92:95], v[36:39], v[132:135], 0
s_waitcnt vmcnt(7)
v_mfma_f32_16x16x32_bf16 v[48:51], v[40:43], v[136:139], v[48:51]
ds_read_b64_tr_b16 v[36:37], v9 offset:8192
ds_read_b64_tr_b16 v[38:39], v9 offset:8704
v_mfma_f32_16x16x32_bf16 v[52:55], v[40:43], v[140:143], v[52:55]
buffer_load_dwordx4 v[172:175], v13, s[32:35], s54 offen offset:2304 sc1
v_mfma_f32_16x16x32_bf16 v[56:59], v[44:47], v[136:139], v[56:59]
ds_read_b64_tr_b16 v[40:41], v5 offset:8192
ds_read_b64_tr_b16 v[42:43], v5 offset:8704
v_mfma_f32_16x16x32_bf16 v[60:63], v[44:47], v[140:143], v[60:63]
s_waitcnt lgkmcnt(6)
v_mfma_f32_16x16x32_bf16 v[64:67], v[16:19], v[136:139], v[64:67]
ds_read_b64_tr_b16 v[44:45], v10 offset:8192
ds_read_b64_tr_b16 v[46:47], v10 offset:8704
v_mfma_f32_16x16x32_bf16 v[68:71], v[16:19], v[140:143], v[68:71]
s_add_u32 s54, s54, 4096
buffer_load_dwordx4 v[176:179], v13, s[32:35], s54 offen offset:0 sc1
v_mfma_f32_16x16x32_bf16 v[72:75], v[20:23], v[136:139], v[72:75]
ds_read_b64_tr_b16 v[16:17], v6 offset:8192
ds_read_b64_tr_b16 v[18:19], v6 offset:8704
v_mfma_f32_16x16x32_bf16 v[76:79], v[20:23], v[140:143], v[76:79]
v_mfma_f32_16x16x32_bf16 v[80:83], v[24:27], v[136:139], v[80:83]
ds_read_b64_tr_b16 v[20:21], v11 offset:8192
ds_read_b64_tr_b16 v[22:23], v11 offset:8704
v_mfma_f32_16x16x32_bf16 v[84:87], v[24:27], v[140:143], v[84:87]
buffer_load_dwordx4 v[180:183], v13, s[32:35], s54 offen offset:256 sc1
v_mfma_f32_16x16x32_bf16 v[88:91], v[28:31], v[136:139], v[88:91]
ds_read_b64_tr_b16 v[24:25], v4 offset:12288
ds_read_b64_tr_b16 v[26:27], v4 offset:12800
v_mfma_f32_16x16x32_bf16 v[92:95], v[28:31], v[140:143], v[92:95]
s_waitcnt vmcnt(8) lgkmcnt(6)
v_mfma_f32_16x16x32_bf16 v[48:51], v[32:35], v[144:147], v[48:51]
ds_read_b64_tr_b16 v[28:29], v9 offset:12288
ds_read_b64_tr_b16 v[30:31], v9 offset:12800
v_mfma_f32_16x16x32_bf16 v[52:55], v[32:35], v[148:151], v[52:55]
buffer_load_dwordx4 v[184:187], v13, s[32:35], s54 offen offset:2048 sc1
v_mfma_f32_16x16x32_bf16 v[56:59], v[36:39], v[144:147], v[56:59]
ds_read_b64_tr_b16 v[32:33], v5 offset:12288
ds_read_b64_tr_b16 v[34:35], v5 offset:12800
v_mfma_f32_16x16x32_bf16 v[60:63], v[36:39], v[148:151], v[60:63]
v_mfma_f32_16x16x32_bf16 v[64:67], v[40:43], v[144:147], v[64:67]
ds_read_b64_tr_b16 v[36:37], v10 offset:12288
ds_read_b64_tr_b16 v[38:39], v10 offset:12800
v_mfma_f32_16x16x32_bf16 v[68:71], v[40:43], v[148:151], v[68:71]
buffer_load_dwordx4 v[188:191], v13, s[32:35], s54 offen offset:2304 sc1
v_mfma_f32_16x16x32_bf16 v[72:75], v[44:47], v[144:147], v[72:75]
ds_read_b64_tr_b16 v[40:41], v6 offset:12288
ds_read_b64_tr_b16 v[42:43], v6 offset:12800
v_mfma_f32_16x16x32_bf16 v[76:79], v[44:47], v[148:151], v[76:79]
s_waitcnt lgkmcnt(6)
v_mfma_f32_16x16x32_bf16 v[80:83], v[16:19], v[144:147], v[80:83]
ds_read_b64_tr_b16 v[44:45], v11 offset:12288
ds_read_b64_tr_b16 v[46:47], v11 offset:12800
v_mfma_f32_16x16x32_bf16 v[84:87], v[16:19], v[148:151], v[84:87]
s_add_u32 s54, s54, 4096
buffer_load_dwordx4 v[192:195], v13, s[32:35], s54 offen offset:0 sc1
v_mfma_f32_16x16x32_bf16 v[88:91], v[20:23], v[144:147], v[88:91]
ds_read_b64_tr_b16 v[16:17], v4 offset:16384
ds_read_b64_tr_b16 v[18:19], v4 offset:16896
v_mfma_f32_16x16x32_bf16 v[92:95], v[20:23], v[148:151], v[92:95]
s_waitcnt vmcnt(9)
v_mfma_f32_16x16x32_bf16 v[48:51], v[24:27], v[152:155], v[48:51]
ds_read_b64_tr_b16 v[20:21], v9 offset:16384
ds_read_b64_tr_b16 v[22:23], v9 offset:16896
v_mfma_f32_16x16x32_bf16 v[52:55], v[24:27], v[156:159], v[52:55]
buffer_load_dwordx4 v[196:199], v13, s[32:35], s54 offen offset:256 sc1
v_mfma_f32_16x16x32_bf16 v[56:59], v[28:31], v[152:155], v[56:59]
ds_read_b64_tr_b16 v[24:25], v5 offset:16384
ds_read_b64_tr_b16 v[26:27], v5 offset:16896
v_mfma_f32_16x16x32_bf16 v[60:63], v[28:31], v[156:159], v[60:63]
s_waitcnt lgkmcnt(6)
v_mfma_f32_16x16x32_bf16 v[64:67], v[32:35], v[152:155], v[64:67]
ds_read_b64_tr_b16 v[28:29], v10 offset:16384
ds_read_b64_tr_b16 v[30:31], v10 offset:16896
v_mfma_f32_16x16x32_bf16 v[68:71], v[32:35], v[156:159], v[68:71]
buffer_load_dwordx4 v[200:203], v13, s[32:35], s54 offen offset:2048 sc1
v_mfma_f32_16x16x32_bf16 v[72:75], v[36:39], v[152:155], v[72:75]
ds_read_b64_tr_b16 v[32:33], v6 offset:16384
ds_read_b64_tr_b16 v[34:35], v6 offset:16896
v_mfma_f32_16x16x32_bf16 v[76:79], v[36:39], v[156:159], v[76:79]
v_mfma_f32_16x16x32_bf16 v[80:83], v[40:43], v[152:155], v[80:83]
ds_read_b64_tr_b16 v[36:37], v11 offset:16384
ds_read_b64_tr_b16 v[38:39], v11 offset:16896
v_mfma_f32_16x16x32_bf16 v[84:87], v[40:43], v[156:159], v[84:87]
buffer_load_dwordx4 v[204:207], v13, s[32:35], s54 offen offset:2304 sc1
v_mfma_f32_16x16x32_bf16 v[88:91], v[44:47], v[152:155], v[88:91]
ds_read_b64_tr_b16 v[40:41], v4 offset:20480
ds_read_b64_tr_b16 v[42:43], v4 offset:20992
v_mfma_f32_16x16x32_bf16 v[92:95], v[44:47], v[156:159], v[92:95]
s_waitcnt vmcnt(10) lgkmcnt(6)
v_mfma_f32_16x16x32_bf16 v[48:51], v[16:19], v[160:163], v[48:51]
ds_read_b64_tr_b16 v[44:45], v9 offset:20480
ds_read_b64_tr_b16 v[46:47], v9 offset:20992
v_mfma_f32_16x16x32_bf16 v[52:55], v[16:19], v[164:167], v[52:55]
s_add_u32 s54, s54, 4096
buffer_load_dwordx4 v[208:211], v13, s[32:35], s54 offen offset:0 sc1
v_mfma_f32_16x16x32_bf16 v[56:59], v[20:23], v[160:163], v[56:59]
ds_read_b64_tr_b16 v[16:17], v5 offset:20480
ds_read_b64_tr_b16 v[18:19], v5 offset:20992
v_mfma_f32_16x16x32_bf16 v[60:63], v[20:23], v[164:167], v[60:63]
v_mfma_f32_16x16x32_bf16 v[64:67], v[24:27], v[160:163], v[64:67]
ds_read_b64_tr_b16 v[20:21], v10 offset:20480
ds_read_b64_tr_b16 v[22:23], v10 offset:20992
v_mfma_f32_16x16x32_bf16 v[68:71], v[24:27], v[164:167], v[68:71]
buffer_load_dwordx4 v[212:215], v13, s[32:35], s54 offen offset:256 sc1
v_mfma_f32_16x16x32_bf16 v[72:75], v[28:31], v[160:163], v[72:75]
ds_read_b64_tr_b16 v[24:25], v6 offset:20480
ds_read_b64_tr_b16 v[26:27], v6 offset:20992
v_mfma_f32_16x16x32_bf16 v[76:79], v[28:31], v[164:167], v[76:79]
s_waitcnt lgkmcnt(6)
v_mfma_f32_16x16x32_bf16 v[80:83], v[32:35], v[160:163], v[80:83]
ds_read_b64_tr_b16 v[28:29], v11 offset:20480
ds_read_b64_tr_b16 v[30:31], v11 offset:20992
v_mfma_f32_16x16x32_bf16 v[84:87], v[32:35], v[164:167], v[84:87]
buffer_load_dwordx4 v[216:219], v13, s[32:35], s54 offen offset:2048 sc1
v_mfma_f32_16x16x32_bf16 v[88:91], v[36:39], v[160:163], v[88:91]
ds_read_b64_tr_b16 v[32:33], v4 offset:24576
ds_read_b64_tr_b16 v[34:35], v4 offset:25088
v_mfma_f32_16x16x32_bf16 v[92:95], v[36:39], v[164:167], v[92:95]
s_waitcnt vmcnt(11)
v_mfma_f32_16x16x32_bf16 v[48:51], v[40:43], v[168:171], v[48:51]
ds_read_b64_tr_b16 v[36:37], v9 offset:24576
ds_read_b64_tr_b16 v[38:39], v9 offset:25088
v_mfma_f32_16x16x32_bf16 v[52:55], v[40:43], v[172:175], v[52:55]
buffer_load_dwordx4 v[220:223], v13, s[32:35], s54 offen offset:2304 sc1
v_mfma_f32_16x16x32_bf16 v[56:59], v[44:47], v[168:171], v[56:59]
ds_read_b64_tr_b16 v[40:41], v5 offset:24576
ds_read_b64_tr_b16 v[42:43], v5 offset:25088
v_mfma_f32_16x16x32_bf16 v[60:63], v[44:47], v[172:175], v[60:63]
s_waitcnt lgkmcnt(6)
v_mfma_f32_16x16x32_bf16 v[64:67], v[16:19], v[168:171], v[64:67]
ds_read_b64_tr_b16 v[44:45], v10 offset:24576
ds_read_b64_tr_b16 v[46:47], v10 offset:25088
v_mfma_f32_16x16x32_bf16 v[68:71], v[16:19], v[172:175], v[68:71]
s_add_u32 s54, s54, 4096
buffer_load_dwordx4 v[224:227], v13, s[32:35], s54 offen offset:0 sc1
v_mfma_f32_16x16x32_bf16 v[72:75], v[20:23], v[168:171], v[72:75]
ds_read_b64_tr_b16 v[16:17], v6 offset:24576
ds_read_b64_tr_b16 v[18:19], v6 offset:25088
v_mfma_f32_16x16x32_bf16 v[76:79], v[20:23], v[172:175], v[76:79]
v_mfma_f32_16x16x32_bf16 v[80:83], v[24:27], v[168:171], v[80:83]
ds_read_b64_tr_b16 v[20:21], v11 offset:24576
ds_read_b64_tr_b16 v[22:23], v11 offset:25088
v_mfma_f32_16x16x32_bf16 v[84:87], v[24:27], v[172:175], v[84:87]
buffer_load_dwordx4 v[228:231], v13, s[32:35], s54 offen offset:256 sc1
v_mfma_f32_16x16x32_bf16 v[88:91], v[28:31], v[168:171], v[88:91]
ds_read_b64_tr_b16 v[24:25], v4 offset:28672
ds_read_b64_tr_b16 v[26:27], v4 offset:29184
v_mfma_f32_16x16x32_bf16 v[92:95], v[28:31], v[172:175], v[92:95]
s_waitcnt vmcnt(12) lgkmcnt(6)
v_mfma_f32_16x16x32_bf16 v[48:51], v[32:35], v[176:179], v[48:51]
ds_read_b64_tr_b16 v[28:29], v9 offset:28672
ds_read_b64_tr_b16 v[30:31], v9 offset:29184
v_mfma_f32_16x16x32_bf16 v[52:55], v[32:35], v[180:183], v[52:55]
buffer_load_dwordx4 v[232:235], v13, s[32:35], s54 offen offset:2048 sc1
v_mfma_f32_16x16x32_bf16 v[56:59], v[36:39], v[176:179], v[56:59]
ds_read_b64_tr_b16 v[32:33], v5 offset:28672
ds_read_b64_tr_b16 v[34:35], v5 offset:29184
v_mfma_f32_16x16x32_bf16 v[60:63], v[36:39], v[180:183], v[60:63]
v_mfma_f32_16x16x32_bf16 v[64:67], v[40:43], v[176:179], v[64:67]
ds_read_b64_tr_b16 v[36:37], v10 offset:28672
ds_read_b64_tr_b16 v[38:39], v10 offset:29184
v_mfma_f32_16x16x32_bf16 v[68:71], v[40:43], v[180:183], v[68:71]
buffer_load_dwordx4 v[236:239], v13, s[32:35], s54 offen offset:2304 sc1
v_mfma_f32_16x16x32_bf16 v[72:75], v[44:47], v[176:179], v[72:75]
ds_read_b64_tr_b16 v[40:41], v6 offset:28672
ds_read_b64_tr_b16 v[42:43], v6 offset:29184
v_mfma_f32_16x16x32_bf16 v[76:79], v[44:47], v[180:183], v[76:79]
s_waitcnt lgkmcnt(6)
v_mfma_f32_16x16x32_bf16 v[80:83], v[16:19], v[176:179], v[80:83]
ds_read_b64_tr_b16 v[44:45], v11 offset:28672
ds_read_b64_tr_b16 v[46:47], v11 offset:29184
v_mfma_f32_16x16x32_bf16 v[84:87], v[16:19], v[180:183], v[84:87]
s_add_u32 s54, s54, 4096
buffer_load_dwordx4 v[240:243], v13, s[32:35], s54 offen offset:0 sc1
v_mfma_f32_16x16x32_bf16 v[88:91], v[20:23], v[176:179], v[88:91]
ds_read_b64_tr_b16 v[16:17], v4 offset:32768
ds_read_b64_tr_b16 v[18:19], v4 offset:33280
v_mfma_f32_16x16x32_bf16 v[92:95], v[20:23], v[180:183], v[92:95]
s_waitcnt vmcnt(13)
v_mfma_f32_16x16x32_bf16 v[48:51], v[24:27], v[184:187], v[48:51]
ds_read_b64_tr_b16 v[20:21], v9 offset:32768
ds_read_b64_tr_b16 v[22:23], v9 offset:33280
v_mfma_f32_16x16x32_bf16 v[52:55], v[24:27], v[188:191], v[52:55]
buffer_load_dwordx4 v[244:247], v13, s[32:35], s54 offen offset:256 sc1
v_mfma_f32_16x16x32_bf16 v[56:59], v[28:31], v[184:187], v[56:59]
ds_read_b64_tr_b16 v[24:25], v5 offset:32768
ds_read_b64_tr_b16 v[26:27], v5 offset:33280
v_mfma_f32_16x16x32_bf16 v[60:63], v[28:31], v[188:191], v[60:63]
s_waitcnt lgkmcnt(6)
v_mfma_f32_16x16x32_bf16 v[64:67], v[32:35], v[184:187], v[64:67]
ds_read_b64_tr_b16 v[28:29], v10 offset:32768
ds_read_b64_tr_b16 v[30:31], v10 offset:33280
v_mfma_f32_16x16x32_bf16 v[68:71], v[32:35], v[188:191], v[68:71]
buffer_load_dwordx4 v[248:251], v13, s[32:35], s54 offen offset:2048 sc1
v_mfma_f32_16x16x32_bf16 v[72:75], v[36:39], v[184:187], v[72:75]
ds_read_b64_tr_b16 v[32:33], v6 offset:32768
ds_read_b64_tr_b16 v[34:35], v6 offset:33280
v_mfma_f32_16x16x32_bf16 v[76:79], v[36:39], v[188:191], v[76:79]
v_mfma_f32_16x16x32_bf16 v[80:83], v[40:43], v[184:187], v[80:83]
ds_read_b64_tr_b16 v[36:37], v11 offset:32768
ds_read_b64_tr_b16 v[38:39], v11 offset:33280
v_mfma_f32_16x16x32_bf16 v[84:87], v[40:43], v[188:191], v[84:87]
buffer_load_dwordx4 v[252:255], v13, s[32:35], s54 offen offset:2304 sc1
v_mfma_f32_16x16x32_bf16 v[88:91], v[44:47], v[184:187], v[88:91]
ds_read_b64_tr_b16 v[40:41], v4 offset:36864
ds_read_b64_tr_b16 v[42:43], v4 offset:37376
v_mfma_f32_16x16x32_bf16 v[92:95], v[44:47], v[188:191], v[92:95]
s_waitcnt vmcnt(14) lgkmcnt(6)
v_mfma_f32_16x16x32_bf16 v[48:51], v[16:19], v[192:195], v[48:51]
ds_read_b64_tr_b16 v[44:45], v9 offset:36864
ds_read_b64_tr_b16 v[46:47], v9 offset:37376
v_mfma_f32_16x16x32_bf16 v[52:55], v[16:19], v[196:199], v[52:55]
buffer_store_dwordx4 v[96:99], v14, s[32:35], s90 offen offset:0
v_mfma_f32_16x16x32_bf16 v[56:59], v[20:23], v[192:195], v[56:59]
ds_read_b64_tr_b16 v[16:17], v5 offset:36864
ds_read_b64_tr_b16 v[18:19], v5 offset:37376
v_mfma_f32_16x16x32_bf16 v[60:63], v[20:23], v[196:199], v[60:63]
v_mfma_f32_16x16x32_bf16 v[64:67], v[24:27], v[192:195], v[64:67]
ds_read_b64_tr_b16 v[20:21], v10 offset:36864
ds_read_b64_tr_b16 v[22:23], v10 offset:37376
v_mfma_f32_16x16x32_bf16 v[68:71], v[24:27], v[196:199], v[68:71]
buffer_store_dwordx4 v[100:103], v14, s[32:35], s90 offen offset:128
v_mfma_f32_16x16x32_bf16 v[72:75], v[28:31], v[192:195], v[72:75]
ds_read_b64_tr_b16 v[24:25], v6 offset:36864
ds_read_b64_tr_b16 v[26:27], v6 offset:37376
v_mfma_f32_16x16x32_bf16 v[76:79], v[28:31], v[196:199], v[76:79]
s_waitcnt lgkmcnt(6)
v_mfma_f32_16x16x32_bf16 v[80:83], v[32:35], v[192:195], v[80:83]
ds_read_b64_tr_b16 v[28:29], v11 offset:36864
ds_read_b64_tr_b16 v[30:31], v11 offset:37376
v_mfma_f32_16x16x32_bf16 v[84:87], v[32:35], v[196:199], v[84:87]
s_lshl_b32 s86, s30, 5
s_add_u32 s86, s86, s31
s_lshl_b32 s86, s86, 6
s_add_u32 s86, s86, 21004288
v_lshrrev_b32 v2, 1, v8
s_mov_b64 exec, 0xff
buffer_store_dwordx2 a[240:241], v2, s[32:35], s86 offen sc1
s_mov_b64 exec, -1
v_mfma_f32_16x16x32_bf16 v[88:91], v[36:39], v[192:195], v[88:91]
ds_read_b64_tr_b16 v[32:33], v4 offset:40960
ds_read_b64_tr_b16 v[34:35], v4 offset:41472
v_mfma_f32_16x16x32_bf16 v[92:95], v[36:39], v[196:199], v[92:95]
s_waitcnt vmcnt(15)
v_mfma_f32_16x16x32_bf16 v[48:51], v[40:43], v[200:203], v[48:51]
ds_read_b64_tr_b16 v[36:37], v9 offset:40960
ds_read_b64_tr_b16 v[38:39], v9 offset:41472
v_mfma_f32_16x16x32_bf16 v[52:55], v[40:43], v[204:207], v[52:55]
s_add_u32 s100, s87, 0
buffer_load_dwordx4 a[0:3], v8, s[32:35], s100 offen offset:0 sc1
v_mfma_f32_16x16x32_bf16 v[56:59], v[44:47], v[200:203], v[56:59]
ds_read_b64_tr_b16 v[40:41], v5 offset:40960
ds_read_b64_tr_b16 v[42:43], v5 offset:41472
v_mfma_f32_16x16x32_bf16 v[60:63], v[44:47], v[204:207], v[60:63]
s_waitcnt lgkmcnt(6)
v_mfma_f32_16x16x32_bf16 v[64:67], v[16:19], v[200:203], v[64:67]
ds_read_b64_tr_b16 v[44:45], v10 offset:40960
ds_read_b64_tr_b16 v[46:47], v10 offset:41472
v_mfma_f32_16x16x32_bf16 v[68:71], v[16:19], v[204:207], v[68:71]
buffer_load_dwordx4 a[4:7], v8, s[32:35], s100 offen offset:1024 sc1
v_mfma_f32_16x16x32_bf16 v[72:75], v[20:23], v[200:203], v[72:75]
ds_read_b64_tr_b16 v[16:17], v6 offset:40960
ds_read_b64_tr_b16 v[18:19], v6 offset:41472
v_mfma_f32_16x16x32_bf16 v[76:79], v[20:23], v[204:207], v[76:79]
v_mfma_f32_16x16x32_bf16 v[80:83], v[24:27], v[200:203], v[80:83]
ds_read_b64_tr_b16 v[20:21], v11 offset:40960
ds_read_b64_tr_b16 v[22:23], v11 offset:41472
v_mfma_f32_16x16x32_bf16 v[84:87], v[24:27], v[204:207], v[84:87]
buffer_load_dwordx4 a[8:11], v8, s[32:35], s100 offen offset:2048 sc1
v_mfma_f32_16x16x32_bf16 v[88:91], v[28:31], v[200:203], v[88:91]
ds_read_b64_tr_b16 v[24:25], v4 offset:45056
ds_read_b64_tr_b16 v[26:27], v4 offset:45568
v_mfma_f32_16x16x32_bf16 v[92:95], v[28:31], v[204:207], v[92:95]
s_waitcnt vmcnt(16) lgkmcnt(6)
v_mfma_f32_16x16x32_bf16 v[48:51], v[32:35], v[208:211], v[48:51]
ds_read_b64_tr_b16 v[28:29], v9 offset:45056
ds_read_b64_tr_b16 v[30:31], v9 offset:45568
v_mfma_f32_16x16x32_bf16 v[52:55], v[32:35], v[212:215], v[52:55]
buffer_load_dwordx4 a[12:15], v8, s[32:35], s100 offen offset:3072 sc1
v_mfma_f32_16x16x32_bf16 v[56:59], v[36:39], v[208:211], v[56:59]
ds_read_b64_tr_b16 v[32:33], v5 offset:45056
ds_read_b64_tr_b16 v[34:35], v5 offset:45568
v_mfma_f32_16x16x32_bf16 v[60:63], v[36:39], v[212:215], v[60:63]
v_mfma_f32_16x16x32_bf16 v[64:67], v[40:43], v[208:211], v[64:67]
ds_read_b64_tr_b16 v[36:37], v10 offset:45056
ds_read_b64_tr_b16 v[38:39], v10 offset:45568
v_mfma_f32_16x16x32_bf16 v[68:71], v[40:43], v[212:215], v[68:71]
s_add_u32 s100, s87, 4096
buffer_load_dwordx4 a[16:19], v8, s[32:35], s100 offen offset:0 sc1
v_mfma_f32_16x16x32_bf16 v[72:75], v[44:47], v[208:211], v[72:75]
ds_read_b64_tr_b16 v[40:41], v6 offset:45056
ds_read_b64_tr_b16 v[42:43], v6 offset:45568
v_mfma_f32_16x16x32_bf16 v[76:79], v[44:47], v[212:215], v[76:79]
s_waitcnt lgkmcnt(6)
v_mfma_f32_16x16x32_bf16 v[80:83], v[16:19], v[208:211], v[80:83]
ds_read_b64_tr_b16 v[44:45], v11 offset:45056
ds_read_b64_tr_b16 v[46:47], v11 offset:45568
v_mfma_f32_16x16x32_bf16 v[84:87], v[16:19], v[212:215], v[84:87]
buffer_load_dwordx4 a[20:23], v8, s[32:35], s100 offen offset:1024 sc1
v_mfma_f32_16x16x32_bf16 v[88:91], v[20:23], v[208:211], v[88:91]
ds_read_b64_tr_b16 v[16:17], v4 offset:49152
ds_read_b64_tr_b16 v[18:19], v4 offset:49664
v_mfma_f32_16x16x32_bf16 v[92:95], v[20:23], v[212:215], v[92:95]
s_waitcnt vmcnt(17)
v_mfma_f32_16x16x32_bf16 v[48:51], v[24:27], v[216:219], v[48:51]
ds_read_b64_tr_b16 v[20:21], v9 offset:49152
ds_read_b64_tr_b16 v[22:23], v9 offset:49664
v_mfma_f32_16x16x32_bf16 v[52:55], v[24:27], v[220:223], v[52:55]
buffer_load_dwordx4 a[24:27], v8, s[32:35], s100 offen offset:2048 sc1
v_mfma_f32_16x16x32_bf16 v[56:59], v[28:31], v[216:219], v[56:59]
ds_read_b64_tr_b16 v[24:25], v4 offset:53248
ds_read_b64_tr_b16 v[26:27], v4 offset:53760
v_mfma_f32_16x16x32_bf16 v[60:63], v[28:31], v[220:223], v[60:63]
s_waitcnt lgkmcnt(6)
v_mfma_f32_16x16x32_bf16 v[64:67], v[32:35], v[216:219], v[64:67]
ds_read_b64_tr_b16 v[28:29], v9 offset:53248
ds_read_b64_tr_b16 v[30:31], v9 offset:53760
v_mfma_f32_16x16x32_bf16 v[68:71], v[32:35], v[220:223], v[68:71]
buffer_load_dwordx4 a[28:31], v8, s[32:35], s100 offen offset:3072 sc1
v_mfma_f32_16x16x32_bf16 v[72:75], v[36:39], v[216:219], v[72:75]
ds_read_b64_tr_b16 v[32:33], v4 offset:57344
ds_read_b64_tr_b16 v[34:35], v4 offset:57856
v_mfma_f32_16x16x32_bf16 v[76:79], v[36:39], v[220:223], v[76:79]
v_mfma_f32_16x16x32_bf16 v[80:83], v[40:43], v[216:219], v[80:83]
ds_read_b64_tr_b16 v[36:37], v9 offset:57344
ds_read_b64_tr_b16 v[38:39], v9 offset:57856
v_mfma_f32_16x16x32_bf16 v[84:87], v[40:43], v[220:223], v[84:87]
s_add_u32 s100, s87, 8192
buffer_load_dwordx4 a[32:35], v8, s[32:35], s100 offen offset:0 sc1
v_mfma_f32_16x16x32_bf16 v[88:91], v[44:47], v[216:219], v[88:91]
ds_read_b64_tr_b16 v[40:41], v4 offset:61440
ds_read_b64_tr_b16 v[42:43], v4 offset:61952
v_mfma_f32_16x16x32_bf16 v[92:95], v[44:47], v[220:223], v[92:95]
s_waitcnt vmcnt(18) lgkmcnt(6)
v_mfma_f32_16x16x32_bf16 v[48:51], v[16:19], v[224:227], v[48:51]
ds_read_b64_tr_b16 v[44:45], v9 offset:61440
ds_read_b64_tr_b16 v[46:47], v9 offset:61952
v_mfma_f32_16x16x32_bf16 v[52:55], v[16:19], v[228:231], v[52:55]
buffer_load_dwordx4 a[36:39], v8, s[32:35], s100 offen offset:1024 sc1
v_mfma_f32_16x16x32_bf16 v[56:59], v[20:23], v[224:227], v[56:59]
ds_read_b64_tr_b16 v[16:17], v5 offset:49152
ds_read_b64_tr_b16 v[18:19], v5 offset:49664
v_mfma_f32_16x16x32_bf16 v[60:63], v[20:23], v[228:231], v[60:63]
s_waitcnt vmcnt(17)
v_mfma_f32_16x16x32_bf16 v[48:51], v[24:27], v[232:235], v[48:51]
ds_read_b64_tr_b16 v[20:21], v10 offset:49152
ds_read_b64_tr_b16 v[22:23], v10 offset:49664
v_mfma_f32_16x16x32_bf16 v[52:55], v[24:27], v[236:239], v[52:55]
buffer_load_dwordx4 a[40:43], v8, s[32:35], s100 offen offset:2048 sc1
v_mfma_f32_16x16x32_bf16 v[56:59], v[28:31], v[232:235], v[56:59]
ds_read_b64_tr_b16 v[24:25], v5 offset:53248
ds_read_b64_tr_b16 v[26:27], v5 offset:53760
v_mfma_f32_16x16x32_bf16 v[60:63], v[28:31], v[236:239], v[60:63]
s_waitcnt vmcnt(16) lgkmcnt(6)
v_mfma_f32_16x16x32_bf16 v[48:51], v[32:35], v[240:243], v[48:51]
ds_read_b64_tr_b16 v[28:29], v10 offset:53248
ds_read_b64_tr_b16 v[30:31], v10 offset:53760
v_mfma_f32_16x16x32_bf16 v[52:55], v[32:35], v[244:247], v[52:55]
buffer_load_dwordx4 a[44:47], v8, s[32:35], s100 offen offset:3072 sc1
v_mfma_f32_16x16x32_bf16 v[56:59], v[36:39], v[240:243], v[56:59]
ds_read_b64_tr_b16 v[32:33], v5 offset:57344
ds_read_b64_tr_b16 v[34:35], v5 offset:57856
v_mfma_f32_16x16x32_bf16 v[60:63], v[36:39], v[244:247], v[60:63]
s_waitcnt vmcnt(15)
v_mfma_f32_16x16x32_bf16 v[48:51], v[40:43], v[248:251], v[48:51]
ds_read_b64_tr_b16 v[36:37], v10 offset:57344
ds_read_b64_tr_b16 v[38:39], v10 offset:57856
v_mfma_f32_16x16x32_bf16 v[52:55], v[40:43], v[252:255], v[52:55]
s_add_u32 s100, s87, 12288
buffer_load_dwordx4 a[48:51], v8, s[32:35], s100 offen offset:0 sc1
v_mfma_f32_16x16x32_bf16 v[56:59], v[44:47], v[248:251], v[56:59]
ds_read_b64_tr_b16 v[40:41], v5 offset:61440
ds_read_b64_tr_b16 v[42:43], v5 offset:61952
v_mfma_f32_16x16x32_bf16 v[60:63], v[44:47], v[252:255], v[60:63]
s_waitcnt lgkmcnt(6)
v_mfma_f32_16x16x32_bf16 v[64:67], v[16:19], v[224:227], v[64:67]
ds_read_b64_tr_b16 v[44:45], v10 offset:61440
ds_read_b64_tr_b16 v[46:47], v10 offset:61952
v_mfma_f32_16x16x32_bf16 v[68:71], v[16:19], v[228:231], v[68:71]
buffer_load_dwordx4 a[52:55], v8, s[32:35], s100 offen offset:1024 sc1
v_mfma_f32_16x16x32_bf16 v[72:75], v[20:23], v[224:227], v[72:75]
ds_read_b64_tr_b16 v[16:17], v6 offset:49152
ds_read_b64_tr_b16 v[18:19], v6 offset:49664
v_mfma_f32_16x16x32_bf16 v[76:79], v[20:23], v[228:231], v[76:79]
v_mfma_f32_16x16x32_bf16 v[64:67], v[24:27], v[232:235], v[64:67]
ds_read_b64_tr_b16 v[20:21], v11 offset:49152
ds_read_b64_tr_b16 v[22:23], v11 offset:49664
v_mfma_f32_16x16x32_bf16 v[68:71], v[24:27], v[236:239], v[68:71]
buffer_load_dwordx4 a[56:59], v8, s[32:35], s100 offen offset:2048 sc1
v_exp_f32 v48, -v48
v_mfma_f32_16x16x32_bf16 v[72:75], v[28:31], v[232:235], v[72:75]
ds_read_b64_tr_b16 v[24:25], v6 offset:53248
ds_read_b64_tr_b16 v[26:27], v6 offset:53760
v_add_f32 v48, 1.0, v48
v_mfma_f32_16x16x32_bf16 v[76:79], v[28:31], v[236:239], v[76:79]
s_waitcnt lgkmcnt(6)
v_exp_f32 v49, -v49
v_mfma_f32_16x16x32_bf16 v[64:67], v[32:35], v[240:243], v[64:67]
ds_read_b64_tr_b16 v[28:29], v11 offset:53248
ds_read_b64_tr_b16 v[30:31], v11 offset:53760
v_add_f32 v49, 1.0, v49
v_mfma_f32_16x16x32_bf16 v[68:71], v[32:35], v[244:247], v[68:71]
buffer_load_dwordx4 a[60:63], v8, s[32:35], s100 offen offset:3072 sc1
v_exp_f32 v50, -v50
v_mfma_f32_16x16x32_bf16 v[72:75], v[36:39], v[240:243], v[72:75]
ds_read_b64_tr_b16 v[32:33], v6 offset:57344
ds_read_b64_tr_b16 v[34:35], v6 offset:57856
v_add_f32 v50, 1.0, v50
v_mfma_f32_16x16x32_bf16 v[76:79], v[36:39], v[244:247], v[76:79]
v_exp_f32 v51, -v51
v_mfma_f32_16x16x32_bf16 v[64:67], v[40:43], v[248:251], v[64:67]
ds_read_b64_tr_b16 v[36:37], v11 offset:57344
ds_read_b64_tr_b16 v[38:39], v11 offset:57856
v_add_f32 v51, 1.0, v51
v_mfma_f32_16x16x32_bf16 v[68:71], v[40:43], v[252:255], v[68:71]
s_add_u32 s100, s87, 16384
buffer_load_dwordx4 a[64:67], v8, s[32:35], s100 offen offset:0 sc1
v_mfma_f32_16x16x32_bf16 v[72:75], v[44:47], v[248:251], v[72:75]
ds_read_b64_tr_b16 v[40:41], v6 offset:61440
ds_read_b64_tr_b16 v[42:43], v6 offset:61952
v_mfma_f32_16x16x32_bf16 v[76:79], v[44:47], v[252:255], v[76:79]
s_waitcnt lgkmcnt(6)
v_exp_f32 v52, -v52
v_mfma_f32_16x16x32_bf16 v[80:83], v[16:19], v[224:227], v[80:83]
ds_read_b64_tr_b16 v[44:45], v11 offset:61440
ds_read_b64_tr_b16 v[46:47], v11 offset:61952
v_add_f32 v52, 1.0, v52
v_mfma_f32_16x16x32_bf16 v[84:87], v[16:19], v[228:231], v[84:87]
buffer_load_dwordx4 a[68:71], v8, s[32:35], s100 offen offset:1024 sc1
v_exp_f32 v53, -v53
v_mfma_f32_16x16x32_bf16 v[88:91], v[20:23], v[224:227], v[88:91]
ds_read_b64_tr_b16 v[16:17], v7 offset:0
ds_read_b64_tr_b16 v[18:19], v7 offset:512
v_add_f32 v53, 1.0, v53
v_mfma_f32_16x16x32_bf16 v[92:95], v[20:23], v[228:231], v[92:95]
v_exp_f32 v54, -v54
v_mfma_f32_16x16x32_bf16 v[80:83], v[24:27], v[232:235], v[80:83]
ds_read_b64_tr_b16 v[20:21], v12 offset:0
ds_read_b64_tr_b16 v[22:23], v12 offset:512
v_add_f32 v54, 1.0, v54
v_mfma_f32_16x16x32_bf16 v[84:87], v[24:27], v[236:239], v[84:87]
buffer_load_dwordx4 a[72:75], v8, s[32:35], s100 offen offset:2048 sc1
v_exp_f32 v55, -v55
v_mfma_f32_16x16x32_bf16 v[88:91], v[28:31], v[232:235], v[88:91]
ds_read_b64_tr_b16 v[24:25], v7 offset:4096
ds_read_b64_tr_b16 v[26:27], v7 offset:4608
v_add_f32 v55, 1.0, v55
v_mfma_f32_16x16x32_bf16 v[92:95], v[28:31], v[236:239], v[92:95]
s_waitcnt lgkmcnt(6)
v_rcp_f32 v48, v48
v_mfma_f32_16x16x32_bf16 v[80:83], v[32:35], v[240:243], v[80:83]
ds_read_b64_tr_b16 v[28:29], v12 offset:4096
ds_read_b64_tr_b16 v[30:31], v12 offset:4608
v_mul_f32 v48, v48, v56
v_mfma_f32_16x16x32_bf16 v[84:87], v[32:35], v[244:247], v[84:87]
buffer_load_dwordx4 a[76:79], v8, s[32:35], s100 offen offset:3072 sc1
v_exp_f32 v64, -v64
v_mfma_f32_16x16x32_bf16 v[88:91], v[36:39], v[240:243], v[88:91]
ds_read_b64_tr_b16 v[32:33], v7 offset:8192
ds_read_b64_tr_b16 v[34:35], v7 offset:8704
v_add_f32 v64, 1.0, v64
v_mfma_f32_16x16x32_bf16 v[92:95], v[36:39], v[244:247], v[92:95]
v_rcp_f32 v49, v49
v_mfma_f32_16x16x32_bf16 v[80:83], v[40:43], v[248:251], v[80:83]
ds_read_b64_tr_b16 v[36:37], v12 offset:8192
ds_read_b64_tr_b16 v[38:39], v12 offset:8704
v_mul_f32 v49, v49, v57
v_mfma_f32_16x16x32_bf16 v[84:87], v[40:43], v[252:255], v[84:87]
v_exp_f32 v65, -v65
v_cvt_pk_bf16_f32 v48, v48, v49
v_mfma_f32_16x16x32_bf16 v[88:91], v[44:47], v[248:251], v[88:91]
ds_read_b64_tr_b16 v[40:41], v7 offset:12288
ds_read_b64_tr_b16 v[42:43], v7 offset:12800
v_add_f32 v65, 1.0, v65
v_mfma_f32_16x16x32_bf16 v[92:95], v[44:47], v[252:255], v[92:95]
s_waitcnt lgkmcnt(6)
v_rcp_f32 v50, v50
v_mfma_f32_16x16x32_bf16 v[96:99], v[16:19], v[128:131], 0
ds_read_b64_tr_b16 v[44:45], v12 offset:12288
ds_read_b64_tr_b16 v[46:47], v12 offset:12800
v_mul_f32 v50, v50, v58
v_mfma_f32_16x16x32_bf16 v[100:103], v[16:19], v[132:135], 0
v_exp_f32 v66, -v66
v_mfma_f32_16x16x32_bf16 v[104:107], v[20:23], v[128:131], 0
ds_read_b64_tr_b16 v[16:17], v7 offset:16384
ds_read_b64_tr_b16 v[18:19], v7 offset:16896
v_add_f32 v66, 1.0, v66
v_mfma_f32_16x16x32_bf16 v[108:111], v[20:23], v[132:135], 0
v_rcp_f32 v51, v51
v_mfma_f32_16x16x32_bf16 v[96:99], v[24:27], v[136:139], v[96:99]
ds_read_b64_tr_b16 v[20:21], v12 offset:16384
ds_read_b64_tr_b16 v[22:23], v12 offset:16896
v_mul_f32 v51, v51, v59
v_mfma_f32_16x16x32_bf16 v[100:103], v[24:27], v[140:143], v[100:103]
s_mov_b32 s55, s81
buffer_load_dwordx4 v[128:131], v13, s[32:35], s55 offen offset:0 sc1
v_cvt_pk_bf16_f32 v49, v50, v51
v_mfma_f32_16x16x32_bf16 v[104:107], v[28:31], v[136:139], v[104:107]
ds_read_b64_tr_b16 v[24:25], v7 offset:20480
ds_read_b64_tr_b16 v[26:27], v7 offset:20992
v_mfma_f32_16x16x32_bf16 v[108:111], v[28:31], v[140:143], v[108:111]
s_waitcnt lgkmcnt(6)
v_exp_f32 v67, -v67
v_mfma_f32_16x16x32_bf16 v[96:99], v[32:35], v[144:147], v[96:99]
ds_read_b64_tr_b16 v[28:29], v12 offset:20480
ds_read_b64_tr_b16 v[30:31], v12 offset:20992
v_add_f32 v67, 1.0, v67
v_mfma_f32_16x16x32_bf16 v[100:103], v[32:35], v[148:151], v[100:103]
buffer_load_dwordx4 v[132:135], v13, s[32:35], s55 offen offset:256 sc1
v_rcp_f32 v52, v52
v_mfma_f32_16x16x32_bf16 v[104:107], v[36:39], v[144:147], v[104:107]
ds_read_b64_tr_b16 v[32:33], v7 offset:24576
ds_read_b64_tr_b16 v[34:35], v7 offset:25088
v_mul_f32 v52, v52, v60
v_mfma_f32_16x16x32_bf16 v[108:111], v[36:39], v[148:151], v[108:111]
v_exp_f32 v68, -v68
v_mfma_f32_16x16x32_bf16 v[96:99], v[40:43], v[152:155], v[96:99]
ds_read_b64_tr_b16 v[36:37], v12 offset:24576
ds_read_b64_tr_b16 v[38:39], v12 offset:25088
v_add_f32 v68, 1.0, v68
v_mfma_f32_16x16x32_bf16 v[100:103], v[40:43], v[156:159], v[100:103]
buffer_load_dwordx4 v[136:139], v13, s[32:35], s55 offen offset:2048 sc1
v_rcp_f32 v53, v53
v_mfma_f32_16x16x32_bf16 v[104:107], v[44:47], v[152:155], v[104:107]
ds_read_b64_tr_b16 v[40:41], v7 offset:28672
ds_read_b64_tr_b16 v[42:43], v7 offset:29184
v_mul_f32 v53, v53, v61
v_mfma_f32_16x16x32_bf16 v[108:111], v[44:47], v[156:159], v[108:111]
s_waitcnt lgkmcnt(6)
v_exp_f32 v69, -v69
v_mfma_f32_16x16x32_bf16 v[96:99], v[16:19], v[160:163], v[96:99]
ds_read_b64_tr_b16 v[44:45], v12 offset:28672
ds_read_b64_tr_b16 v[46:47], v12 offset:29184
v_add_f32 v69, 1.0, v69
v_mfma_f32_16x16x32_bf16 v[100:103], v[16:19], v[164:167], v[100:103]
buffer_load_dwordx4 v[140:143], v13, s[32:35], s55 offen offset:2304 sc1
v_rcp_f32 v54, v54
v_mfma_f32_16x16x32_bf16 v[104:107], v[20:23], v[160:163], v[104:107]
ds_read_b64_tr_b16 v[16:17], v7 offset:32768
ds_read_b64_tr_b16 v[18:19], v7 offset:33280
v_mul_f32 v54, v54, v62
v_mfma_f32_16x16x32_bf16 v[108:111], v[20:23], v[164:167], v[108:111]
v_exp_f32 v70, -v70
v_cvt_pk_bf16_f32 v50, v52, v53
v_mfma_f32_16x16x32_bf16 v[96:99], v[24:27], v[168:171], v[96:99]
ds_read_b64_tr_b16 v[20:21], v12 offset:32768
ds_read_b64_tr_b16 v[22:23], v12 offset:33280
v_add_f32 v70, 1.0, v70
v_mfma_f32_16x16x32_bf16 v[100:103], v[24:27], v[172:175], v[100:103]
s_add_u32 s55, s55, 4096
buffer_load_dwordx4 v[144:147], v13, s[32:35], s55 offen offset:0 sc1
v_permlane16_swap_b32 v48, v50
v_mfma_f32_16x16x32_bf16 v[104:107], v[28:31], v[168:171], v[104:107]
ds_read_b64_tr_b16 v[24:25], v7 offset:36864
ds_read_b64_tr_b16 v[26:27], v7 offset:37376
v_mfma_f32_16x16x32_bf16 v[108:111], v[28:31], v[172:175], v[108:111]
s_waitcnt lgkmcnt(6)
v_rcp_f32 v55, v55
v_mfma_f32_16x16x32_bf16 v[96:99], v[32:35], v[176:179], v[96:99]
ds_read_b64_tr_b16 v[28:29], v12 offset:36864
ds_read_b64_tr_b16 v[30:31], v12 offset:37376
v_mul_f32 v55, v55, v63
v_mfma_f32_16x16x32_bf16 v[100:103], v[32:35], v[180:183], v[100:103]
buffer_load_dwordx4 v[148:151], v13, s[32:35], s55 offen offset:256 sc1
v_exp_f32 v71, -v71
v_mfma_f32_16x16x32_bf16 v[104:107], v[36:39], v[176:179], v[104:107]
ds_read_b64_tr_b16 v[32:33], v7 offset:40960
ds_read_b64_tr_b16 v[34:35], v7 offset:41472
v_add_f32 v71, 1.0, v71
v_mfma_f32_16x16x32_bf16 v[108:111], v[36:39], v[180:183], v[108:111]
v_rcp_f32 v64, v64
v_cvt_pk_bf16_f32 v51, v54, v55
v_mfma_f32_16x16x32_bf16 v[96:99], v[40:43], v[184:187], v[96:99]
ds_read_b64_tr_b16 v[36:37], v12 offset:40960
ds_read_b64_tr_b16 v[38:39], v12 offset:41472
v_mul_f32 v64, v64, v72
v_mfma_f32_16x16x32_bf16 v[100:103], v[40:43], v[188:191], v[100:103]
buffer_load_dwordx4 v[152:155], v13, s[32:35], s55 offen offset:2048 sc1
v_exp_f32 v80, -v80
v_mfma_f32_16x16x32_bf16 v[104:107], v[44:47], v[184:187], v[104:107]
ds_read_b64_tr_b16 v[40:41], v7 offset:45056
ds_read_b64_tr_b16 v[42:43], v7 offset:45568
v_add_f32 v80, 1.0, v80
v_mfma_f32_16x16x32_bf16 v[108:111], v[44:47], v[188:191], v[108:111]
s_waitcnt lgkmcnt(6)
v_rcp_f32 v65, v65
v_mfma_f32_16x16x32_bf16 v[96:99], v[16:19], v[192:195], v[96:99]
ds_read_b64_tr_b16 v[44:45], v12 offset:45056
ds_read_b64_tr_b16 v[46:47], v12 offset:45568
v_mul_f32 v65, v65, v73
v_mfma_f32_16x16x32_bf16 v[100:103], v[16:19], v[196:199], v[100:103]
buffer_load_dwordx4 v[156:159], v13, s[32:35], s55 offen offset:2304 sc1
v_exp_f32 v81, -v81
v_mfma_f32_16x16x32_bf16 v[104:107], v[20:23], v[192:195], v[104:107]
ds_read_b64_tr_b16 v[16:17], v7 offset:49152
ds_read_b64_tr_b16 v[18:19], v7 offset:49664
v_add_f32 v81, 1.0, v81
v_mfma_f32_16x16x32_bf16 v[108:111], v[20:23], v[196:199], v[108:111]
v_rcp_f32 v66, v66
v_permlane16_swap_b32 v49, v51
v_mfma_f32_16x16x32_bf16 v[96:99], v[24:27], v[200:203], v[96:99]
ds_read_b64_tr_b16 v[20:21], v12 offset:49152
ds_read_b64_tr_b16 v[22:23], v12 offset:49664
v_mul_f32 v66, v66, v74
v_mfma_f32_16x16x32_bf16 v[100:103], v[24:27], v[204:207], v[100:103]
s_add_u32 s55, s55, 4096
buffer_load_dwordx4 v[160:163], v13, s[32:35], s55 offen offset:0 sc1
v_cvt_pk_bf16_f32 v64, v64, v65
v_mfma_f32_16x16x32_bf16 v[104:107], v[28:31], v[200:203], v[104:107]
ds_read_b64_tr_b16 v[24:25], v7 offset:53248
ds_read_b64_tr_b16 v[26:27], v7 offset:53760
v_mfma_f32_16x16x32_bf16 v[108:111], v[28:31], v[204:207], v[108:111]
buffer_store_dwordx4 v[48:51], v8, s[32:35], s72 offen sc1
s_waitcnt lgkmcnt(6)
v_mfma_f32_16x16x32_bf16 v[96:99], v[32:35], v[208:211], v[96:99]
ds_read_b64_tr_b16 v[28:29], v12 offset:53248
ds_read_b64_tr_b16 v[30:31], v12 offset:53760
v_mfma_f32_16x16x32_bf16 v[100:103], v[32:35], v[212:215], v[100:103]
buffer_load_dwordx4 v[164:167], v13, s[32:35], s55 offen offset:256 sc1
v_exp_f32 v82, -v82
v_mfma_f32_16x16x32_bf16 v[104:107], v[36:39], v[208:211], v[104:107]
ds_read_b64_tr_b16 v[32:33], v7 offset:57344
ds_read_b64_tr_b16 v[34:35], v7 offset:57856
v_add_f32 v82, 1.0, v82
v_mfma_f32_16x16x32_bf16 v[108:111], v[36:39], v[212:215], v[108:111]
v_rcp_f32 v67, v67
v_mfma_f32_16x16x32_bf16 v[96:99], v[40:43], v[216:219], v[96:99]
ds_read_b64_tr_b16 v[36:37], v12 offset:57344
ds_read_b64_tr_b16 v[38:39], v12 offset:57856
v_mul_f32 v67, v67, v75
v_mfma_f32_16x16x32_bf16 v[100:103], v[40:43], v[220:223], v[100:103]
buffer_load_dwordx4 v[168:171], v13, s[32:35], s55 offen offset:2048 sc1
v_exp_f32 v83, -v83
v_mfma_f32_16x16x32_bf16 v[104:107], v[44:47], v[216:219], v[104:107]
ds_read_b64_tr_b16 v[40:41], v7 offset:61440
ds_read_b64_tr_b16 v[42:43], v7 offset:61952
v_add_f32 v83, 1.0, v83
v_mfma_f32_16x16x32_bf16 v[108:111], v[44:47], v[220:223], v[108:111]
s_waitcnt lgkmcnt(6)
v_rcp_f32 v68, v68
v_mfma_f32_16x16x32_bf16 v[96:99], v[16:19], v[224:227], v[96:99]
ds_read_b64_tr_b16 v[44:45], v12 offset:61440
ds_read_b64_tr_b16 v[46:47], v12 offset:61952
v_mul_f32 v68, v68, v76
v_mfma_f32_16x16x32_bf16 v[100:103], v[16:19], v[228:231], v[100:103]
buffer_load_dwordx4 v[172:175], v13, s[32:35], s55 offen offset:2304 sc1
v_exp_f32 v84, -v84
v_mfma_f32_16x16x32_bf16 v[104:107], v[20:23], v[224:227], v[104:107]
ds_read_b64_tr_b16 v[16:17], v4 offset:0
ds_read_b64_tr_b16 v[18:19], v4 offset:512
v_add_f32 v84, 1.0, v84
v_mfma_f32_16x16x32_bf16 v[108:111], v[20:23], v[228:231], v[108:111]
v_rcp_f32 v69, v69
v_cvt_pk_bf16_f32 v65, v66, v67
v_mfma_f32_16x16x32_bf16 v[96:99], v[24:27], v[232:235], v[96:99]
ds_read_b64_tr_b16 v[20:21], v9 offset:0
ds_read_b64_tr_b16 v[22:23], v9 offset:512
v_mul_f32 v69, v69, v77
v_mfma_f32_16x16x32_bf16 v[100:103], v[24:27], v[236:239], v[100:103]
s_add_u32 s55, s55, 4096
buffer_load_dwordx4 v[176:179], v13, s[32:35], s55 offen offset:0 sc1
v_cvt_pk_bf16_f32 v66, v68, v69
v_mfma_f32_16x16x32_bf16 v[104:107], v[28:31], v[232:235], v[104:107]
ds_read_b64_tr_b16 v[24:25], v5 offset:0
ds_read_b64_tr_b16 v[26:27], v5 offset:512
v_permlane16_swap_b32 v64, v66
v_mfma_f32_16x16x32_bf16 v[108:111], v[28:31], v[236:239], v[108:111]
s_waitcnt lgkmcnt(6)
v_exp_f32 v85, -v85
v_mfma_f32_16x16x32_bf16 v[96:99], v[32:35], v[240:243], v[96:99]
ds_read_b64_tr_b16 v[28:29], v10 offset:0
ds_read_b64_tr_b16 v[30:31], v10 offset:512
v_add_f32 v85, 1.0, v85
v_mfma_f32_16x16x32_bf16 v[100:103], v[32:35], v[244:247], v[100:103]
buffer_load_dwordx4 v[180:183], v13, s[32:35], s55 offen offset:256 sc1
v_rcp_f32 v70, v70
v_mfma_f32_16x16x32_bf16 v[104:107], v[36:39], v[240:243], v[104:107]
ds_read_b64_tr_b16 v[32:33], v4 offset:4096
ds_read_b64_tr_b16 v[34:35], v4 offset:4608
v_mul_f32 v70, v70, v78
v_mfma_f32_16x16x32_bf16 v[108:111], v[36:39], v[244:247], v[108:111]
v_exp_f32 v86, -v86
v_mfma_f32_16x16x32_bf16 v[96:99], v[40:43], v[248:251], v[96:99]
ds_read_b64_tr_b16 v[36:37], v9 offset:4096
ds_read_b64_tr_b16 v[38:39], v9 offset:4608
v_add_f32 v86, 1.0, v86
v_mfma_f32_16x16x32_bf16 v[100:103], v[40:43], v[252:255], v[100:103]
buffer_load_dwordx4 v[184:187], v13, s[32:35], s55 offen offset:2048 sc1
v_rcp_f32 v71, v71
v_mfma_f32_16x16x32_bf16 v[104:107], v[44:47], v[248:251], v[104:107]
ds_read_b64_tr_b16 v[40:41], v5 offset:4096
ds_read_b64_tr_b16 v[42:43], v5 offset:4608
v_mul_f32 v71, v71, v79
v_mfma_f32_16x16x32_bf16 v[108:111], v[44:47], v[252:255], v[108:111]
s_waitcnt vmcnt(14) lgkmcnt(6)
v_exp_f32 v87, -v87
v_mfma_f32_16x16x32_bf16 v[112:115], v[16:19], v[128:131], 0
ds_read_b64_tr_b16 v[44:45], v10 offset:4096
ds_read_b64_tr_b16 v[46:47], v10 offset:4608
v_add_f32 v87, 1.0, v87
v_mfma_f32_16x16x32_bf16 v[116:119], v[16:19], v[132:135], 0
buffer_load_dwordx4 v[188:191], v13, s[32:35], s55 offen offset:2304 sc1
v_rcp_f32 v80, v80
v_mfma_f32_16x16x32_bf16 v[120:123], v[20:23], v[128:131], 0
ds_read_b64_tr_b16 v[16:17], v4 offset:8192
ds_read_b64_tr_b16 v[18:19], v4 offset:8704
v_mul_f32 v80, v80, v88
v_mfma_f32_16x16x32_bf16 v[124:127], v[20:23], v[132:135], 0
v_rcp_f32 v81, v81
v_cvt_pk_bf16_f32 v67, v70, v71
v_mfma_f32_16x16x32_bf16 v[48:51], v[24:27], v[128:131], 0
ds_read_b64_tr_b16 v[20:21], v9 offset:8192
ds_read_b64_tr_b16 v[22:23], v9 offset:8704
v_mul_f32 v81, v81, v89
v_mfma_f32_16x16x32_bf16 v[52:55], v[24:27], v[132:135], 0
s_add_u32 s55, s55, 4096
buffer_load_dwordx4 v[192:195], v13, s[32:35], s55 offen offset:0 sc1
v_permlane16_swap_b32 v65, v67
v_mfma_f32_16x16x32_bf16 v[56:59], v[28:31], v[128:131], 0
ds_read_b64_tr_b16 v[24:25], v5 offset:8192
ds_read_b64_tr_b16 v[26:27], v5 offset:8704
v_cvt_pk_bf16_f32 v80, v80, v81
v_mfma_f32_16x16x32_bf16 v[60:63], v[28:31], v[132:135], 0
buffer_store_dwordx4 v[64:67], v8, s[32:35], s73 offen sc1
s_waitcnt vmcnt(15) lgkmcnt(6)
v_mfma_f32_16x16x32_bf16 v[112:115], v[32:35], v[136:139], v[112:115]
ds_read_b64_tr_b16 v[28:29], v10 offset:8192
ds_read_b64_tr_b16 v[30:31], v10 offset:8704
v_mfma_f32_16x16x32_bf16 v[116:119], v[32:35], v[140:143], v[116:119]
buffer_load_dwordx4 v[196:199], v13, s[32:35], s55 offen offset:256 sc1
v_exp_f32 v96, -v96
v_mfma_f32_16x16x32_bf16 v[120:123], v[36:39], v[136:139], v[120:123]
ds_read_b64_tr_b16 v[32:33], v4 offset:12288
ds_read_b64_tr_b16 v[34:35], v4 offset:12800
v_add_f32 v96, 1.0, v96
v_mfma_f32_16x16x32_bf16 v[124:127], v[36:39], v[140:143], v[124:127]
v_exp_f32 v97, -v97
v_mfma_f32_16x16x32_bf16 v[48:51], v[40:43], v[136:139], v[48:51]
ds_read_b64_tr_b16 v[36:37], v9 offset:12288
ds_read_b64_tr_b16 v[38:39], v9 offset:12800
v_add_f32 v97, 1.0, v97
v_mfma_f32_16x16x32_bf16 v[52:55], v[40:43], v[140:143], v[52:55]
buffer_load_dwordx4 v[200:203], v13, s[32:35], s55 offen offset:2048 sc1
v_rcp_f32 v82, v82
v_mfma_f32_16x16x32_bf16 v[56:59], v[44:47], v[136:139], v[56:59]
ds_read_b64_tr_b16 v[40:41], v5 offset:12288
ds_read_b64_tr_b16 v[42:43], v5 offset:12800
v_mul_f32 v82, v82, v90
v_mfma_f32_16x16x32_bf16 v[60:63], v[44:47], v[140:143], v[60:63]
s_waitcnt vmcnt(15) lgkmcnt(6)
v_exp_f32 v98, -v98
v_mfma_f32_16x16x32_bf16 v[112:115], v[16:19], v[144:147], v[112:115]
ds_read_b64_tr_b16 v[44:45], v10 offset:12288
ds_read_b64_tr_b16 v[46:47], v10 offset:12800
v_add_f32 v98, 1.0, v98
v_mfma_f32_16x16x32_bf16 v[116:119], v[16:19], v[148:151], v[116:119]
buffer_load_dwordx4 v[204:207], v13, s[32:35], s55 offen offset:2304 sc1
v_rcp_f32 v83, v83
v_mfma_f32_16x16x32_bf16 v[120:123], v[20:23], v[144:147], v[120:123]
ds_read_b64_tr_b16 v[16:17], v4 offset:16384
ds_read_b64_tr_b16 v[18:19], v4 offset:16896
v_mul_f32 v83, v83, v91
v_mfma_f32_16x16x32_bf16 v[124:127], v[20:23], v[148:151], v[124:127]
v_exp_f32 v99, -v99
v_cvt_pk_bf16_f32 v81, v82, v83
v_mfma_f32_16x16x32_bf16 v[48:51], v[24:27], v[144:147], v[48:51]
ds_read_b64_tr_b16 v[20:21], v9 offset:16384
ds_read_b64_tr_b16 v[22:23], v9 offset:16896
v_add_f32 v99, 1.0, v99
v_mfma_f32_16x16x32_bf16 v[52:55], v[24:27], v[148:151], v[52:55]
s_add_u32 s55, s55, 4096
buffer_load_dwordx4 v[208:211], v13, s[32:35], s55 offen offset:0 sc1
v_mfma_f32_16x16x32_bf16 v[56:59], v[28:31], v[144:147], v[56:59]
ds_read_b64_tr_b16 v[24:25], v5 offset:16384
ds_read_b64_tr_b16 v[26:27], v5 offset:16896
v_mfma_f32_16x16x32_bf16 v[60:63], v[28:31], v[148:151], v[60:63]
s_waitcnt vmcnt(15) lgkmcnt(6)
v_rcp_f32 v84, v84
v_mfma_f32_16x16x32_bf16 v[112:115], v[32:35], v[152:155], v[112:115]
ds_read_b64_tr_b16 v[28:29], v10 offset:16384
ds_read_b64_tr_b16 v[30:31], v10 offset:16896
v_mul_f32 v84, v84, v92
v_mfma_f32_16x16x32_bf16 v[116:119], v[32:35], v[156:159], v[116:119]
buffer_load_dwordx4 v[212:215], v13, s[32:35], s55 offen offset:256 sc1
v_exp_f32 v100, -v100
v_mfma_f32_16x16x32_bf16 v[120:123], v[36:39], v[152:155], v[120:123]
ds_read_b64_tr_b16 v[32:33], v4 offset:20480
ds_read_b64_tr_b16 v[34:35], v4 offset:20992
v_add_f32 v100, 1.0, v100
v_mfma_f32_16x16x32_bf16 v[124:127], v[36:39], v[156:159], v[124:127]
v_rcp_f32 v85, v85
v_mfma_f32_16x16x32_bf16 v[48:51], v[40:43], v[152:155], v[48:51]
ds_read_b64_tr_b16 v[36:37], v9 offset:20480
ds_read_b64_tr_b16 v[38:39], v9 offset:20992
v_mul_f32 v85, v85, v93
v_mfma_f32_16x16x32_bf16 v[52:55], v[40:43], v[156:159], v[52:55]
buffer_load_dwordx4 v[216:219], v13, s[32:35], s55 offen offset:2048 sc1
v_exp_f32 v101, -v101
v_mfma_f32_16x16x32_bf16 v[56:59], v[44:47], v[152:155], v[56:59]
ds_read_b64_tr_b16 v[40:41], v5 offset:20480
ds_read_b64_tr_b16 v[42:43], v5 offset:20992
v_add_f32 v101, 1.0, v101
v_mfma_f32_16x16x32_bf16 v[60:63], v[44:47], v[156:159], v[60:63]
s_waitcnt vmcnt(14) lgkmcnt(6)
v_rcp_f32 v86, v86
v_mfma_f32_16x16x32_bf16 v[112:115], v[16:19], v[160:163], v[112:115]
ds_read_b64_tr_b16 v[44:45], v10 offset:20480
ds_read_b64_tr_b16 v[46:47], v10 offset:20992
v_mul_f32 v86, v86, v94
v_mfma_f32_16x16x32_bf16 v[116:119], v[16:19], v[164:167], v[116:119]
buffer_load_dwordx4 v[220:223], v13, s[32:35], s55 offen offset:2304 sc1
v_exp_f32 v102, -v102
v_mfma_f32_16x16x32_bf16 v[120:123], v[20:23], v[160:163], v[120:123]
ds_read_b64_tr_b16 v[16:17], v4 offset:24576
ds_read_b64_tr_b16 v[18:19], v4 offset:25088
v_add_f32 v102, 1.0, v102
v_mfma_f32_16x16x32_bf16 v[124:127], v[20:23], v[164:167], v[124:127]
v_rcp_f32 v87, v87
v_cvt_pk_bf16_f32 v82, v84, v85
v_mfma_f32_16x16x32_bf16 v[48:51], v[24:27], v[160:163], v[48:51]
ds_read_b64_tr_b16 v[20:21], v9 offset:24576
ds_read_b64_tr_b16 v[22:23], v9 offset:25088
v_mul_f32 v87, v87, v95
v_mfma_f32_16x16x32_bf16 v[52:55], v[24:27], v[164:167], v[52:55]
s_add_u32 s55, s55, 4096
buffer_load_dwordx4 v[224:227], v13, s[32:35], s55 offen offset:0 sc1
v_cvt_pk_bf16_f32 v83, v86, v87
v_mfma_f32_16x16x32_bf16 v[56:59], v[28:31], v[160:163], v[56:59]
ds_read_b64_tr_b16 v[24:25], v5 offset:24576
ds_read_b64_tr_b16 v[26:27], v5 offset:25088
v_permlane16_swap_b32 v80, v82
v_mfma_f32_16x16x32_bf16 v[60:63], v[28:31], v[164:167], v[60:63]
s_waitcnt vmcnt(14) lgkmcnt(6)
v_exp_f32 v103, -v103
v_mfma_f32_16x16x32_bf16 v[112:115], v[32:35], v[168:171], v[112:115]
ds_read_b64_tr_b16 v[28:29], v10 offset:24576
ds_read_b64_tr_b16 v[30:31], v10 offset:25088
v_add_f32 v103, 1.0, v103
v_mfma_f32_16x16x32_bf16 v[116:119], v[32:35], v[172:175], v[116:119]
buffer_load_dwordx4 v[228:231], v13, s[32:35], s55 offen offset:256 sc1
v_rcp_f32 v96, v96
v_mfma_f32_16x16x32_bf16 v[120:123], v[36:39], v[168:171], v[120:123]
ds_read_b64_tr_b16 v[32:33], v4 offset:28672
ds_read_b64_tr_b16 v[34:35], v4 offset:29184
v_mul_f32 v96, v96, v104
v_mfma_f32_16x16x32_bf16 v[124:127], v[36:39], v[172:175], v[124:127]
v_rcp_f32 v97, v97
v_permlane16_swap_b32 v81, v83
v_mfma_f32_16x16x32_bf16 v[48:51], v[40:43], v[168:171], v[48:51]
ds_read_b64_tr_b16 v[36:37], v9 offset:28672
ds_read_b64_tr_b16 v[38:39], v9 offset:29184
v_mul_f32 v97, v97, v105
v_mfma_f32_16x16x32_bf16 v[52:55], v[40:43], v[172:175], v[52:55]
buffer_load_dwordx4 v[232:235], v13, s[32:35], s55 offen offset:2048 sc1
buffer_store_dwordx4 v[80:83], v8, s[32:35], s74 offen sc1
v_mfma_f32_16x16x32_bf16 v[56:59], v[44:47], v[168:171], v[56:59]
ds_read_b64_tr_b16 v[40:41], v5 offset:28672
ds_read_b64_tr_b16 v[42:43], v5 offset:29184
v_cvt_pk_bf16_f32 v96, v96, v97
v_mfma_f32_16x16x32_bf16 v[60:63], v[44:47], v[172:175], v[60:63]
s_waitcnt vmcnt(15) lgkmcnt(6)
v_rcp_f32 v98, v98
v_mfma_f32_16x16x32_bf16 v[112:115], v[16:19], v[176:179], v[112:115]
ds_read_b64_tr_b16 v[44:45], v10 offset:28672
ds_read_b64_tr_b16 v[46:47], v10 offset:29184
v_mul_f32 v98, v98, v106
v_mfma_f32_16x16x32_bf16 v[116:119], v[16:19], v[180:183], v[116:119]
buffer_load_dwordx4 v[236:239], v13, s[32:35], s55 offen offset:2304 sc1
v_rcp_f32 v99, v99
v_mfma_f32_16x16x32_bf16 v[120:123], v[20:23], v[176:179], v[120:123]
ds_read_b64_tr_b16 v[16:17], v4 offset:32768
ds_read_b64_tr_b16 v[18:19], v4 offset:33280
v_mul_f32 v99, v99, v107
v_mfma_f32_16x16x32_bf16 v[124:127], v[20:23], v[180:183], v[124:127]
v_rcp_f32 v100, v100
v_cvt_pk_bf16_f32 v97, v98, v99
v_mfma_f32_16x16x32_bf16 v[48:51], v[24:27], v[176:179], v[48:51]
ds_read_b64_tr_b16 v[20:21], v9 offset:32768
ds_read_b64_tr_b16 v[22:23], v9 offset:33280
v_mul_f32 v100, v100, v108
v_mfma_f32_16x16x32_bf16 v[52:55], v[24:27], v[180:183], v[52:55]
s_add_u32 s55, s55, 4096
buffer_load_dwordx4 v[240:243], v13, s[32:35], s55 offen offset:0 sc1
v_mfma_f32_16x16x32_bf16 v[56:59], v[28:31], v[176:179], v[56:59]
ds_read_b64_tr_b16 v[24:25], v5 offset:32768
ds_read_b64_tr_b16 v[26:27], v5 offset:33280
v_mfma_f32_16x16x32_bf16 v[60:63], v[28:31], v[180:183], v[60:63]
s_waitcnt vmcnt(15) lgkmcnt(6)
v_rcp_f32 v101, v101
v_mfma_f32_16x16x32_bf16 v[112:115], v[32:35], v[184:187], v[112:115]
ds_read_b64_tr_b16 v[28:29], v10 offset:32768
ds_read_b64_tr_b16 v[30:31], v10 offset:33280
v_mul_f32 v101, v101, v109
v_mfma_f32_16x16x32_bf16 v[116:119], v[32:35], v[188:191], v[116:119]
buffer_load_dwordx4 v[244:247], v13, s[32:35], s55 offen offset:256 sc1
v_rcp_f32 v102, v102
v_mfma_f32_16x16x32_bf16 v[120:123], v[36:39], v[184:187], v[120:123]
ds_read_b64_tr_b16 v[32:33], v4 offset:36864
ds_read_b64_tr_b16 v[34:35], v4 offset:37376
v_mul_f32 v102, v102, v110
v_mfma_f32_16x16x32_bf16 v[124:127], v[36:39], v[188:191], v[124:127]
v_rcp_f32 v103, v103
v_cvt_pk_bf16_f32 v98, v100, v101
v_mfma_f32_16x16x32_bf16 v[48:51], v[40:43], v[184:187], v[48:51]
ds_read_b64_tr_b16 v[36:37], v9 offset:36864
ds_read_b64_tr_b16 v[38:39], v9 offset:37376
v_mul_f32 v103, v103, v111
v_mfma_f32_16x16x32_bf16 v[52:55], v[40:43], v[188:191], v[52:55]
buffer_load_dwordx4 v[248:251], v13, s[32:35], s55 offen offset:2048 sc1
v_cvt_pk_bf16_f32 v99, v102, v103
v_permlane16_swap_b32 v96, v98
v_mfma_f32_16x16x32_bf16 v[56:59], v[44:47], v[184:187], v[56:59]
ds_read_b64_tr_b16 v[40:41], v5 offset:36864
ds_read_b64_tr_b16 v[42:43], v5 offset:37376
v_permlane16_swap_b32 v97, v99
v_mfma_f32_16x16x32_bf16 v[60:63], v[44:47], v[188:191], v[60:63]
buffer_store_dwordx4 v[96:99], v8, s[32:35], s75 offen sc1
s_waitcnt vmcnt(15) lgkmcnt(6)
v_mfma_f32_16x16x32_bf16 v[112:115], v[16:19], v[192:195], v[112:115]
ds_read_b64_tr_b16 v[44:45], v10 offset:36864
ds_read_b64_tr_b16 v[46:47], v10 offset:37376
v_mfma_f32_16x16x32_bf16 v[116:119], v[16:19], v[196:199], v[116:119]
buffer_load_dwordx4 v[252:255], v13, s[32:35], s55 offen offset:2304 sc1
v_mfma_f32_16x16x32_bf16 v[120:123], v[20:23], v[192:195], v[120:123]
ds_read_b64_tr_b16 v[16:17], v4 offset:40960
ds_read_b64_tr_b16 v[18:19], v4 offset:41472
v_mfma_f32_16x16x32_bf16 v[124:127], v[20:23], v[196:199], v[124:127]
v_mfma_f32_16x16x32_bf16 v[48:51], v[24:27], v[192:195], v[48:51]
ds_read_b64_tr_b16 v[20:21], v9 offset:40960
ds_read_b64_tr_b16 v[22:23], v9 offset:41472
v_mfma_f32_16x16x32_bf16 v[52:55], v[24:27], v[196:199], v[52:55]
s_lshr_b32 s86, s31, 2
s_lshl_b32 s86, s86, 7
s_add_u32 s86, s86, s93
v_and_b32 v3, 3, v1
v_lshlrev_b32 v3, 10, v3
buffer_load_dword v3, v3, s[32:35], s86 offen sc1
v_mfma_f32_16x16x32_bf16 v[56:59], v[28:31], v[192:195], v[56:59]
ds_read_b64_tr_b16 v[24:25], v5 offset:40960
ds_read_b64_tr_b16 v[26:27], v5 offset:41472
v_mfma_f32_16x16x32_bf16 v[60:63], v[28:31], v[196:199], v[60:63]
s_waitcnt vmcnt(15) lgkmcnt(6)
v_mfma_f32_16x16x32_bf16 v[112:115], v[32:35], v[200:203], v[112:115]
ds_read_b64_tr_b16 v[28:29], v10 offset:40960
ds_read_b64_tr_b16 v[30:31], v10 offset:41472
v_mfma_f32_16x16x32_bf16 v[116:119], v[32:35], v[204:207], v[116:119]
s_add_u32 s100, s87, 20480
buffer_load_dwordx4 a[80:83], v8, s[32:35], s100 offen offset:0 sc1
v_mfma_f32_16x16x32_bf16 v[120:123], v[36:39], v[200:203], v[120:123]
ds_read_b64_tr_b16 v[32:33], v4 offset:45056
ds_read_b64_tr_b16 v[34:35], v4 offset:45568
v_mfma_f32_16x16x32_bf16 v[124:127], v[36:39], v[204:207], v[124:127]
v_mfma_f32_16x16x32_bf16 v[48:51], v[40:43], v[200:203], v[48:51]
ds_read_b64_tr_b16 v[36:37], v9 offset:45056
ds_read_b64_tr_b16 v[38:39], v9 offset:45568
v_mfma_f32_16x16x32_bf16 v[52:55], v[40:43], v[204:207], v[52:55]
buffer_load_dwordx4 a[84:87], v8, s[32:35], s100 offen offset:1024 sc1
v_mfma_f32_16x16x32_bf16 v[56:59], v[44:47], v[200:203], v[56:59]
ds_read_b64_tr_b16 v[40:41], v5 offset:45056
ds_read_b64_tr_b16 v[42:43], v5 offset:45568
v_mfma_f32_16x16x32_bf16 v[60:63], v[44:47], v[204:207], v[60:63]
s_waitcnt vmcnt(15) lgkmcnt(6)
v_mfma_f32_16x16x32_bf16 v[112:115], v[16:19], v[208:211], v[112:115]
ds_read_b64_tr_b16 v[44:45], v10 offset:45056
ds_read_b64_tr_b16 v[46:47], v10 offset:45568
v_mfma_f32_16x16x32_bf16 v[116:119], v[16:19], v[212:215], v[116:119]
buffer_load_dwordx4 a[88:91], v8, s[32:35], s100 offen offset:2048 sc1
v_mfma_f32_16x16x32_bf16 v[120:123], v[20:23], v[208:211], v[120:123]
ds_read_b64_tr_b16 v[16:17], v4 offset:49152
ds_read_b64_tr_b16 v[18:19], v4 offset:49664
v_mfma_f32_16x16x32_bf16 v[124:127], v[20:23], v[212:215], v[124:127]
v_mfma_f32_16x16x32_bf16 v[48:51], v[24:27], v[208:211], v[48:51]
ds_read_b64_tr_b16 v[20:21], v9 offset:49152
ds_read_b64_tr_b16 v[22:23], v9 offset:49664
v_mfma_f32_16x16x32_bf16 v[52:55], v[24:27], v[212:215], v[52:55]
buffer_load_dwordx4 a[92:95], v8, s[32:35], s100 offen offset:3072 sc1
v_mfma_f32_16x16x32_bf16 v[56:59], v[28:31], v[208:211], v[56:59]
ds_read_b64_tr_b16 v[24:25], v5 offset:49152
ds_read_b64_tr_b16 v[26:27], v5 offset:49664
v_mfma_f32_16x16x32_bf16 v[60:63], v[28:31], v[212:215], v[60:63]
s_waitcnt vmcnt(15) lgkmcnt(6)
v_mfma_f32_16x16x32_bf16 v[112:115], v[32:35], v[216:219], v[112:115]
ds_read_b64_tr_b16 v[28:29], v10 offset:49152
ds_read_b64_tr_b16 v[30:31], v10 offset:49664
v_mfma_f32_16x16x32_bf16 v[116:119], v[32:35], v[220:223], v[116:119]
s_add_u32 s100, s87, 24576
buffer_load_dwordx4 a[96:99], v8, s[32:35], s100 offen offset:0 sc1
v_mfma_f32_16x16x32_bf16 v[120:123], v[36:39], v[216:219], v[120:123]
ds_read_b64_tr_b16 v[32:33], v4 offset:53248
ds_read_b64_tr_b16 v[34:35], v4 offset:53760
v_mfma_f32_16x16x32_bf16 v[124:127], v[36:39], v[220:223], v[124:127]
v_mfma_f32_16x16x32_bf16 v[48:51], v[40:43], v[216:219], v[48:51]
ds_read_b64_tr_b16 v[36:37], v9 offset:53248
ds_read_b64_tr_b16 v[38:39], v9 offset:53760
v_mfma_f32_16x16x32_bf16 v[52:55], v[40:43], v[220:223], v[52:55]
buffer_load_dwordx4 a[100:103], v8, s[32:35], s100 offen offset:1024 sc1
v_mfma_f32_16x16x32_bf16 v[56:59], v[44:47], v[216:219], v[56:59]
ds_read_b64_tr_b16 v[40:41], v5 offset:53248
ds_read_b64_tr_b16 v[42:43], v5 offset:53760
v_mfma_f32_16x16x32_bf16 v[60:63], v[44:47], v[220:223], v[60:63]
s_waitcnt vmcnt(15) lgkmcnt(6)
v_mfma_f32_16x16x32_bf16 v[112:115], v[16:19], v[224:227], v[112:115]
ds_read_b64_tr_b16 v[44:45], v10 offset:53248
ds_read_b64_tr_b16 v[46:47], v10 offset:53760
v_mfma_f32_16x16x32_bf16 v[116:119], v[16:19], v[228:231], v[116:119]
buffer_load_dwordx4 a[104:107], v8, s[32:35], s100 offen offset:2048 sc1
v_mfma_f32_16x16x32_bf16 v[120:123], v[20:23], v[224:227], v[120:123]
ds_read_b64_tr_b16 v[16:17], v4 offset:57344
ds_read_b64_tr_b16 v[18:19], v4 offset:57856
v_mfma_f32_16x16x32_bf16 v[124:127], v[20:23], v[228:231], v[124:127]
v_mfma_f32_16x16x32_bf16 v[48:51], v[24:27], v[224:227], v[48:51]
ds_read_b64_tr_b16 v[20:21], v9 offset:57344
ds_read_b64_tr_b16 v[22:23], v9 offset:57856
v_mfma_f32_16x16x32_bf16 v[52:55], v[24:27], v[228:231], v[52:55]
s_waitcnt vmcnt(9)
v_add_u32_e64 v2, s53, 4
s_cmp_eq_u32 s71, 1
s_cbranch_scc0 OS_35
buffer_store_dword v2, off, s[32:35], s99 offset:0
OSb_36:
v_mfma_f32_16x16x32_bf16 v[56:59], v[28:31], v[224:227], v[56:59]
ds_read_b64_tr_b16 v[24:25], v5 offset:57344
ds_read_b64_tr_b16 v[26:27], v5 offset:57856
v_mfma_f32_16x16x32_bf16 v[60:63], v[28:31], v[228:231], v[60:63]
buffer_load_dwordx4 a[108:111], v8, s[32:35], s100 offen offset:3072 sc1
s_waitcnt lgkmcnt(6)
v_mfma_f32_16x16x32_bf16 v[112:115], v[32:35], v[232:235], v[112:115]
ds_read_b64_tr_b16 v[28:29], v10 offset:57344
ds_read_b64_tr_b16 v[30:31], v10 offset:57856
v_mfma_f32_16x16x32_bf16 v[116:119], v[32:35], v[236:239], v[116:119]
v_mfma_f32_16x16x32_bf16 v[120:123], v[36:39], v[232:235], v[120:123]
ds_read_b64_tr_b16 v[32:33], v4 offset:61440
ds_read_b64_tr_b16 v[34:35], v4 offset:61952
v_mfma_f32_16x16x32_bf16 v[124:127], v[36:39], v[236:239], v[124:127]
s_add_u32 s100, s87, 28672
buffer_load_dwordx4 a[112:115], v8, s[32:35], s100 offen offset:0 sc1
v_mfma_f32_16x16x32_bf16 v[48:51], v[40:43], v[232:235], v[48:51]
ds_read_b64_tr_b16 v[36:37], v9 offset:61440
ds_read_b64_tr_b16 v[38:39], v9 offset:61952
v_mfma_f32_16x16x32_bf16 v[52:55], v[40:43], v[236:239], v[52:55]
v_mfma_f32_16x16x32_bf16 v[56:59], v[44:47], v[232:235], v[56:59]
ds_read_b64_tr_b16 v[40:41], v5 offset:61440
ds_read_b64_tr_b16 v[42:43], v5 offset:61952
v_mfma_f32_16x16x32_bf16 v[60:63], v[44:47], v[236:239], v[60:63]
buffer_load_dwordx4 a[116:119], v8, s[32:35], s100 offen offset:1024 sc1
s_waitcnt lgkmcnt(6)
v_mfma_f32_16x16x32_bf16 v[112:115], v[16:19], v[240:243], v[112:115]
ds_read_b64_tr_b16 v[44:45], v10 offset:61440
ds_read_b64_tr_b16 v[46:47], v10 offset:61952
v_mfma_f32_16x16x32_bf16 v[116:119], v[16:19], v[244:247], v[116:119]
v_mfma_f32_16x16x32_bf16 v[120:123], v[20:23], v[240:243], v[120:123]
ds_read_b64_tr_b16 v[16:17], v6 offset:0
ds_read_b64_tr_b16 v[18:19], v6 offset:512
v_mfma_f32_16x16x32_bf16 v[124:127], v[20:23], v[244:247], v[124:127]
buffer_load_dwordx4 a[120:123], v8, s[32:35], s100 offen offset:2048 sc1
v_mfma_f32_16x16x32_bf16 v[48:51], v[24:27], v[240:243], v[48:51]
ds_read_b64_tr_b16 v[20:21], v11 offset:0
ds_read_b64_tr_b16 v[22:23], v11 offset:512
v_mfma_f32_16x16x32_bf16 v[52:55], v[24:27], v[244:247], v[52:55]
v_mfma_f32_16x16x32_bf16 v[56:59], v[28:31], v[240:243], v[56:59]
ds_read_b64_tr_b16 v[24:25], v6 offset:4096
ds_read_b64_tr_b16 v[26:27], v6 offset:4608
v_mfma_f32_16x16x32_bf16 v[60:63], v[28:31], v[244:247], v[60:63]
buffer_load_dwordx4 a[124:127], v8, s[32:35], s100 offen offset:3072 sc1
s_waitcnt vmcnt(14) lgkmcnt(6)
v_mfma_f32_16x16x32_bf16 v[112:115], v[32:35], v[248:251], v[112:115]
ds_read_b64_tr_b16 v[28:29], v11 offset:4096
ds_read_b64_tr_b16 v[30:31], v11 offset:4608
v_mfma_f32_16x16x32_bf16 v[116:119], v[32:35], v[252:255], v[116:119]
v_mfma_f32_16x16x32_bf16 v[120:123], v[36:39], v[248:251], v[120:123]
ds_read_b64_tr_b16 v[32:33], v6 offset:8192
ds_read_b64_tr_b16 v[34:35], v6 offset:8704
v_mfma_f32_16x16x32_bf16 v[124:127], v[36:39], v[252:255], v[124:127]
s_add_u32 s100, s87, 32768
buffer_load_dwordx4 a[128:131], v8, s[32:35], s100 offen offset:0 sc1
v_mfma_f32_16x16x32_bf16 v[48:51], v[40:43], v[248:251], v[48:51]
ds_read_b64_tr_b16 v[36:37], v11 offset:8192
ds_read_b64_tr_b16 v[38:39], v11 offset:8704
v_mfma_f32_16x16x32_bf16 v[52:55], v[40:43], v[252:255], v[52:55]
v_mfma_f32_16x16x32_bf16 v[56:59], v[44:47], v[248:251], v[56:59]
ds_read_b64_tr_b16 v[40:41], v6 offset:12288
ds_read_b64_tr_b16 v[42:43], v6 offset:12800
v_mfma_f32_16x16x32_bf16 v[60:63], v[44:47], v[252:255], v[60:63]
buffer_load_dwordx4 a[132:135], v8, s[32:35], s100 offen offset:1024 sc1
s_waitcnt lgkmcnt(6)
v_mfma_f32_16x16x32_bf16 v[64:67], v[16:19], v[128:131], 0
ds_read_b64_tr_b16 v[44:45], v11 offset:12288
ds_read_b64_tr_b16 v[46:47], v11 offset:12800
v_mfma_f32_16x16x32_bf16 v[68:71], v[16:19], v[132:135], 0
v_exp_f32 v112, -v112
v_mfma_f32_16x16x32_bf16 v[72:75], v[20:23], v[128:131], 0
ds_read_b64_tr_b16 v[16:17], v6 offset:16384
ds_read_b64_tr_b16 v[18:19], v6 offset:16896
v_add_f32 v112, 1.0, v112
v_mfma_f32_16x16x32_bf16 v[76:79], v[20:23], v[132:135], 0
buffer_load_dwordx4 a[136:139], v8, s[32:35], s100 offen offset:2048 sc1
v_exp_f32 v113, -v113
v_mfma_f32_16x16x32_bf16 v[64:67], v[24:27], v[136:139], v[64:67]
ds_read_b64_tr_b16 v[20:21], v11 offset:16384
ds_read_b64_tr_b16 v[22:23], v11 offset:16896
v_add_f32 v113, 1.0, v113
v_mfma_f32_16x16x32_bf16 v[68:71], v[24:27], v[140:143], v[68:71]
v_exp_f32 v114, -v114
v_mfma_f32_16x16x32_bf16 v[72:75], v[28:31], v[136:139], v[72:75]
ds_read_b64_tr_b16 v[24:25], v6 offset:20480
ds_read_b64_tr_b16 v[26:27], v6 offset:20992
v_add_f32 v114, 1.0, v114
v_mfma_f32_16x16x32_bf16 v[76:79], v[28:31], v[140:143], v[76:79]
buffer_load_dwordx4 a[140:143], v8, s[32:35], s100 offen offset:3072 sc1
s_waitcnt lgkmcnt(6)
v_mfma_f32_16x16x32_bf16 v[64:67], v[32:35], v[144:147], v[64:67]
ds_read_b64_tr_b16 v[28:29], v11 offset:20480
ds_read_b64_tr_b16 v[30:31], v11 offset:20992
v_mfma_f32_16x16x32_bf16 v[68:71], v[32:35], v[148:151], v[68:71]
v_exp_f32 v115, -v115
v_mfma_f32_16x16x32_bf16 v[72:75], v[36:39], v[144:147], v[72:75]
ds_read_b64_tr_b16 v[32:33], v6 offset:24576
ds_read_b64_tr_b16 v[34:35], v6 offset:25088
v_add_f32 v115, 1.0, v115
v_mfma_f32_16x16x32_bf16 v[76:79], v[36:39], v[148:151], v[76:79]
s_add_u32 s100, s87, 36864
buffer_load_dwordx4 a[144:147], v8, s[32:35], s100 offen offset:0 sc1
v_mfma_f32_16x16x32_bf16 v[64:67], v[40:43], v[152:155], v[64:67]
ds_read_b64_tr_b16 v[36:37], v11 offset:24576
ds_read_b64_tr_b16 v[38:39], v11 offset:25088
v_mfma_f32_16x16x32_bf16 v[68:71], v[40:43], v[156:159], v[68:71]
v_exp_f32 v116, -v116
v_mfma_f32_16x16x32_bf16 v[72:75], v[44:47], v[152:155], v[72:75]
ds_read_b64_tr_b16 v[40:41], v6 offset:28672
ds_read_b64_tr_b16 v[42:43], v6 offset:29184
v_add_f32 v116, 1.0, v116
v_mfma_f32_16x16x32_bf16 v[76:79], v[44:47], v[156:159], v[76:79]
buffer_load_dwordx4 a[148:151], v8, s[32:35], s100 offen offset:1024 sc1
s_waitcnt lgkmcnt(6)
v_mfma_f32_16x16x32_bf16 v[64:67], v[16:19], v[160:163], v[64:67]
ds_read_b64_tr_b16 v[44:45], v11 offset:28672
ds_read_b64_tr_b16 v[46:47], v11 offset:29184
v_mfma_f32_16x16x32_bf16 v[68:71], v[16:19], v[164:167], v[68:71]
v_exp_f32 v117, -v117
v_mfma_f32_16x16x32_bf16 v[72:75], v[20:23], v[160:163], v[72:75]
ds_read_b64_tr_b16 v[16:17], v6 offset:32768
ds_read_b64_tr_b16 v[18:19], v6 offset:33280
v_add_f32 v117, 1.0, v117
v_mfma_f32_16x16x32_bf16 v[76:79], v[20:23], v[164:167], v[76:79]
buffer_load_dwordx4 a[152:155], v8, s[32:35], s100 offen offset:2048 sc1
v_exp_f32 v118, -v118
v_mfma_f32_16x16x32_bf16 v[64:67], v[24:27], v[168:171], v[64:67]
ds_read_b64_tr_b16 v[20:21], v11 offset:32768
ds_read_b64_tr_b16 v[22:23], v11 offset:33280
v_add_f32 v118, 1.0, v118
v_mfma_f32_16x16x32_bf16 v[68:71], v[24:27], v[172:175], v[68:71]
v_exp_f32 v119, -v119
v_mfma_f32_16x16x32_bf16 v[72:75], v[28:31], v[168:171], v[72:75]
ds_read_b64_tr_b16 v[24:25], v6 offset:36864
ds_read_b64_tr_b16 v[26:27], v6 offset:37376
v_add_f32 v119, 1.0, v119
v_mfma_f32_16x16x32_bf16 v[76:79], v[28:31], v[172:175], v[76:79]
buffer_load_dwordx4 a[156:159], v8, s[32:35], s100 offen offset:3072 sc1
s_waitcnt lgkmcnt(6)
v_mfma_f32_16x16x32_bf16 v[64:67], v[32:35], v[176:179], v[64:67]
ds_read_b64_tr_b16 v[28:29], v11 offset:36864
ds_read_b64_tr_b16 v[30:31], v11 offset:37376
v_mfma_f32_16x16x32_bf16 v[68:71], v[32:35], v[180:183], v[68:71]
v_rcp_f32 v112, v112
v_mfma_f32_16x16x32_bf16 v[72:75], v[36:39], v[176:179], v[72:75]
ds_read_b64_tr_b16 v[32:33], v6 offset:40960
ds_read_b64_tr_b16 v[34:35], v6 offset:41472
v_mul_f32 v112, v112, v120
v_mfma_f32_16x16x32_bf16 v[76:79], v[36:39], v[180:183], v[76:79]
s_add_u32 s100, s87, 40960
buffer_load_dwordx4 a[160:163], v8, s[32:35], s100 offen offset:0 sc1
v_mfma_f32_16x16x32_bf16 v[64:67], v[40:43], v[184:187], v[64:67]
ds_read_b64_tr_b16 v[36:37], v11 offset:40960
ds_read_b64_tr_b16 v[38:39], v11 offset:41472
v_mfma_f32_16x16x32_bf16 v[68:71], v[40:43], v[188:191], v[68:71]
v_exp_f32 v48, -v48
v_mfma_f32_16x16x32_bf16 v[72:75], v[44:47], v[184:187], v[72:75]
ds_read_b64_tr_b16 v[40:41], v6 offset:45056
ds_read_b64_tr_b16 v[42:43], v6 offset:45568
v_add_f32 v48, 1.0, v48
v_mfma_f32_16x16x32_bf16 v[76:79], v[44:47], v[188:191], v[76:79]
buffer_load_dwordx4 a[164:167], v8, s[32:35], s100 offen offset:1024 sc1
s_waitcnt lgkmcnt(6)
v_mfma_f32_16x16x32_bf16 v[64:67], v[16:19], v[192:195], v[64:67]
ds_read_b64_tr_b16 v[44:45], v11 offset:45056
ds_read_b64_tr_b16 v[46:47], v11 offset:45568
v_mfma_f32_16x16x32_bf16 v[68:71], v[16:19], v[196:199], v[68:71]
v_rcp_f32 v113, v113
v_mfma_f32_16x16x32_bf16 v[72:75], v[20:23], v[192:195], v[72:75]
ds_read_b64_tr_b16 v[16:17], v6 offset:49152
ds_read_b64_tr_b16 v[18:19], v6 offset:49664
v_mul_f32 v113, v113, v121
v_mfma_f32_16x16x32_bf16 v[76:79], v[20:23], v[196:199], v[76:79]
buffer_load_dwordx4 a[168:171], v8, s[32:35], s100 offen offset:2048 sc1
v_exp_f32 v49, -v49
v_mfma_f32_16x16x32_bf16 v[64:67], v[24:27], v[200:203], v[64:67]
ds_read_b64_tr_b16 v[20:21], v11 offset:49152
ds_read_b64_tr_b16 v[22:23], v11 offset:49664
v_add_f32 v49, 1.0, v49
v_mfma_f32_16x16x32_bf16 v[68:71], v[24:27], v[204:207], v[68:71]
v_rcp_f32 v114, v114
v_cvt_pk_bf16_f32 v112, v112, v113
v_mfma_f32_16x16x32_bf16 v[72:75], v[28:31], v[200:203], v[72:75]
ds_read_b64_tr_b16 v[24:25], v6 offset:53248
ds_read_b64_tr_b16 v[26:27], v6 offset:53760
v_mul_f32 v114, v114, v122
v_mfma_f32_16x16x32_bf16 v[76:79], v[28:31], v[204:207], v[76:79]
buffer_load_dwordx4 a[172:175], v8, s[32:35], s100 offen offset:3072 sc1
s_waitcnt lgkmcnt(6)
v_mfma_f32_16x16x32_bf16 v[64:67], v[32:35], v[208:211], v[64:67]
ds_read_b64_tr_b16 v[28:29], v11 offset:53248
ds_read_b64_tr_b16 v[30:31], v11 offset:53760
v_mfma_f32_16x16x32_bf16 v[68:71], v[32:35], v[212:215], v[68:71]
v_exp_f32 v50, -v50
v_mfma_f32_16x16x32_bf16 v[72:75], v[36:39], v[208:211], v[72:75]
ds_read_b64_tr_b16 v[32:33], v6 offset:57344
ds_read_b64_tr_b16 v[34:35], v6 offset:57856
v_add_f32 v50, 1.0, v50
v_mfma_f32_16x16x32_bf16 v[76:79], v[36:39], v[212:215], v[76:79]
s_add_u32 s100, s87, 45056
buffer_load_dwordx4 a[176:179], v8, s[32:35], s100 offen offset:0 sc1
v_mfma_f32_16x16x32_bf16 v[64:67], v[40:43], v[216:219], v[64:67]
ds_read_b64_tr_b16 v[36:37], v11 offset:57344
ds_read_b64_tr_b16 v[38:39], v11 offset:57856
v_mfma_f32_16x16x32_bf16 v[68:71], v[40:43], v[220:223], v[68:71]
v_rcp_f32 v115, v115
v_mfma_f32_16x16x32_bf16 v[72:75], v[44:47], v[216:219], v[72:75]
ds_read_b64_tr_b16 v[40:41], v6 offset:61440
ds_read_b64_tr_b16 v[42:43], v6 offset:61952
v_mul_f32 v115, v115, v123
v_mfma_f32_16x16x32_bf16 v[76:79], v[44:47], v[220:223], v[76:79]
buffer_load_dwordx4 a[180:183], v8, s[32:35], s100 offen offset:1024 sc1
s_waitcnt lgkmcnt(6)
v_cvt_pk_bf16_f32 v113, v114, v115
v_mfma_f32_16x16x32_bf16 v[64:67], v[16:19], v[224:227], v[64:67]
ds_read_b64_tr_b16 v[44:45], v11 offset:61440
ds_read_b64_tr_b16 v[46:47], v11 offset:61952
v_mfma_f32_16x16x32_bf16 v[68:71], v[16:19], v[228:231], v[68:71]
v_exp_f32 v51, -v51
v_mfma_f32_16x16x32_bf16 v[72:75], v[20:23], v[224:227], v[72:75]
v_rcp_f32 v116, v116
v_add_f32 v51, 1.0, v51
v_mfma_f32_16x16x32_bf16 v[76:79], v[20:23], v[228:231], v[76:79]
buffer_load_dwordx4 a[184:187], v8, s[32:35], s100 offen offset:2048 sc1
v_exp_f32 v52, -v52
v_mfma_f32_16x16x32_bf16 v[64:67], v[24:27], v[232:235], v[64:67]
v_rcp_f32 v117, v117
v_mul_f32 v116, v116, v124
v_mfma_f32_16x16x32_bf16 v[68:71], v[24:27], v[236:239], v[68:71]
v_exp_f32 v53, -v53
v_add_f32 v52, 1.0, v52
v_mfma_f32_16x16x32_bf16 v[72:75], v[28:31], v[232:235], v[72:75]
v_rcp_f32 v118, v118
v_mul_f32 v117, v117, v125
v_mfma_f32_16x16x32_bf16 v[76:79], v[28:31], v[236:239], v[76:79]
buffer_load_dwordx4 a[188:191], v8, s[32:35], s100 offen offset:3072 sc1
s_waitcnt lgkmcnt(0)
v_add_f32 v53, 1.0, v53
v_mfma_f32_16x16x32_bf16 v[64:67], v[32:35], v[240:243], v[64:67]
v_exp_f32 v54, -v54
v_mul_f32 v118, v118, v126
v_mfma_f32_16x16x32_bf16 v[68:71], v[32:35], v[244:247], v[68:71]
v_rcp_f32 v119, v119
v_add_f32 v54, 1.0, v54
v_mfma_f32_16x16x32_bf16 v[72:75], v[36:39], v[240:243], v[72:75]
v_exp_f32 v55, -v55
v_mul_f32 v119, v119, v127
v_mfma_f32_16x16x32_bf16 v[76:79], v[36:39], v[244:247], v[76:79]
s_add_u32 s100, s87, 49152
buffer_load_dwordx4 a[192:195], v8, s[32:35], s100 offen offset:0 sc1
v_add_f32 v55, 1.0, v55
v_mfma_f32_16x16x32_bf16 v[64:67], v[40:43], v[248:251], v[64:67]
v_rcp_f32 v48, v48
v_cvt_pk_bf16_f32 v114, v116, v117
v_mfma_f32_16x16x32_bf16 v[68:71], v[40:43], v[252:255], v[68:71]
v_accvgpr_read_b32 v14, a244
buffer_load_dword v15, v14, s[32:35], 0 offen sc1
v_mul_f32 v48, v48, v56
v_mfma_f32_16x16x32_bf16 v[72:75], v[44:47], v[248:251], v[72:75]
v_rcp_f32 v49, v49
v_cvt_pk_bf16_f32 v115, v118, v119
v_mfma_f32_16x16x32_bf16 v[76:79], v[44:47], v[252:255], v[76:79]
buffer_load_dwordx4 a[196:199], v8, s[32:35], s100 offen offset:1024 sc1
v_rcp_f32 v50, v50
buffer_load_dwordx4 a[200:203], v8, s[32:35], s100 offen offset:2048 sc1
buffer_load_dwordx4 a[204:207], v8, s[32:35], s100 offen offset:3072 sc1
s_add_u32 s100, s87, 53248
buffer_load_dwordx4 a[208:211], v8, s[32:35], s100 offen offset:0 sc1
buffer_load_dwordx4 a[212:215], v8, s[32:35], s100 offen offset:1024 sc1
buffer_load_dwordx4 a[216:219], v8, s[32:35], s100 offen offset:2048 sc1
buffer_load_dwordx4 a[220:223], v8, s[32:35], s100 offen offset:3072 sc1
v_rcp_f32 v51, v51
v_rcp_f32 v52, v52
v_rcp_f32 v53, v53
v_mul_f32 v49, v49, v57
v_rcp_f32 v54, v54
v_mul_f32 v50, v50, v58
v_rcp_f32 v55, v55
v_permlane16_swap_b32 v112, v114
v_permlane16_swap_b32 v113, v115
v_mul_f32 v51, v51, v59
v_mul_f32 v52, v52, v60
buffer_store_dwordx4 v[112:115], v8, s[32:35], s76 offen sc1
v_mul_f32 v53, v53, v61
v_cvt_pk_bf16_f32 v48, v48, v49
v_mul_f32 v54, v54, v62
v_mul_f32 v55, v55, v63
v_cvt_pk_bf16_f32 v49, v50, v51
v_cvt_pk_bf16_f32 v50, v52, v53
v_cvt_pk_bf16_f32 v51, v54, v55
s_nop 0
v_permlane16_swap_b32 v48, v50
v_permlane16_swap_b32 v49, v51
buffer_store_dwordx4 v[48:51], v8, s[32:35], s77 offen sc1
s_branch G1j_34
G1o_33:
s_mov_b32 s54, s80
buffer_load_dwordx4 v[128:131], v13, s[32:35], s54 offen offset:0 sc1
buffer_load_dwordx4 v[132:135], v13, s[32:35], s54 offen offset:256 sc1
buffer_load_dwordx4 v[136:139], v13, s[32:35], s54 offen offset:2048 sc1
buffer_load_dwordx4 v[140:143], v13, s[32:35], s54 offen offset:2304 sc1
s_add_u32 s54, s54, 4096
buffer_load_dwordx4 v[144:147], v13, s[32:35], s54 offen offset:0 sc1
buffer_load_dwordx4 v[148:151], v13, s[32:35], s54 offen offset:256 sc1
buffer_load_dwordx4 v[152:155], v13, s[32:35], s54 offen offset:2048 sc1
buffer_load_dwordx4 v[156:159], v13, s[32:35], s54 offen offset:2304 sc1
ds_read_b64_tr_b16 v[16:17], v4 offset:0
ds_read_b64_tr_b16 v[18:19], v4 offset:512
ds_read_b64_tr_b16 v[20:21], v9 offset:0
ds_read_b64_tr_b16 v[22:23], v9 offset:512
ds_read_b64_tr_b16 v[24:25], v5 offset:0
ds_read_b64_tr_b16 v[26:27], v5 offset:512
ds_read_b64_tr_b16 v[28:29], v10 offset:0
ds_read_b64_tr_b16 v[30:31], v10 offset:512
ds_read_b64_tr_b16 v[32:33], v6 offset:0
ds_read_b64_tr_b16 v[34:35], v6 offset:512
ds_read_b64_tr_b16 v[36:37], v11 offset:0
ds_read_b64_tr_b16 v[38:39], v11 offset:512
ds_read_b64_tr_b16 v[40:41], v4 offset:4096
ds_read_b64_tr_b16 v[42:43], v4 offset:4608
s_waitcnt vmcnt(6) lgkmcnt(6)
v_mfma_f32_16x16x32_bf16 v[48:51], v[16:19], v[128:131], 0
ds_read_b64_tr_b16 v[44:45], v9 offset:4096
ds_read_b64_tr_b16 v[46:47], v9 offset:4608
v_mfma_f32_16x16x32_bf16 v[52:55], v[16:19], v[132:135], 0
s_add_u32 s54, s54, 4096
buffer_load_dwordx4 v[160:163], v13, s[32:35], s54 offen offset:0 sc1
v_mfma_f32_16x16x32_bf16 v[56:59], v[20:23], v[128:131], 0
ds_read_b64_tr_b16 v[16:17], v5 offset:4096
ds_read_b64_tr_b16 v[18:19], v5 offset:4608
v_mfma_f32_16x16x32_bf16 v[60:63], v[20:23], v[132:135], 0
v_mfma_f32_16x16x32_bf16 v[64:67], v[24:27], v[128:131], 0
ds_read_b64_tr_b16 v[20:21], v10 offset:4096
ds_read_b64_tr_b16 v[22:23], v10 offset:4608
v_mfma_f32_16x16x32_bf16 v[68:71], v[24:27], v[132:135], 0
buffer_load_dwordx4 v[164:167], v13, s[32:35], s54 offen offset:256 sc1
v_mfma_f32_16x16x32_bf16 v[72:75], v[28:31], v[128:131], 0
ds_read_b64_tr_b16 v[24:25], v6 offset:4096
ds_read_b64_tr_b16 v[26:27], v6 offset:4608
v_mfma_f32_16x16x32_bf16 v[76:79], v[28:31], v[132:135], 0
s_waitcnt lgkmcnt(6)
v_mfma_f32_16x16x32_bf16 v[80:83], v[32:35], v[128:131], 0
ds_read_b64_tr_b16 v[28:29], v11 offset:4096
ds_read_b64_tr_b16 v[30:31], v11 offset:4608
v_mfma_f32_16x16x32_bf16 v[84:87], v[32:35], v[132:135], 0
buffer_load_dwordx4 v[168:171], v13, s[32:35], s54 offen offset:2048 sc1
v_mfma_f32_16x16x32_bf16 v[88:91], v[36:39], v[128:131], 0
ds_read_b64_tr_b16 v[32:33], v4 offset:8192
ds_read_b64_tr_b16 v[34:35], v4 offset:8704
v_mfma_f32_16x16x32_bf16 v[92:95], v[36:39], v[132:135], 0
s_waitcnt vmcnt(7)
v_mfma_f32_16x16x32_bf16 v[48:51], v[40:43], v[136:139], v[48:51]
ds_read_b64_tr_b16 v[36:37], v9 offset:8192
ds_read_b64_tr_b16 v[38:39], v9 offset:8704
v_mfma_f32_16x16x32_bf16 v[52:55], v[40:43], v[140:143], v[52:55]
buffer_load_dwordx4 v[172:175], v13, s[32:35], s54 offen offset:2304 sc1
v_mfma_f32_16x16x32_bf16 v[56:59], v[44:47], v[136:139], v[56:59]
ds_read_b64_tr_b16 v[40:41], v5 offset:8192
ds_read_b64_tr_b16 v[42:43], v5 offset:8704
v_mfma_f32_16x16x32_bf16 v[60:63], v[44:47], v[140:143], v[60:63]
s_waitcnt lgkmcnt(6)
v_mfma_f32_16x16x32_bf16 v[64:67], v[16:19], v[136:139], v[64:67]
ds_read_b64_tr_b16 v[44:45], v10 offset:8192
ds_read_b64_tr_b16 v[46:47], v10 offset:8704
v_mfma_f32_16x16x32_bf16 v[68:71], v[16:19], v[140:143], v[68:71]
s_add_u32 s54, s54, 4096
buffer_load_dwordx4 v[176:179], v13, s[32:35], s54 offen offset:0 sc1
v_mfma_f32_16x16x32_bf16 v[72:75], v[20:23], v[136:139], v[72:75]
ds_read_b64_tr_b16 v[16:17], v6 offset:8192
ds_read_b64_tr_b16 v[18:19], v6 offset:8704
v_mfma_f32_16x16x32_bf16 v[76:79], v[20:23], v[140:143], v[76:79]
v_mfma_f32_16x16x32_bf16 v[80:83], v[24:27], v[136:139], v[80:83]
ds_read_b64_tr_b16 v[20:21], v11 offset:8192
ds_read_b64_tr_b16 v[22:23], v11 offset:8704
v_mfma_f32_16x16x32_bf16 v[84:87], v[24:27], v[140:143], v[84:87]
buffer_load_dwordx4 v[180:183], v13, s[32:35], s54 offen offset:256 sc1
v_mfma_f32_16x16x32_bf16 v[88:91], v[28:31], v[136:139], v[88:91]
ds_read_b64_tr_b16 v[24:25], v4 offset:12288
ds_read_b64_tr_b16 v[26:27], v4 offset:12800
v_mfma_f32_16x16x32_bf16 v[92:95], v[28:31], v[140:143], v[92:95]
s_waitcnt vmcnt(8) lgkmcnt(6)
v_mfma_f32_16x16x32_bf16 v[48:51], v[32:35], v[144:147], v[48:51]
ds_read_b64_tr_b16 v[28:29], v9 offset:12288
ds_read_b64_tr_b16 v[30:31], v9 offset:12800
v_mfma_f32_16x16x32_bf16 v[52:55], v[32:35], v[148:151], v[52:55]
buffer_load_dwordx4 v[184:187], v13, s[32:35], s54 offen offset:2048 sc1
v_mfma_f32_16x16x32_bf16 v[56:59], v[36:39], v[144:147], v[56:59]
ds_read_b64_tr_b16 v[32:33], v5 offset:12288
ds_read_b64_tr_b16 v[34:35], v5 offset:12800
v_mfma_f32_16x16x32_bf16 v[60:63], v[36:39], v[148:151], v[60:63]
v_mfma_f32_16x16x32_bf16 v[64:67], v[40:43], v[144:147], v[64:67]
ds_read_b64_tr_b16 v[36:37], v10 offset:12288
ds_read_b64_tr_b16 v[38:39], v10 offset:12800
v_mfma_f32_16x16x32_bf16 v[68:71], v[40:43], v[148:151], v[68:71]
buffer_load_dwordx4 v[188:191], v13, s[32:35], s54 offen offset:2304 sc1
v_mfma_f32_16x16x32_bf16 v[72:75], v[44:47], v[144:147], v[72:75]
ds_read_b64_tr_b16 v[40:41], v6 offset:12288
ds_read_b64_tr_b16 v[42:43], v6 offset:12800
v_mfma_f32_16x16x32_bf16 v[76:79], v[44:47], v[148:151], v[76:79]
s_waitcnt lgkmcnt(6)
v_mfma_f32_16x16x32_bf16 v[80:83], v[16:19], v[144:147], v[80:83]
ds_read_b64_tr_b16 v[44:45], v11 offset:12288
ds_read_b64_tr_b16 v[46:47], v11 offset:12800
v_mfma_f32_16x16x32_bf16 v[84:87], v[16:19], v[148:151], v[84:87]
s_add_u32 s54, s54, 4096
buffer_load_dwordx4 v[192:195], v13, s[32:35], s54 offen offset:0 sc1
v_mfma_f32_16x16x32_bf16 v[88:91], v[20:23], v[144:147], v[88:91]
ds_read_b64_tr_b16 v[16:17], v4 offset:16384
ds_read_b64_tr_b16 v[18:19], v4 offset:16896
v_mfma_f32_16x16x32_bf16 v[92:95], v[20:23], v[148:151], v[92:95]
s_waitcnt vmcnt(9)
v_mfma_f32_16x16x32_bf16 v[48:51], v[24:27], v[152:155], v[48:51]
ds_read_b64_tr_b16 v[20:21], v9 offset:16384
ds_read_b64_tr_b16 v[22:23], v9 offset:16896
v_mfma_f32_16x16x32_bf16 v[52:55], v[24:27], v[156:159], v[52:55]
buffer_load_dwordx4 v[196:199], v13, s[32:35], s54 offen offset:256 sc1
v_mfma_f32_16x16x32_bf16 v[56:59], v[28:31], v[152:155], v[56:59]
ds_read_b64_tr_b16 v[24:25], v5 offset:16384
ds_read_b64_tr_b16 v[26:27], v5 offset:16896
v_mfma_f32_16x16x32_bf16 v[60:63], v[28:31], v[156:159], v[60:63]
s_waitcnt lgkmcnt(6)
v_mfma_f32_16x16x32_bf16 v[64:67], v[32:35], v[152:155], v[64:67]
ds_read_b64_tr_b16 v[28:29], v10 offset:16384
ds_read_b64_tr_b16 v[30:31], v10 offset:16896
v_mfma_f32_16x16x32_bf16 v[68:71], v[32:35], v[156:159], v[68:71]
buffer_load_dwordx4 v[200:203], v13, s[32:35], s54 offen offset:2048 sc1
v_mfma_f32_16x16x32_bf16 v[72:75], v[36:39], v[152:155], v[72:75]
ds_read_b64_tr_b16 v[32:33], v6 offset:16384
ds_read_b64_tr_b16 v[34:35], v6 offset:16896
v_mfma_f32_16x16x32_bf16 v[76:79], v[36:39], v[156:159], v[76:79]
v_mfma_f32_16x16x32_bf16 v[80:83], v[40:43], v[152:155], v[80:83]
ds_read_b64_tr_b16 v[36:37], v11 offset:16384
ds_read_b64_tr_b16 v[38:39], v11 offset:16896
v_mfma_f32_16x16x32_bf16 v[84:87], v[40:43], v[156:159], v[84:87]
buffer_load_dwordx4 v[204:207], v13, s[32:35], s54 offen offset:2304 sc1
v_mfma_f32_16x16x32_bf16 v[88:91], v[44:47], v[152:155], v[88:91]
ds_read_b64_tr_b16 v[40:41], v4 offset:20480
ds_read_b64_tr_b16 v[42:43], v4 offset:20992
v_mfma_f32_16x16x32_bf16 v[92:95], v[44:47], v[156:159], v[92:95]
s_waitcnt vmcnt(10) lgkmcnt(6)
v_mfma_f32_16x16x32_bf16 v[48:51], v[16:19], v[160:163], v[48:51]
ds_read_b64_tr_b16 v[44:45], v9 offset:20480
ds_read_b64_tr_b16 v[46:47], v9 offset:20992
v_mfma_f32_16x16x32_bf16 v[52:55], v[16:19], v[164:167], v[52:55]
s_add_u32 s54, s54, 4096
buffer_load_dwordx4 v[208:211], v13, s[32:35], s54 offen offset:0 sc1
v_mfma_f32_16x16x32_bf16 v[56:59], v[20:23], v[160:163], v[56:59]
ds_read_b64_tr_b16 v[16:17], v5 offset:20480
ds_read_b64_tr_b16 v[18:19], v5 offset:20992
v_mfma_f32_16x16x32_bf16 v[60:63], v[20:23], v[164:167], v[60:63]
v_mfma_f32_16x16x32_bf16 v[64:67], v[24:27], v[160:163], v[64:67]
ds_read_b64_tr_b16 v[20:21], v10 offset:20480
ds_read_b64_tr_b16 v[22:23], v10 offset:20992
v_mfma_f32_16x16x32_bf16 v[68:71], v[24:27], v[164:167], v[68:71]
buffer_load_dwordx4 v[212:215], v13, s[32:35], s54 offen offset:256 sc1
v_mfma_f32_16x16x32_bf16 v[72:75], v[28:31], v[160:163], v[72:75]
ds_read_b64_tr_b16 v[24:25], v6 offset:20480
ds_read_b64_tr_b16 v[26:27], v6 offset:20992
v_mfma_f32_16x16x32_bf16 v[76:79], v[28:31], v[164:167], v[76:79]
s_waitcnt lgkmcnt(6)
v_mfma_f32_16x16x32_bf16 v[80:83], v[32:35], v[160:163], v[80:83]
ds_read_b64_tr_b16 v[28:29], v11 offset:20480
ds_read_b64_tr_b16 v[30:31], v11 offset:20992
v_mfma_f32_16x16x32_bf16 v[84:87], v[32:35], v[164:167], v[84:87]
buffer_load_dwordx4 v[216:219], v13, s[32:35], s54 offen offset:2048 sc1
v_mfma_f32_16x16x32_bf16 v[88:91], v[36:39], v[160:163], v[88:91]
ds_read_b64_tr_b16 v[32:33], v4 offset:24576
ds_read_b64_tr_b16 v[34:35], v4 offset:25088
v_mfma_f32_16x16x32_bf16 v[92:95], v[36:39], v[164:167], v[92:95]
s_waitcnt vmcnt(11)
v_mfma_f32_16x16x32_bf16 v[48:51], v[40:43], v[168:171], v[48:51]
ds_read_b64_tr_b16 v[36:37], v9 offset:24576
ds_read_b64_tr_b16 v[38:39], v9 offset:25088
v_mfma_f32_16x16x32_bf16 v[52:55], v[40:43], v[172:175], v[52:55]
buffer_load_dwordx4 v[220:223], v13, s[32:35], s54 offen offset:2304 sc1
v_mfma_f32_16x16x32_bf16 v[56:59], v[44:47], v[168:171], v[56:59]
ds_read_b64_tr_b16 v[40:41], v5 offset:24576
ds_read_b64_tr_b16 v[42:43], v5 offset:25088
v_mfma_f32_16x16x32_bf16 v[60:63], v[44:47], v[172:175], v[60:63]
s_waitcnt lgkmcnt(6)
v_mfma_f32_16x16x32_bf16 v[64:67], v[16:19], v[168:171], v[64:67]
ds_read_b64_tr_b16 v[44:45], v10 offset:24576
ds_read_b64_tr_b16 v[46:47], v10 offset:25088
v_mfma_f32_16x16x32_bf16 v[68:71], v[16:19], v[172:175], v[68:71]
s_add_u32 s54, s54, 4096
buffer_load_dwordx4 v[224:227], v13, s[32:35], s54 offen offset:0 sc1
v_mfma_f32_16x16x32_bf16 v[72:75], v[20:23], v[168:171], v[72:75]
ds_read_b64_tr_b16 v[16:17], v6 offset:24576
ds_read_b64_tr_b16 v[18:19], v6 offset:25088
v_mfma_f32_16x16x32_bf16 v[76:79], v[20:23], v[172:175], v[76:79]
v_mfma_f32_16x16x32_bf16 v[80:83], v[24:27], v[168:171], v[80:83]
ds_read_b64_tr_b16 v[20:21], v11 offset:24576
ds_read_b64_tr_b16 v[22:23], v11 offset:25088
v_mfma_f32_16x16x32_bf16 v[84:87], v[24:27], v[172:175], v[84:87]
buffer_load_dwordx4 v[228:231], v13, s[32:35], s54 offen offset:256 sc1
v_mfma_f32_16x16x32_bf16 v[88:91], v[28:31], v[168:171], v[88:91]
ds_read_b64_tr_b16 v[24:25], v4 offset:28672
ds_read_b64_tr_b16 v[26:27], v4 offset:29184
v_mfma_f32_16x16x32_bf16 v[92:95], v[28:31], v[172:175], v[92:95]
s_waitcnt vmcnt(12) lgkmcnt(6)
v_mfma_f32_16x16x32_bf16 v[48:51], v[32:35], v[176:179], v[48:51]
ds_read_b64_tr_b16 v[28:29], v9 offset:28672
ds_read_b64_tr_b16 v[30:31], v9 offset:29184
v_mfma_f32_16x16x32_bf16 v[52:55], v[32:35], v[180:183], v[52:55]
buffer_load_dwordx4 v[232:235], v13, s[32:35], s54 offen offset:2048 sc1
v_mfma_f32_16x16x32_bf16 v[56:59], v[36:39], v[176:179], v[56:59]
ds_read_b64_tr_b16 v[32:33], v5 offset:28672
ds_read_b64_tr_b16 v[34:35], v5 offset:29184
v_mfma_f32_16x16x32_bf16 v[60:63], v[36:39], v[180:183], v[60:63]
v_mfma_f32_16x16x32_bf16 v[64:67], v[40:43], v[176:179], v[64:67]
ds_read_b64_tr_b16 v[36:37], v10 offset:28672
ds_read_b64_tr_b16 v[38:39], v10 offset:29184
v_mfma_f32_16x16x32_bf16 v[68:71], v[40:43], v[180:183], v[68:71]
buffer_load_dwordx4 v[236:239], v13, s[32:35], s54 offen offset:2304 sc1
v_mfma_f32_16x16x32_bf16 v[72:75], v[44:47], v[176:179], v[72:75]
ds_read_b64_tr_b16 v[40:41], v6 offset:28672
ds_read_b64_tr_b16 v[42:43], v6 offset:29184
v_mfma_f32_16x16x32_bf16 v[76:79], v[44:47], v[180:183], v[76:79]
s_waitcnt lgkmcnt(6)
v_mfma_f32_16x16x32_bf16 v[80:83], v[16:19], v[176:179], v[80:83]
ds_read_b64_tr_b16 v[44:45], v11 offset:28672
ds_read_b64_tr_b16 v[46:47], v11 offset:29184
v_mfma_f32_16x16x32_bf16 v[84:87], v[16:19], v[180:183], v[84:87]
s_add_u32 s54, s54, 4096
buffer_load_dwordx4 v[240:243], v13, s[32:35], s54 offen offset:0 sc1
v_mfma_f32_16x16x32_bf16 v[88:91], v[20:23], v[176:179], v[88:91]
ds_read_b64_tr_b16 v[16:17], v4 offset:32768
ds_read_b64_tr_b16 v[18:19], v4 offset:33280
v_mfma_f32_16x16x32_bf16 v[92:95], v[20:23], v[180:183], v[92:95]
s_waitcnt vmcnt(13)
v_mfma_f32_16x16x32_bf16 v[48:51], v[24:27], v[184:187], v[48:51]
ds_read_b64_tr_b16 v[20:21], v9 offset:32768
ds_read_b64_tr_b16 v[22:23], v9 offset:33280
v_mfma_f32_16x16x32_bf16 v[52:55], v[24:27], v[188:191], v[52:55]
buffer_load_dwordx4 v[244:247], v13, s[32:35], s54 offen offset:256 sc1
v_mfma_f32_16x16x32_bf16 v[56:59], v[28:31], v[184:187], v[56:59]
ds_read_b64_tr_b16 v[24:25], v5 offset:32768
ds_read_b64_tr_b16 v[26:27], v5 offset:33280
v_mfma_f32_16x16x32_bf16 v[60:63], v[28:31], v[188:191], v[60:63]
s_waitcnt lgkmcnt(6)
v_mfma_f32_16x16x32_bf16 v[64:67], v[32:35], v[184:187], v[64:67]
ds_read_b64_tr_b16 v[28:29], v10 offset:32768
ds_read_b64_tr_b16 v[30:31], v10 offset:33280
v_mfma_f32_16x16x32_bf16 v[68:71], v[32:35], v[188:191], v[68:71]
buffer_load_dwordx4 v[248:251], v13, s[32:35], s54 offen offset:2048 sc1
v_mfma_f32_16x16x32_bf16 v[72:75], v[36:39], v[184:187], v[72:75]
ds_read_b64_tr_b16 v[32:33], v6 offset:32768
ds_read_b64_tr_b16 v[34:35], v6 offset:33280
v_mfma_f32_16x16x32_bf16 v[76:79], v[36:39], v[188:191], v[76:79]
v_mfma_f32_16x16x32_bf16 v[80:83], v[40:43], v[184:187], v[80:83]
ds_read_b64_tr_b16 v[36:37], v11 offset:32768
ds_read_b64_tr_b16 v[38:39], v11 offset:33280
v_mfma_f32_16x16x32_bf16 v[84:87], v[40:43], v[188:191], v[84:87]
buffer_load_dwordx4 v[252:255], v13, s[32:35], s54 offen offset:2304 sc1
v_mfma_f32_16x16x32_bf16 v[88:91], v[44:47], v[184:187], v[88:91]
ds_read_b64_tr_b16 v[40:41], v4 offset:36864
ds_read_b64_tr_b16 v[42:43], v4 offset:37376
v_mfma_f32_16x16x32_bf16 v[92:95], v[44:47], v[188:191], v[92:95]
s_waitcnt vmcnt(14) lgkmcnt(6)
v_mfma_f32_16x16x32_bf16 v[48:51], v[16:19], v[192:195], v[48:51]
ds_read_b64_tr_b16 v[44:45], v9 offset:36864
ds_read_b64_tr_b16 v[46:47], v9 offset:37376
v_mfma_f32_16x16x32_bf16 v[52:55], v[16:19], v[196:199], v[52:55]
buffer_store_dwordx4 v[96:99], v14, s[32:35], s90 offen offset:0
v_mfma_f32_16x16x32_bf16 v[56:59], v[20:23], v[192:195], v[56:59]
ds_read_b64_tr_b16 v[16:17], v5 offset:36864
ds_read_b64_tr_b16 v[18:19], v5 offset:37376
v_mfma_f32_16x16x32_bf16 v[60:63], v[20:23], v[196:199], v[60:63]
v_mfma_f32_16x16x32_bf16 v[64:67], v[24:27], v[192:195], v[64:67]
ds_read_b64_tr_b16 v[20:21], v10 offset:36864
ds_read_b64_tr_b16 v[22:23], v10 offset:37376
v_mfma_f32_16x16x32_bf16 v[68:71], v[24:27], v[196:199], v[68:71]
buffer_store_dwordx4 v[100:103], v14, s[32:35], s90 offen offset:128
v_mfma_f32_16x16x32_bf16 v[72:75], v[28:31], v[192:195], v[72:75]
ds_read_b64_tr_b16 v[24:25], v6 offset:36864
ds_read_b64_tr_b16 v[26:27], v6 offset:37376
v_mfma_f32_16x16x32_bf16 v[76:79], v[28:31], v[196:199], v[76:79]
s_waitcnt lgkmcnt(6)
v_mfma_f32_16x16x32_bf16 v[80:83], v[32:35], v[192:195], v[80:83]
ds_read_b64_tr_b16 v[28:29], v11 offset:36864
ds_read_b64_tr_b16 v[30:31], v11 offset:37376
v_mfma_f32_16x16x32_bf16 v[84:87], v[32:35], v[196:199], v[84:87]
s_lshl_b32 s86, s30, 5
s_add_u32 s86, s86, s31
s_lshl_b32 s86, s86, 6
s_add_u32 s86, s86, 21004288
v_lshrrev_b32 v2, 1, v8
s_mov_b64 exec, 0xff
buffer_store_dwordx2 a[240:241], v2, s[32:35], s86 offen sc1
s_mov_b64 exec, -1
v_mfma_f32_16x16x32_bf16 v[88:91], v[36:39], v[192:195], v[88:91]
ds_read_b64_tr_b16 v[32:33], v4 offset:40960
ds_read_b64_tr_b16 v[34:35], v4 offset:41472
v_mfma_f32_16x16x32_bf16 v[92:95], v[36:39], v[196:199], v[92:95]
s_waitcnt vmcnt(15)
v_mfma_f32_16x16x32_bf16 v[48:51], v[40:43], v[200:203], v[48:51]
ds_read_b64_tr_b16 v[36:37], v9 offset:40960
ds_read_b64_tr_b16 v[38:39], v9 offset:41472
v_mfma_f32_16x16x32_bf16 v[52:55], v[40:43], v[204:207], v[52:55]
s_mov_b32 s55, s81
buffer_load_dwordx4 v[128:131], v13, s[32:35], s55 offen offset:0 sc1
v_mfma_f32_16x16x32_bf16 v[56:59], v[44:47], v[200:203], v[56:59]
ds_read_b64_tr_b16 v[40:41], v5 offset:40960
ds_read_b64_tr_b16 v[42:43], v5 offset:41472
v_mfma_f32_16x16x32_bf16 v[60:63], v[44:47], v[204:207], v[60:63]
s_waitcnt lgkmcnt(6)
v_mfma_f32_16x16x32_bf16 v[64:67], v[16:19], v[200:203], v[64:67]
ds_read_b64_tr_b16 v[44:45], v10 offset:40960
ds_read_b64_tr_b16 v[46:47], v10 offset:41472
v_mfma_f32_16x16x32_bf16 v[68:71], v[16:19], v[204:207], v[68:71]
buffer_load_dwordx4 v[132:135], v13, s[32:35], s55 offen offset:256 sc1
v_mfma_f32_16x16x32_bf16 v[72:75], v[20:23], v[200:203], v[72:75]
ds_read_b64_tr_b16 v[16:17], v6 offset:40960
ds_read_b64_tr_b16 v[18:19], v6 offset:41472
v_mfma_f32_16x16x32_bf16 v[76:79], v[20:23], v[204:207], v[76:79]
v_mfma_f32_16x16x32_bf16 v[80:83], v[24:27], v[200:203], v[80:83]
ds_read_b64_tr_b16 v[20:21], v11 offset:40960
ds_read_b64_tr_b16 v[22:23], v11 offset:41472
v_mfma_f32_16x16x32_bf16 v[84:87], v[24:27], v[204:207], v[84:87]
buffer_load_dwordx4 v[136:139], v13, s[32:35], s55 offen offset:2048 sc1
v_mfma_f32_16x16x32_bf16 v[88:91], v[28:31], v[200:203], v[88:91]
ds_read_b64_tr_b16 v[24:25], v4 offset:45056
ds_read_b64_tr_b16 v[26:27], v4 offset:45568
v_mfma_f32_16x16x32_bf16 v[92:95], v[28:31], v[204:207], v[92:95]
s_waitcnt vmcnt(16) lgkmcnt(6)
v_mfma_f32_16x16x32_bf16 v[48:51], v[32:35], v[208:211], v[48:51]
ds_read_b64_tr_b16 v[28:29], v9 offset:45056
ds_read_b64_tr_b16 v[30:31], v9 offset:45568
v_mfma_f32_16x16x32_bf16 v[52:55], v[32:35], v[212:215], v[52:55]
buffer_load_dwordx4 v[140:143], v13, s[32:35], s55 offen offset:2304 sc1
v_mfma_f32_16x16x32_bf16 v[56:59], v[36:39], v[208:211], v[56:59]
ds_read_b64_tr_b16 v[32:33], v5 offset:45056
ds_read_b64_tr_b16 v[34:35], v5 offset:45568
v_mfma_f32_16x16x32_bf16 v[60:63], v[36:39], v[212:215], v[60:63]
v_mfma_f32_16x16x32_bf16 v[64:67], v[40:43], v[208:211], v[64:67]
ds_read_b64_tr_b16 v[36:37], v10 offset:45056
ds_read_b64_tr_b16 v[38:39], v10 offset:45568
v_mfma_f32_16x16x32_bf16 v[68:71], v[40:43], v[212:215], v[68:71]
s_add_u32 s55, s55, 4096
buffer_load_dwordx4 v[144:147], v13, s[32:35], s55 offen offset:0 sc1
v_mfma_f32_16x16x32_bf16 v[72:75], v[44:47], v[208:211], v[72:75]
ds_read_b64_tr_b16 v[40:41], v6 offset:45056
ds_read_b64_tr_b16 v[42:43], v6 offset:45568
v_mfma_f32_16x16x32_bf16 v[76:79], v[44:47], v[212:215], v[76:79]
s_waitcnt lgkmcnt(6)
v_mfma_f32_16x16x32_bf16 v[80:83], v[16:19], v[208:211], v[80:83]
ds_read_b64_tr_b16 v[44:45], v11 offset:45056
ds_read_b64_tr_b16 v[46:47], v11 offset:45568
v_mfma_f32_16x16x32_bf16 v[84:87], v[16:19], v[212:215], v[84:87]
buffer_load_dwordx4 v[148:151], v13, s[32:35], s55 offen offset:256 sc1
v_mfma_f32_16x16x32_bf16 v[88:91], v[20:23], v[208:211], v[88:91]
ds_read_b64_tr_b16 v[16:17], v4 offset:49152
ds_read_b64_tr_b16 v[18:19], v4 offset:49664
v_mfma_f32_16x16x32_bf16 v[92:95], v[20:23], v[212:215], v[92:95]
s_waitcnt vmcnt(17)
v_mfma_f32_16x16x32_bf16 v[48:51], v[24:27], v[216:219], v[48:51]
ds_read_b64_tr_b16 v[20:21], v9 offset:49152
ds_read_b64_tr_b16 v[22:23], v9 offset:49664
v_mfma_f32_16x16x32_bf16 v[52:55], v[24:27], v[220:223], v[52:55]
buffer_load_dwordx4 v[152:155], v13, s[32:35], s55 offen offset:2048 sc1
v_mfma_f32_16x16x32_bf16 v[56:59], v[28:31], v[216:219], v[56:59]
ds_read_b64_tr_b16 v[24:25], v5 offset:49152
ds_read_b64_tr_b16 v[26:27], v5 offset:49664
v_mfma_f32_16x16x32_bf16 v[60:63], v[28:31], v[220:223], v[60:63]
s_waitcnt lgkmcnt(6)
v_mfma_f32_16x16x32_bf16 v[64:67], v[32:35], v[216:219], v[64:67]
ds_read_b64_tr_b16 v[28:29], v10 offset:49152
ds_read_b64_tr_b16 v[30:31], v10 offset:49664
v_mfma_f32_16x16x32_bf16 v[68:71], v[32:35], v[220:223], v[68:71]
buffer_load_dwordx4 v[156:159], v13, s[32:35], s55 offen offset:2304 sc1
v_mfma_f32_16x16x32_bf16 v[72:75], v[36:39], v[216:219], v[72:75]
ds_read_b64_tr_b16 v[32:33], v6 offset:49152
ds_read_b64_tr_b16 v[34:35], v6 offset:49664
v_mfma_f32_16x16x32_bf16 v[76:79], v[36:39], v[220:223], v[76:79]
v_mfma_f32_16x16x32_bf16 v[80:83], v[40:43], v[216:219], v[80:83]
ds_read_b64_tr_b16 v[36:37], v11 offset:49152
ds_read_b64_tr_b16 v[38:39], v11 offset:49664
v_mfma_f32_16x16x32_bf16 v[84:87], v[40:43], v[220:223], v[84:87]
s_add_u32 s55, s55, 4096
buffer_load_dwordx4 v[160:163], v13, s[32:35], s55 offen offset:0 sc1
v_mfma_f32_16x16x32_bf16 v[88:91], v[44:47], v[216:219], v[88:91]
ds_read_b64_tr_b16 v[40:41], v4 offset:53248
ds_read_b64_tr_b16 v[42:43], v4 offset:53760
v_mfma_f32_16x16x32_bf16 v[92:95], v[44:47], v[220:223], v[92:95]
s_waitcnt vmcnt(18) lgkmcnt(6)
v_mfma_f32_16x16x32_bf16 v[48:51], v[16:19], v[224:227], v[48:51]
ds_read_b64_tr_b16 v[44:45], v9 offset:53248
ds_read_b64_tr_b16 v[46:47], v9 offset:53760
v_mfma_f32_16x16x32_bf16 v[52:55], v[16:19], v[228:231], v[52:55]
buffer_load_dwordx4 v[164:167], v13, s[32:35], s55 offen offset:256 sc1
v_mfma_f32_16x16x32_bf16 v[56:59], v[20:23], v[224:227], v[56:59]
ds_read_b64_tr_b16 v[16:17], v5 offset:53248
ds_read_b64_tr_b16 v[18:19], v5 offset:53760
v_mfma_f32_16x16x32_bf16 v[60:63], v[20:23], v[228:231], v[60:63]
v_mfma_f32_16x16x32_bf16 v[64:67], v[24:27], v[224:227], v[64:67]
ds_read_b64_tr_b16 v[20:21], v10 offset:53248
ds_read_b64_tr_b16 v[22:23], v10 offset:53760
v_mfma_f32_16x16x32_bf16 v[68:71], v[24:27], v[228:231], v[68:71]
buffer_load_dwordx4 v[168:171], v13, s[32:35], s55 offen offset:2048 sc1
v_mfma_f32_16x16x32_bf16 v[72:75], v[28:31], v[224:227], v[72:75]
ds_read_b64_tr_b16 v[24:25], v6 offset:53248
ds_read_b64_tr_b16 v[26:27], v6 offset:53760
v_mfma_f32_16x16x32_bf16 v[76:79], v[28:31], v[228:231], v[76:79]
s_waitcnt lgkmcnt(6)
v_mfma_f32_16x16x32_bf16 v[80:83], v[32:35], v[224:227], v[80:83]
ds_read_b64_tr_b16 v[28:29], v11 offset:53248
ds_read_b64_tr_b16 v[30:31], v11 offset:53760
v_mfma_f32_16x16x32_bf16 v[84:87], v[32:35], v[228:231], v[84:87]
buffer_load_dwordx4 v[172:175], v13, s[32:35], s55 offen offset:2304 sc1
v_mfma_f32_16x16x32_bf16 v[88:91], v[36:39], v[224:227], v[88:91]
ds_read_b64_tr_b16 v[32:33], v4 offset:57344
ds_read_b64_tr_b16 v[34:35], v4 offset:57856
v_mfma_f32_16x16x32_bf16 v[92:95], v[36:39], v[228:231], v[92:95]
s_waitcnt vmcnt(19)
v_mfma_f32_16x16x32_bf16 v[48:51], v[40:43], v[232:235], v[48:51]
ds_read_b64_tr_b16 v[36:37], v9 offset:57344
ds_read_b64_tr_b16 v[38:39], v9 offset:57856
v_mfma_f32_16x16x32_bf16 v[52:55], v[40:43], v[236:239], v[52:55]
s_add_u32 s55, s55, 4096
buffer_load_dwordx4 v[176:179], v13, s[32:35], s55 offen offset:0 sc1
v_mfma_f32_16x16x32_bf16 v[56:59], v[44:47], v[232:235], v[56:59]
ds_read_b64_tr_b16 v[40:41], v5 offset:57344
ds_read_b64_tr_b16 v[42:43], v5 offset:57856
v_mfma_f32_16x16x32_bf16 v[60:63], v[44:47], v[236:239], v[60:63]
s_waitcnt lgkmcnt(6)
v_mfma_f32_16x16x32_bf16 v[64:67], v[16:19], v[232:235], v[64:67]
ds_read_b64_tr_b16 v[44:45], v10 offset:57344
ds_read_b64_tr_b16 v[46:47], v10 offset:57856
v_mfma_f32_16x16x32_bf16 v[68:71], v[16:19], v[236:239], v[68:71]
buffer_load_dwordx4 v[180:183], v13, s[32:35], s55 offen offset:256 sc1
v_mfma_f32_16x16x32_bf16 v[72:75], v[20:23], v[232:235], v[72:75]
ds_read_b64_tr_b16 v[16:17], v6 offset:57344
ds_read_b64_tr_b16 v[18:19], v6 offset:57856
v_mfma_f32_16x16x32_bf16 v[76:79], v[20:23], v[236:239], v[76:79]
v_mfma_f32_16x16x32_bf16 v[80:83], v[24:27], v[232:235], v[80:83]
ds_read_b64_tr_b16 v[20:21], v11 offset:57344
ds_read_b64_tr_b16 v[22:23], v11 offset:57856
v_mfma_f32_16x16x32_bf16 v[84:87], v[24:27], v[236:239], v[84:87]
buffer_load_dwordx4 v[184:187], v13, s[32:35], s55 offen offset:2048 sc1
v_mfma_f32_16x16x32_bf16 v[88:91], v[28:31], v[232:235], v[88:91]
ds_read_b64_tr_b16 v[24:25], v4 offset:61440
ds_read_b64_tr_b16 v[26:27], v4 offset:61952
v_mfma_f32_16x16x32_bf16 v[92:95], v[28:31], v[236:239], v[92:95]
s_waitcnt vmcnt(20) lgkmcnt(6)
v_mfma_f32_16x16x32_bf16 v[48:51], v[32:35], v[240:243], v[48:51]
ds_read_b64_tr_b16 v[28:29], v9 offset:61440
ds_read_b64_tr_b16 v[30:31], v9 offset:61952
v_mfma_f32_16x16x32_bf16 v[52:55], v[32:35], v[244:247], v[52:55]
buffer_load_dwordx4 v[188:191], v13, s[32:35], s55 offen offset:2304 sc1
v_mfma_f32_16x16x32_bf16 v[56:59], v[36:39], v[240:243], v[56:59]
ds_read_b64_tr_b16 v[32:33], v5 offset:61440
ds_read_b64_tr_b16 v[34:35], v5 offset:61952
v_mfma_f32_16x16x32_bf16 v[60:63], v[36:39], v[244:247], v[60:63]
v_mfma_f32_16x16x32_bf16 v[64:67], v[40:43], v[240:243], v[64:67]
ds_read_b64_tr_b16 v[36:37], v10 offset:61440
ds_read_b64_tr_b16 v[38:39], v10 offset:61952
v_mfma_f32_16x16x32_bf16 v[68:71], v[40:43], v[244:247], v[68:71]
s_add_u32 s55, s55, 4096
buffer_load_dwordx4 v[192:195], v13, s[32:35], s55 offen offset:0 sc1
v_mfma_f32_16x16x32_bf16 v[72:75], v[44:47], v[240:243], v[72:75]
ds_read_b64_tr_b16 v[40:41], v6 offset:61440
ds_read_b64_tr_b16 v[42:43], v6 offset:61952
v_mfma_f32_16x16x32_bf16 v[76:79], v[44:47], v[244:247], v[76:79]
s_waitcnt lgkmcnt(6)
v_mfma_f32_16x16x32_bf16 v[80:83], v[16:19], v[240:243], v[80:83]
ds_read_b64_tr_b16 v[44:45], v11 offset:61440
ds_read_b64_tr_b16 v[46:47], v11 offset:61952
v_mfma_f32_16x16x32_bf16 v[84:87], v[16:19], v[244:247], v[84:87]
buffer_load_dwordx4 v[196:199], v13, s[32:35], s55 offen offset:256 sc1
v_mfma_f32_16x16x32_bf16 v[88:91], v[20:23], v[240:243], v[88:91]
ds_read_b64_tr_b16 v[16:17], v4 offset:0
ds_read_b64_tr_b16 v[18:19], v4 offset:512
v_mfma_f32_16x16x32_bf16 v[92:95], v[20:23], v[244:247], v[92:95]
s_waitcnt vmcnt(21)
v_mfma_f32_16x16x32_bf16 v[48:51], v[24:27], v[248:251], v[48:51]
ds_read_b64_tr_b16 v[20:21], v9 offset:0
ds_read_b64_tr_b16 v[22:23], v9 offset:512
v_mfma_f32_16x16x32_bf16 v[52:55], v[24:27], v[252:255], v[52:55]
buffer_load_dwordx4 v[200:203], v13, s[32:35], s55 offen offset:2048 sc1
v_mfma_f32_16x16x32_bf16 v[56:59], v[28:31], v[248:251], v[56:59]
ds_read_b64_tr_b16 v[24:25], v5 offset:0
ds_read_b64_tr_b16 v[26:27], v5 offset:512
v_mfma_f32_16x16x32_bf16 v[60:63], v[28:31], v[252:255], v[60:63]
s_waitcnt lgkmcnt(6)
v_mfma_f32_16x16x32_bf16 v[64:67], v[32:35], v[248:251], v[64:67]
ds_read_b64_tr_b16 v[28:29], v10 offset:0
ds_read_b64_tr_b16 v[30:31], v10 offset:512
v_mfma_f32_16x16x32_bf16 v[68:71], v[32:35], v[252:255], v[68:71]
buffer_load_dwordx4 v[204:207], v13, s[32:35], s55 offen offset:2304 sc1
v_mfma_f32_16x16x32_bf16 v[72:75], v[36:39], v[248:251], v[72:75]
ds_read_b64_tr_b16 v[32:33], v4 offset:4096
ds_read_b64_tr_b16 v[34:35], v4 offset:4608
v_mfma_f32_16x16x32_bf16 v[76:79], v[36:39], v[252:255], v[76:79]
v_mfma_f32_16x16x32_bf16 v[80:83], v[40:43], v[248:251], v[80:83]
ds_read_b64_tr_b16 v[36:37], v9 offset:4096
ds_read_b64_tr_b16 v[38:39], v9 offset:4608
v_mfma_f32_16x16x32_bf16 v[84:87], v[40:43], v[252:255], v[84:87]
s_add_u32 s55, s55, 4096
buffer_load_dwordx4 v[208:211], v13, s[32:35], s55 offen offset:0 sc1
v_mfma_f32_16x16x32_bf16 v[88:91], v[44:47], v[248:251], v[88:91]
ds_read_b64_tr_b16 v[40:41], v5 offset:4096
ds_read_b64_tr_b16 v[42:43], v5 offset:4608
v_mfma_f32_16x16x32_bf16 v[92:95], v[44:47], v[252:255], v[92:95]
s_waitcnt vmcnt(19) lgkmcnt(6)
v_exp_f32 v48, -v48
v_mfma_f32_16x16x32_bf16 v[96:99], v[16:19], v[128:131], 0
ds_read_b64_tr_b16 v[44:45], v10 offset:4096
ds_read_b64_tr_b16 v[46:47], v10 offset:4608
v_add_f32 v48, 1.0, v48
v_mfma_f32_16x16x32_bf16 v[100:103], v[16:19], v[132:135], 0
buffer_load_dwordx4 v[212:215], v13, s[32:35], s55 offen offset:256 sc1
v_exp_f32 v49, -v49
v_mfma_f32_16x16x32_bf16 v[104:107], v[20:23], v[128:131], 0
ds_read_b64_tr_b16 v[16:17], v4 offset:8192
ds_read_b64_tr_b16 v[18:19], v4 offset:8704
v_add_f32 v49, 1.0, v49
v_mfma_f32_16x16x32_bf16 v[108:111], v[20:23], v[132:135], 0
v_exp_f32 v50, -v50
v_mfma_f32_16x16x32_bf16 v[112:115], v[24:27], v[128:131], 0
ds_read_b64_tr_b16 v[20:21], v9 offset:8192
ds_read_b64_tr_b16 v[22:23], v9 offset:8704
v_add_f32 v50, 1.0, v50
v_mfma_f32_16x16x32_bf16 v[116:119], v[24:27], v[132:135], 0
buffer_load_dwordx4 v[216:219], v13, s[32:35], s55 offen offset:2048 sc1
v_exp_f32 v51, -v51
v_mfma_f32_16x16x32_bf16 v[120:123], v[28:31], v[128:131], 0
ds_read_b64_tr_b16 v[24:25], v5 offset:8192
ds_read_b64_tr_b16 v[26:27], v5 offset:8704
v_add_f32 v51, 1.0, v51
v_mfma_f32_16x16x32_bf16 v[124:127], v[28:31], v[132:135], 0
s_waitcnt vmcnt(19) lgkmcnt(6)
v_exp_f32 v52, -v52
v_mfma_f32_16x16x32_bf16 v[96:99], v[32:35], v[136:139], v[96:99]
ds_read_b64_tr_b16 v[28:29], v10 offset:8192
ds_read_b64_tr_b16 v[30:31], v10 offset:8704
v_add_f32 v52, 1.0, v52
v_mfma_f32_16x16x32_bf16 v[100:103], v[32:35], v[140:143], v[100:103]
buffer_load_dwordx4 v[220:223], v13, s[32:35], s55 offen offset:2304 sc1
v_exp_f32 v53, -v53
v_mfma_f32_16x16x32_bf16 v[104:107], v[36:39], v[136:139], v[104:107]
ds_read_b64_tr_b16 v[32:33], v4 offset:12288
ds_read_b64_tr_b16 v[34:35], v4 offset:12800
v_add_f32 v53, 1.0, v53
v_mfma_f32_16x16x32_bf16 v[108:111], v[36:39], v[140:143], v[108:111]
v_exp_f32 v54, -v54
v_mfma_f32_16x16x32_bf16 v[112:115], v[40:43], v[136:139], v[112:115]
ds_read_b64_tr_b16 v[36:37], v9 offset:12288
ds_read_b64_tr_b16 v[38:39], v9 offset:12800
v_add_f32 v54, 1.0, v54
v_mfma_f32_16x16x32_bf16 v[116:119], v[40:43], v[140:143], v[116:119]
s_add_u32 s55, s55, 4096
buffer_load_dwordx4 v[224:227], v13, s[32:35], s55 offen offset:0 sc1
v_mfma_f32_16x16x32_bf16 v[120:123], v[44:47], v[136:139], v[120:123]
ds_read_b64_tr_b16 v[40:41], v5 offset:12288
ds_read_b64_tr_b16 v[42:43], v5 offset:12800
v_mfma_f32_16x16x32_bf16 v[124:127], v[44:47], v[140:143], v[124:127]
s_waitcnt vmcnt(19) lgkmcnt(6)
v_exp_f32 v55, -v55
v_mfma_f32_16x16x32_bf16 v[96:99], v[16:19], v[144:147], v[96:99]
ds_read_b64_tr_b16 v[44:45], v10 offset:12288
ds_read_b64_tr_b16 v[46:47], v10 offset:12800
v_add_f32 v55, 1.0, v55
v_mfma_f32_16x16x32_bf16 v[100:103], v[16:19], v[148:151], v[100:103]
buffer_load_dwordx4 v[228:231], v13, s[32:35], s55 offen offset:256 sc1
v_rcp_f32 v48, v48
v_mfma_f32_16x16x32_bf16 v[104:107], v[20:23], v[144:147], v[104:107]
ds_read_b64_tr_b16 v[16:17], v4 offset:16384
ds_read_b64_tr_b16 v[18:19], v4 offset:16896
v_mul_f32 v48, v48, v56
v_mfma_f32_16x16x32_bf16 v[108:111], v[20:23], v[148:151], v[108:111]
v_exp_f32 v64, -v64
v_mfma_f32_16x16x32_bf16 v[112:115], v[24:27], v[144:147], v[112:115]
ds_read_b64_tr_b16 v[20:21], v9 offset:16384
ds_read_b64_tr_b16 v[22:23], v9 offset:16896
v_add_f32 v64, 1.0, v64
v_mfma_f32_16x16x32_bf16 v[116:119], v[24:27], v[148:151], v[116:119]
buffer_load_dwordx4 v[232:235], v13, s[32:35], s55 offen offset:2048 sc1
v_rcp_f32 v49, v49
v_mfma_f32_16x16x32_bf16 v[120:123], v[28:31], v[144:147], v[120:123]
ds_read_b64_tr_b16 v[24:25], v5 offset:16384
ds_read_b64_tr_b16 v[26:27], v5 offset:16896
v_mul_f32 v49, v49, v57
v_mfma_f32_16x16x32_bf16 v[124:127], v[28:31], v[148:151], v[124:127]
s_waitcnt vmcnt(19) lgkmcnt(6)
v_exp_f32 v65, -v65
v_mfma_f32_16x16x32_bf16 v[96:99], v[32:35], v[152:155], v[96:99]
ds_read_b64_tr_b16 v[28:29], v10 offset:16384
ds_read_b64_tr_b16 v[30:31], v10 offset:16896
v_add_f32 v65, 1.0, v65
v_mfma_f32_16x16x32_bf16 v[100:103], v[32:35], v[156:159], v[100:103]
buffer_load_dwordx4 v[236:239], v13, s[32:35], s55 offen offset:2304 sc1
v_rcp_f32 v50, v50
v_mfma_f32_16x16x32_bf16 v[104:107], v[36:39], v[152:155], v[104:107]
ds_read_b64_tr_b16 v[32:33], v4 offset:20480
ds_read_b64_tr_b16 v[34:35], v4 offset:20992
v_mul_f32 v50, v50, v58
v_mfma_f32_16x16x32_bf16 v[108:111], v[36:39], v[156:159], v[108:111]
v_exp_f32 v66, -v66
v_cvt_pk_bf16_f32 v48, v48, v49
v_mfma_f32_16x16x32_bf16 v[112:115], v[40:43], v[152:155], v[112:115]
ds_read_b64_tr_b16 v[36:37], v9 offset:20480
ds_read_b64_tr_b16 v[38:39], v9 offset:20992
v_add_f32 v66, 1.0, v66
v_mfma_f32_16x16x32_bf16 v[116:119], v[40:43], v[156:159], v[116:119]
s_add_u32 s55, s55, 4096
buffer_load_dwordx4 v[240:243], v13, s[32:35], s55 offen offset:0 sc1
v_mfma_f32_16x16x32_bf16 v[120:123], v[44:47], v[152:155], v[120:123]
ds_read_b64_tr_b16 v[40:41], v5 offset:20480
ds_read_b64_tr_b16 v[42:43], v5 offset:20992
v_mfma_f32_16x16x32_bf16 v[124:127], v[44:47], v[156:159], v[124:127]
s_waitcnt vmcnt(19) lgkmcnt(6)
v_rcp_f32 v51, v51
v_mfma_f32_16x16x32_bf16 v[96:99], v[16:19], v[160:163], v[96:99]
ds_read_b64_tr_b16 v[44:45], v10 offset:20480
ds_read_b64_tr_b16 v[46:47], v10 offset:20992
v_mul_f32 v51, v51, v59
v_mfma_f32_16x16x32_bf16 v[100:103], v[16:19], v[164:167], v[100:103]
buffer_load_dwordx4 v[244:247], v13, s[32:35], s55 offen offset:256 sc1
v_exp_f32 v67, -v67
v_mfma_f32_16x16x32_bf16 v[104:107], v[20:23], v[160:163], v[104:107]
ds_read_b64_tr_b16 v[16:17], v4 offset:24576
ds_read_b64_tr_b16 v[18:19], v4 offset:25088
v_add_f32 v67, 1.0, v67
v_mfma_f32_16x16x32_bf16 v[108:111], v[20:23], v[164:167], v[108:111]
v_rcp_f32 v52, v52
v_cvt_pk_bf16_f32 v49, v50, v51
v_mfma_f32_16x16x32_bf16 v[112:115], v[24:27], v[160:163], v[112:115]
ds_read_b64_tr_b16 v[20:21], v9 offset:24576
ds_read_b64_tr_b16 v[22:23], v9 offset:25088
v_mul_f32 v52, v52, v60
v_mfma_f32_16x16x32_bf16 v[116:119], v[24:27], v[164:167], v[116:119]
buffer_load_dwordx4 v[248:251], v13, s[32:35], s55 offen offset:2048 sc1
v_exp_f32 v68, -v68
v_mfma_f32_16x16x32_bf16 v[120:123], v[28:31], v[160:163], v[120:123]
ds_read_b64_tr_b16 v[24:25], v5 offset:24576
ds_read_b64_tr_b16 v[26:27], v5 offset:25088
v_add_f32 v68, 1.0, v68
v_mfma_f32_16x16x32_bf16 v[124:127], v[28:31], v[164:167], v[124:127]
s_waitcnt vmcnt(19) lgkmcnt(6)
v_rcp_f32 v53, v53
v_mfma_f32_16x16x32_bf16 v[96:99], v[32:35], v[168:171], v[96:99]
ds_read_b64_tr_b16 v[28:29], v10 offset:24576
ds_read_b64_tr_b16 v[30:31], v10 offset:25088
v_mul_f32 v53, v53, v61
v_mfma_f32_16x16x32_bf16 v[100:103], v[32:35], v[172:175], v[100:103]
buffer_load_dwordx4 v[252:255], v13, s[32:35], s55 offen offset:2304 sc1
v_exp_f32 v69, -v69
v_mfma_f32_16x16x32_bf16 v[104:107], v[36:39], v[168:171], v[104:107]
ds_read_b64_tr_b16 v[32:33], v4 offset:28672
ds_read_b64_tr_b16 v[34:35], v4 offset:29184
v_add_f32 v69, 1.0, v69
v_mfma_f32_16x16x32_bf16 v[108:111], v[36:39], v[172:175], v[108:111]
v_rcp_f32 v54, v54
v_cvt_pk_bf16_f32 v50, v52, v53
v_mfma_f32_16x16x32_bf16 v[112:115], v[40:43], v[168:171], v[112:115]
ds_read_b64_tr_b16 v[36:37], v9 offset:28672
ds_read_b64_tr_b16 v[38:39], v9 offset:29184
v_mul_f32 v54, v54, v62
v_mfma_f32_16x16x32_bf16 v[116:119], v[40:43], v[172:175], v[116:119]
s_add_u32 s100, s87, 0
buffer_load_dwordx4 a[0:3], v8, s[32:35], s100 offen offset:0 sc1
v_permlane16_swap_b32 v48, v50
v_mfma_f32_16x16x32_bf16 v[120:123], v[44:47], v[168:171], v[120:123]
ds_read_b64_tr_b16 v[40:41], v5 offset:28672
ds_read_b64_tr_b16 v[42:43], v5 offset:29184
v_mfma_f32_16x16x32_bf16 v[124:127], v[44:47], v[172:175], v[124:127]
s_waitcnt vmcnt(19) lgkmcnt(6)
v_exp_f32 v70, -v70
v_mfma_f32_16x16x32_bf16 v[96:99], v[16:19], v[176:179], v[96:99]
ds_read_b64_tr_b16 v[44:45], v10 offset:28672
ds_read_b64_tr_b16 v[46:47], v10 offset:29184
v_add_f32 v70, 1.0, v70
v_mfma_f32_16x16x32_bf16 v[100:103], v[16:19], v[180:183], v[100:103]
buffer_load_dwordx4 a[4:7], v8, s[32:35], s100 offen offset:1024 sc1
v_rcp_f32 v55, v55
v_mfma_f32_16x16x32_bf16 v[104:107], v[20:23], v[176:179], v[104:107]
ds_read_b64_tr_b16 v[16:17], v4 offset:32768
ds_read_b64_tr_b16 v[18:19], v4 offset:33280
v_mul_f32 v55, v55, v63
v_mfma_f32_16x16x32_bf16 v[108:111], v[20:23], v[180:183], v[108:111]
v_exp_f32 v71, -v71
v_cvt_pk_bf16_f32 v51, v54, v55
v_mfma_f32_16x16x32_bf16 v[112:115], v[24:27], v[176:179], v[112:115]
ds_read_b64_tr_b16 v[20:21], v9 offset:32768
ds_read_b64_tr_b16 v[22:23], v9 offset:33280
v_add_f32 v71, 1.0, v71
v_mfma_f32_16x16x32_bf16 v[116:119], v[24:27], v[180:183], v[116:119]
buffer_load_dwordx4 a[8:11], v8, s[32:35], s100 offen offset:2048 sc1
v_rcp_f32 v64, v64
v_mfma_f32_16x16x32_bf16 v[120:123], v[28:31], v[176:179], v[120:123]
ds_read_b64_tr_b16 v[24:25], v5 offset:32768
ds_read_b64_tr_b16 v[26:27], v5 offset:33280
v_mul_f32 v64, v64, v72
v_mfma_f32_16x16x32_bf16 v[124:127], v[28:31], v[180:183], v[124:127]
s_waitcnt vmcnt(19) lgkmcnt(6)
v_exp_f32 v80, -v80
v_mfma_f32_16x16x32_bf16 v[96:99], v[32:35], v[184:187], v[96:99]
ds_read_b64_tr_b16 v[28:29], v10 offset:32768
ds_read_b64_tr_b16 v[30:31], v10 offset:33280
v_add_f32 v80, 1.0, v80
v_mfma_f32_16x16x32_bf16 v[100:103], v[32:35], v[188:191], v[100:103]
buffer_load_dwordx4 a[12:15], v8, s[32:35], s100 offen offset:3072 sc1
v_rcp_f32 v65, v65
v_mfma_f32_16x16x32_bf16 v[104:107], v[36:39], v[184:187], v[104:107]
ds_read_b64_tr_b16 v[32:33], v4 offset:36864
ds_read_b64_tr_b16 v[34:35], v4 offset:37376
v_mul_f32 v65, v65, v73
v_mfma_f32_16x16x32_bf16 v[108:111], v[36:39], v[188:191], v[108:111]
v_exp_f32 v81, -v81
v_permlane16_swap_b32 v49, v51
v_mfma_f32_16x16x32_bf16 v[112:115], v[40:43], v[184:187], v[112:115]
ds_read_b64_tr_b16 v[36:37], v9 offset:36864
ds_read_b64_tr_b16 v[38:39], v9 offset:37376
v_add_f32 v81, 1.0, v81
v_mfma_f32_16x16x32_bf16 v[116:119], v[40:43], v[188:191], v[116:119]
s_add_u32 s100, s87, 4096
buffer_load_dwordx4 a[16:19], v8, s[32:35], s100 offen offset:0 sc1
v_cvt_pk_bf16_f32 v64, v64, v65
v_mfma_f32_16x16x32_bf16 v[120:123], v[44:47], v[184:187], v[120:123]
ds_read_b64_tr_b16 v[40:41], v5 offset:36864
ds_read_b64_tr_b16 v[42:43], v5 offset:37376
v_mfma_f32_16x16x32_bf16 v[124:127], v[44:47], v[188:191], v[124:127]
buffer_store_dwordx4 v[48:51], v8, s[32:35], s72 offen sc1
s_waitcnt vmcnt(20) lgkmcnt(6)
v_mfma_f32_16x16x32_bf16 v[96:99], v[16:19], v[192:195], v[96:99]
ds_read_b64_tr_b16 v[44:45], v10 offset:36864
ds_read_b64_tr_b16 v[46:47], v10 offset:37376
v_mfma_f32_16x16x32_bf16 v[100:103], v[16:19], v[196:199], v[100:103]
buffer_load_dwordx4 a[20:23], v8, s[32:35], s100 offen offset:1024 sc1
v_rcp_f32 v66, v66
v_mfma_f32_16x16x32_bf16 v[104:107], v[20:23], v[192:195], v[104:107]
ds_read_b64_tr_b16 v[16:17], v4 offset:40960
ds_read_b64_tr_b16 v[18:19], v4 offset:41472
v_mul_f32 v66, v66, v74
v_mfma_f32_16x16x32_bf16 v[108:111], v[20:23], v[196:199], v[108:111]
v_exp_f32 v82, -v82
v_mfma_f32_16x16x32_bf16 v[112:115], v[24:27], v[192:195], v[112:115]
ds_read_b64_tr_b16 v[20:21], v9 offset:40960
ds_read_b64_tr_b16 v[22:23], v9 offset:41472
v_add_f32 v82, 1.0, v82
v_mfma_f32_16x16x32_bf16 v[116:119], v[24:27], v[196:199], v[116:119]
buffer_load_dwordx4 a[24:27], v8, s[32:35], s100 offen offset:2048 sc1
v_rcp_f32 v67, v67
v_mfma_f32_16x16x32_bf16 v[120:123], v[28:31], v[192:195], v[120:123]
ds_read_b64_tr_b16 v[24:25], v5 offset:40960
ds_read_b64_tr_b16 v[26:27], v5 offset:41472
v_mul_f32 v67, v67, v75
v_mfma_f32_16x16x32_bf16 v[124:127], v[28:31], v[196:199], v[124:127]
s_waitcnt vmcnt(20) lgkmcnt(6)
v_exp_f32 v83, -v83
v_mfma_f32_16x16x32_bf16 v[96:99], v[32:35], v[200:203], v[96:99]
ds_read_b64_tr_b16 v[28:29], v10 offset:40960
ds_read_b64_tr_b16 v[30:31], v10 offset:41472
v_add_f32 v83, 1.0, v83
v_mfma_f32_16x16x32_bf16 v[100:103], v[32:35], v[204:207], v[100:103]
buffer_load_dwordx4 a[28:31], v8, s[32:35], s100 offen offset:3072 sc1
v_rcp_f32 v68, v68
v_mfma_f32_16x16x32_bf16 v[104:107], v[36:39], v[200:203], v[104:107]
ds_read_b64_tr_b16 v[32:33], v4 offset:45056
ds_read_b64_tr_b16 v[34:35], v4 offset:45568
v_mul_f32 v68, v68, v76
v_mfma_f32_16x16x32_bf16 v[108:111], v[36:39], v[204:207], v[108:111]
v_exp_f32 v84, -v84
v_cvt_pk_bf16_f32 v65, v66, v67
v_mfma_f32_16x16x32_bf16 v[112:115], v[40:43], v[200:203], v[112:115]
ds_read_b64_tr_b16 v[36:37], v9 offset:45056
ds_read_b64_tr_b16 v[38:39], v9 offset:45568
v_add_f32 v84, 1.0, v84
v_mfma_f32_16x16x32_bf16 v[116:119], v[40:43], v[204:207], v[116:119]
s_add_u32 s100, s87, 8192
buffer_load_dwordx4 a[32:35], v8, s[32:35], s100 offen offset:0 sc1
v_mfma_f32_16x16x32_bf16 v[120:123], v[44:47], v[200:203], v[120:123]
ds_read_b64_tr_b16 v[40:41], v5 offset:45056
ds_read_b64_tr_b16 v[42:43], v5 offset:45568
v_mfma_f32_16x16x32_bf16 v[124:127], v[44:47], v[204:207], v[124:127]
s_waitcnt vmcnt(20) lgkmcnt(6)
v_rcp_f32 v69, v69
v_mfma_f32_16x16x32_bf16 v[96:99], v[16:19], v[208:211], v[96:99]
ds_read_b64_tr_b16 v[44:45], v10 offset:45056
ds_read_b64_tr_b16 v[46:47], v10 offset:45568
v_mul_f32 v69, v69, v77
v_mfma_f32_16x16x32_bf16 v[100:103], v[16:19], v[212:215], v[100:103]
buffer_load_dwordx4 a[36:39], v8, s[32:35], s100 offen offset:1024 sc1
v_exp_f32 v85, -v85
v_mfma_f32_16x16x32_bf16 v[104:107], v[20:23], v[208:211], v[104:107]
ds_read_b64_tr_b16 v[16:17], v4 offset:49152
ds_read_b64_tr_b16 v[18:19], v4 offset:49664
v_add_f32 v85, 1.0, v85
v_mfma_f32_16x16x32_bf16 v[108:111], v[20:23], v[212:215], v[108:111]
v_rcp_f32 v70, v70
v_cvt_pk_bf16_f32 v66, v68, v69
v_mfma_f32_16x16x32_bf16 v[112:115], v[24:27], v[208:211], v[112:115]
ds_read_b64_tr_b16 v[20:21], v9 offset:49152
ds_read_b64_tr_b16 v[22:23], v9 offset:49664
v_mul_f32 v70, v70, v78
v_mfma_f32_16x16x32_bf16 v[116:119], v[24:27], v[212:215], v[116:119]
buffer_load_dwordx4 a[40:43], v8, s[32:35], s100 offen offset:2048 sc1
v_exp_f32 v86, -v86
v_mfma_f32_16x16x32_bf16 v[120:123], v[28:31], v[208:211], v[120:123]
ds_read_b64_tr_b16 v[24:25], v5 offset:49152
ds_read_b64_tr_b16 v[26:27], v5 offset:49664
v_add_f32 v86, 1.0, v86
v_mfma_f32_16x16x32_bf16 v[124:127], v[28:31], v[212:215], v[124:127]
s_waitcnt vmcnt(20) lgkmcnt(6)
v_rcp_f32 v71, v71
v_mfma_f32_16x16x32_bf16 v[96:99], v[32:35], v[216:219], v[96:99]
ds_read_b64_tr_b16 v[28:29], v10 offset:49152
ds_read_b64_tr_b16 v[30:31], v10 offset:49664
v_mul_f32 v71, v71, v79
v_mfma_f32_16x16x32_bf16 v[100:103], v[32:35], v[220:223], v[100:103]
buffer_load_dwordx4 a[44:47], v8, s[32:35], s100 offen offset:3072 sc1
v_exp_f32 v87, -v87
v_mfma_f32_16x16x32_bf16 v[104:107], v[36:39], v[216:219], v[104:107]
ds_read_b64_tr_b16 v[32:33], v4 offset:53248
ds_read_b64_tr_b16 v[34:35], v4 offset:53760
v_add_f32 v87, 1.0, v87
v_mfma_f32_16x16x32_bf16 v[108:111], v[36:39], v[220:223], v[108:111]
v_rcp_f32 v80, v80
v_cvt_pk_bf16_f32 v67, v70, v71
v_mfma_f32_16x16x32_bf16 v[112:115], v[40:43], v[216:219], v[112:115]
ds_read_b64_tr_b16 v[36:37], v9 offset:53248
ds_read_b64_tr_b16 v[38:39], v9 offset:53760
v_mul_f32 v80, v80, v88
v_mfma_f32_16x16x32_bf16 v[116:119], v[40:43], v[220:223], v[116:119]
s_add_u32 s100, s87, 12288
buffer_load_dwordx4 a[48:51], v8, s[32:35], s100 offen offset:0 sc1
v_permlane16_swap_b32 v64, v66
v_mfma_f32_16x16x32_bf16 v[120:123], v[44:47], v[216:219], v[120:123]
ds_read_b64_tr_b16 v[40:41], v5 offset:53248
ds_read_b64_tr_b16 v[42:43], v5 offset:53760
v_permlane16_swap_b32 v65, v67
v_mfma_f32_16x16x32_bf16 v[124:127], v[44:47], v[220:223], v[124:127]
buffer_store_dwordx4 v[64:67], v8, s[32:35], s73 offen sc1
s_waitcnt vmcnt(21) lgkmcnt(6)
v_mfma_f32_16x16x32_bf16 v[96:99], v[16:19], v[224:227], v[96:99]
ds_read_b64_tr_b16 v[44:45], v10 offset:53248
ds_read_b64_tr_b16 v[46:47], v10 offset:53760
v_mfma_f32_16x16x32_bf16 v[100:103], v[16:19], v[228:231], v[100:103]
buffer_load_dwordx4 a[52:55], v8, s[32:35], s100 offen offset:1024 sc1
v_rcp_f32 v81, v81
v_mfma_f32_16x16x32_bf16 v[104:107], v[20:23], v[224:227], v[104:107]
ds_read_b64_tr_b16 v[16:17], v4 offset:57344
ds_read_b64_tr_b16 v[18:19], v4 offset:57856
v_mul_f32 v81, v81, v89
v_mfma_f32_16x16x32_bf16 v[108:111], v[20:23], v[228:231], v[108:111]
v_rcp_f32 v82, v82
v_cvt_pk_bf16_f32 v80, v80, v81
v_mfma_f32_16x16x32_bf16 v[112:115], v[24:27], v[224:227], v[112:115]
ds_read_b64_tr_b16 v[20:21], v9 offset:57344
ds_read_b64_tr_b16 v[22:23], v9 offset:57856
v_mul_f32 v82, v82, v90
v_mfma_f32_16x16x32_bf16 v[116:119], v[24:27], v[228:231], v[116:119]
buffer_load_dwordx4 a[56:59], v8, s[32:35], s100 offen offset:2048 sc1
v_rcp_f32 v83, v83
v_mfma_f32_16x16x32_bf16 v[120:123], v[28:31], v[224:227], v[120:123]
ds_read_b64_tr_b16 v[24:25], v5 offset:57344
ds_read_b64_tr_b16 v[26:27], v5 offset:57856
v_mul_f32 v83, v83, v91
v_mfma_f32_16x16x32_bf16 v[124:127], v[28:31], v[228:231], v[124:127]
s_waitcnt vmcnt(21) lgkmcnt(6)
v_rcp_f32 v84, v84
v_mfma_f32_16x16x32_bf16 v[96:99], v[32:35], v[232:235], v[96:99]
ds_read_b64_tr_b16 v[28:29], v10 offset:57344
ds_read_b64_tr_b16 v[30:31], v10 offset:57856
v_mul_f32 v84, v84, v92
v_mfma_f32_16x16x32_bf16 v[100:103], v[32:35], v[236:239], v[100:103]
buffer_load_dwordx4 a[60:63], v8, s[32:35], s100 offen offset:3072 sc1
v_rcp_f32 v85, v85
v_mfma_f32_16x16x32_bf16 v[104:107], v[36:39], v[232:235], v[104:107]
ds_read_b64_tr_b16 v[32:33], v4 offset:61440
ds_read_b64_tr_b16 v[34:35], v4 offset:61952
v_mul_f32 v85, v85, v93
v_mfma_f32_16x16x32_bf16 v[108:111], v[36:39], v[236:239], v[108:111]
v_rcp_f32 v86, v86
v_cvt_pk_bf16_f32 v81, v82, v83
v_mfma_f32_16x16x32_bf16 v[112:115], v[40:43], v[232:235], v[112:115]
ds_read_b64_tr_b16 v[36:37], v9 offset:61440
ds_read_b64_tr_b16 v[38:39], v9 offset:61952
v_mul_f32 v86, v86, v94
v_mfma_f32_16x16x32_bf16 v[116:119], v[40:43], v[236:239], v[116:119]
s_add_u32 s100, s87, 16384
buffer_load_dwordx4 a[64:67], v8, s[32:35], s100 offen offset:0 sc1
v_cvt_pk_bf16_f32 v82, v84, v85
v_mfma_f32_16x16x32_bf16 v[120:123], v[44:47], v[232:235], v[120:123]
ds_read_b64_tr_b16 v[40:41], v5 offset:61440
ds_read_b64_tr_b16 v[42:43], v5 offset:61952
v_permlane16_swap_b32 v80, v82
v_mfma_f32_16x16x32_bf16 v[124:127], v[44:47], v[236:239], v[124:127]
s_waitcnt vmcnt(21) lgkmcnt(6)
v_rcp_f32 v87, v87
v_mfma_f32_16x16x32_bf16 v[96:99], v[16:19], v[240:243], v[96:99]
ds_read_b64_tr_b16 v[44:45], v10 offset:61440
ds_read_b64_tr_b16 v[46:47], v10 offset:61952
v_mul_f32 v87, v87, v95
v_mfma_f32_16x16x32_bf16 v[100:103], v[16:19], v[244:247], v[100:103]
buffer_load_dwordx4 a[68:71], v8, s[32:35], s100 offen offset:1024 sc1
v_cvt_pk_bf16_f32 v83, v86, v87
v_mfma_f32_16x16x32_bf16 v[104:107], v[20:23], v[240:243], v[104:107]
ds_read_b64_tr_b16 v[16:17], v6 offset:0
ds_read_b64_tr_b16 v[18:19], v6 offset:512
v_permlane16_swap_b32 v81, v83
v_mfma_f32_16x16x32_bf16 v[108:111], v[20:23], v[244:247], v[108:111]
buffer_store_dwordx4 v[80:83], v8, s[32:35], s74 offen sc1
v_mfma_f32_16x16x32_bf16 v[112:115], v[24:27], v[240:243], v[112:115]
ds_read_b64_tr_b16 v[20:21], v11 offset:0
ds_read_b64_tr_b16 v[22:23], v11 offset:512
v_mfma_f32_16x16x32_bf16 v[116:119], v[24:27], v[244:247], v[116:119]
buffer_load_dwordx4 a[72:75], v8, s[32:35], s100 offen offset:2048 sc1
v_mfma_f32_16x16x32_bf16 v[120:123], v[28:31], v[240:243], v[120:123]
ds_read_b64_tr_b16 v[24:25], v6 offset:4096
ds_read_b64_tr_b16 v[26:27], v6 offset:4608
v_mfma_f32_16x16x32_bf16 v[124:127], v[28:31], v[244:247], v[124:127]
s_waitcnt vmcnt(22) lgkmcnt(6)
v_mfma_f32_16x16x32_bf16 v[96:99], v[32:35], v[248:251], v[96:99]
ds_read_b64_tr_b16 v[28:29], v11 offset:4096
ds_read_b64_tr_b16 v[30:31], v11 offset:4608
v_mfma_f32_16x16x32_bf16 v[100:103], v[32:35], v[252:255], v[100:103]
buffer_load_dwordx4 a[76:79], v8, s[32:35], s100 offen offset:3072 sc1
v_mfma_f32_16x16x32_bf16 v[104:107], v[36:39], v[248:251], v[104:107]
ds_read_b64_tr_b16 v[32:33], v6 offset:8192
ds_read_b64_tr_b16 v[34:35], v6 offset:8704
v_mfma_f32_16x16x32_bf16 v[108:111], v[36:39], v[252:255], v[108:111]
v_mfma_f32_16x16x32_bf16 v[112:115], v[40:43], v[248:251], v[112:115]
ds_read_b64_tr_b16 v[36:37], v11 offset:8192
ds_read_b64_tr_b16 v[38:39], v11 offset:8704
v_mfma_f32_16x16x32_bf16 v[116:119], v[40:43], v[252:255], v[116:119]
s_lshr_b32 s86, s31, 2
s_lshl_b32 s86, s86, 7
s_add_u32 s86, s86, s93
v_and_b32 v3, 3, v1
v_lshlrev_b32 v3, 10, v3
buffer_load_dword v3, v3, s[32:35], s86 offen sc1
v_mfma_f32_16x16x32_bf16 v[120:123], v[44:47], v[248:251], v[120:123]
ds_read_b64_tr_b16 v[40:41], v6 offset:12288
ds_read_b64_tr_b16 v[42:43], v6 offset:12800
v_mfma_f32_16x16x32_bf16 v[124:127], v[44:47], v[252:255], v[124:127]
s_waitcnt lgkmcnt(6)
v_mfma_f32_16x16x32_bf16 v[48:51], v[16:19], v[128:131], 0
ds_read_b64_tr_b16 v[44:45], v11 offset:12288
ds_read_b64_tr_b16 v[46:47], v11 offset:12800
v_mfma_f32_16x16x32_bf16 v[52:55], v[16:19], v[132:135], 0
s_add_u32 s100, s87, 20480
buffer_load_dwordx4 a[80:83], v8, s[32:35], s100 offen offset:0 sc1
v_mfma_f32_16x16x32_bf16 v[56:59], v[20:23], v[128:131], 0
ds_read_b64_tr_b16 v[16:17], v6 offset:16384
ds_read_b64_tr_b16 v[18:19], v6 offset:16896
v_mfma_f32_16x16x32_bf16 v[60:63], v[20:23], v[132:135], 0
v_exp_f32 v96, -v96
v_mfma_f32_16x16x32_bf16 v[48:51], v[24:27], v[136:139], v[48:51]
ds_read_b64_tr_b16 v[20:21], v11 offset:16384
ds_read_b64_tr_b16 v[22:23], v11 offset:16896
v_add_f32 v96, 1.0, v96
v_mfma_f32_16x16x32_bf16 v[52:55], v[24:27], v[140:143], v[52:55]
buffer_load_dwordx4 a[84:87], v8, s[32:35], s100 offen offset:1024 sc1
v_exp_f32 v97, -v97
v_mfma_f32_16x16x32_bf16 v[56:59], v[28:31], v[136:139], v[56:59]
ds_read_b64_tr_b16 v[24:25], v6 offset:20480
ds_read_b64_tr_b16 v[26:27], v6 offset:20992
v_add_f32 v97, 1.0, v97
v_mfma_f32_16x16x32_bf16 v[60:63], v[28:31], v[140:143], v[60:63]
s_waitcnt lgkmcnt(6)
v_exp_f32 v98, -v98
v_mfma_f32_16x16x32_bf16 v[48:51], v[32:35], v[144:147], v[48:51]
ds_read_b64_tr_b16 v[28:29], v11 offset:20480
ds_read_b64_tr_b16 v[30:31], v11 offset:20992
v_add_f32 v98, 1.0, v98
v_mfma_f32_16x16x32_bf16 v[52:55], v[32:35], v[148:151], v[52:55]
buffer_load_dwordx4 a[88:91], v8, s[32:35], s100 offen offset:2048 sc1
v_exp_f32 v99, -v99
v_mfma_f32_16x16x32_bf16 v[56:59], v[36:39], v[144:147], v[56:59]
ds_read_b64_tr_b16 v[32:33], v6 offset:24576
ds_read_b64_tr_b16 v[34:35], v6 offset:25088
v_add_f32 v99, 1.0, v99
v_mfma_f32_16x16x32_bf16 v[60:63], v[36:39], v[148:151], v[60:63]
v_exp_f32 v100, -v100
v_mfma_f32_16x16x32_bf16 v[48:51], v[40:43], v[152:155], v[48:51]
ds_read_b64_tr_b16 v[36:37], v11 offset:24576
ds_read_b64_tr_b16 v[38:39], v11 offset:25088
v_add_f32 v100, 1.0, v100
v_mfma_f32_16x16x32_bf16 v[52:55], v[40:43], v[156:159], v[52:55]
buffer_load_dwordx4 a[92:95], v8, s[32:35], s100 offen offset:3072 sc1
v_exp_f32 v101, -v101
v_mfma_f32_16x16x32_bf16 v[56:59], v[44:47], v[152:155], v[56:59]
ds_read_b64_tr_b16 v[40:41], v6 offset:28672
ds_read_b64_tr_b16 v[42:43], v6 offset:29184
v_add_f32 v101, 1.0, v101
v_mfma_f32_16x16x32_bf16 v[60:63], v[44:47], v[156:159], v[60:63]
s_waitcnt lgkmcnt(6)
v_exp_f32 v102, -v102
v_mfma_f32_16x16x32_bf16 v[48:51], v[16:19], v[160:163], v[48:51]
ds_read_b64_tr_b16 v[44:45], v11 offset:28672
ds_read_b64_tr_b16 v[46:47], v11 offset:29184
v_add_f32 v102, 1.0, v102
v_mfma_f32_16x16x32_bf16 v[52:55], v[16:19], v[164:167], v[52:55]
s_add_u32 s100, s87, 24576
buffer_load_dwordx4 a[96:99], v8, s[32:35], s100 offen offset:0 sc1
v_mfma_f32_16x16x32_bf16 v[56:59], v[20:23], v[160:163], v[56:59]
ds_read_b64_tr_b16 v[16:17], v6 offset:32768
ds_read_b64_tr_b16 v[18:19], v6 offset:33280
v_mfma_f32_16x16x32_bf16 v[60:63], v[20:23], v[164:167], v[60:63]
v_exp_f32 v103, -v103
v_mfma_f32_16x16x32_bf16 v[48:51], v[24:27], v[168:171], v[48:51]
ds_read_b64_tr_b16 v[20:21], v11 offset:32768
ds_read_b64_tr_b16 v[22:23], v11 offset:33280
v_add_f32 v103, 1.0, v103
v_mfma_f32_16x16x32_bf16 v[52:55], v[24:27], v[172:175], v[52:55]
buffer_load_dwordx4 a[100:103], v8, s[32:35], s100 offen offset:1024 sc1
v_rcp_f32 v96, v96
v_mfma_f32_16x16x32_bf16 v[56:59], v[28:31], v[168:171], v[56:59]
ds_read_b64_tr_b16 v[24:25], v6 offset:36864
ds_read_b64_tr_b16 v[26:27], v6 offset:37376
v_mul_f32 v96, v96, v104
v_mfma_f32_16x16x32_bf16 v[60:63], v[28:31], v[172:175], v[60:63]
s_waitcnt lgkmcnt(6)
v_exp_f32 v112, -v112
v_mfma_f32_16x16x32_bf16 v[48:51], v[32:35], v[176:179], v[48:51]
ds_read_b64_tr_b16 v[28:29], v11 offset:36864
ds_read_b64_tr_b16 v[30:31], v11 offset:37376
v_add_f32 v112, 1.0, v112
v_mfma_f32_16x16x32_bf16 v[52:55], v[32:35], v[180:183], v[52:55]
s_waitcnt vmcnt(9)
v_add_u32_e64 v2, s53, 4
s_cmp_eq_u32 s71, 1
s_cbranch_scc0 OS_37
buffer_store_dword v2, off, s[32:35], s99 offset:0
OSb_38:
v_mfma_f32_16x16x32_bf16 v[56:59], v[36:39], v[176:179], v[56:59]
ds_read_b64_tr_b16 v[32:33], v6 offset:40960
ds_read_b64_tr_b16 v[34:35], v6 offset:41472
v_mfma_f32_16x16x32_bf16 v[60:63], v[36:39], v[180:183], v[60:63]
buffer_load_dwordx4 a[104:107], v8, s[32:35], s100 offen offset:2048 sc1
v_rcp_f32 v97, v97
v_mfma_f32_16x16x32_bf16 v[48:51], v[40:43], v[184:187], v[48:51]
ds_read_b64_tr_b16 v[36:37], v11 offset:40960
ds_read_b64_tr_b16 v[38:39], v11 offset:41472
v_mul_f32 v97, v97, v105
v_mfma_f32_16x16x32_bf16 v[52:55], v[40:43], v[188:191], v[52:55]
v_exp_f32 v113, -v113
v_cvt_pk_bf16_f32 v96, v96, v97
v_mfma_f32_16x16x32_bf16 v[56:59], v[44:47], v[184:187], v[56:59]
ds_read_b64_tr_b16 v[40:41], v6 offset:45056
ds_read_b64_tr_b16 v[42:43], v6 offset:45568
v_add_f32 v113, 1.0, v113
v_mfma_f32_16x16x32_bf16 v[60:63], v[44:47], v[188:191], v[60:63]
buffer_load_dwordx4 a[108:111], v8, s[32:35], s100 offen offset:3072 sc1
s_waitcnt lgkmcnt(6)
v_mfma_f32_16x16x32_bf16 v[48:51], v[16:19], v[192:195], v[48:51]
ds_read_b64_tr_b16 v[44:45], v11 offset:45056
ds_read_b64_tr_b16 v[46:47], v11 offset:45568
v_mfma_f32_16x16x32_bf16 v[52:55], v[16:19], v[196:199], v[52:55]
v_rcp_f32 v98, v98
v_mfma_f32_16x16x32_bf16 v[56:59], v[20:23], v[192:195], v[56:59]
ds_read_b64_tr_b16 v[16:17], v6 offset:49152
ds_read_b64_tr_b16 v[18:19], v6 offset:49664
v_mul_f32 v98, v98, v106
v_mfma_f32_16x16x32_bf16 v[60:63], v[20:23], v[196:199], v[60:63]
s_add_u32 s100, s87, 28672
buffer_load_dwordx4 a[112:115], v8, s[32:35], s100 offen offset:0 sc1
v_mfma_f32_16x16x32_bf16 v[48:51], v[24:27], v[200:203], v[48:51]
ds_read_b64_tr_b16 v[20:21], v11 offset:49152
ds_read_b64_tr_b16 v[22:23], v11 offset:49664
v_mfma_f32_16x16x32_bf16 v[52:55], v[24:27], v[204:207], v[52:55]
v_exp_f32 v114, -v114
v_mfma_f32_16x16x32_bf16 v[56:59], v[28:31], v[200:203], v[56:59]
ds_read_b64_tr_b16 v[24:25], v6 offset:53248
ds_read_b64_tr_b16 v[26:27], v6 offset:53760
v_add_f32 v114, 1.0, v114
v_mfma_f32_16x16x32_bf16 v[60:63], v[28:31], v[204:207], v[60:63]
buffer_load_dwordx4 a[116:119], v8, s[32:35], s100 offen offset:1024 sc1
s_waitcnt lgkmcnt(6)
v_mfma_f32_16x16x32_bf16 v[48:51], v[32:35], v[208:211], v[48:51]
ds_read_b64_tr_b16 v[28:29], v11 offset:53248
ds_read_b64_tr_b16 v[30:31], v11 offset:53760
v_mfma_f32_16x16x32_bf16 v[52:55], v[32:35], v[212:215], v[52:55]
v_rcp_f32 v99, v99
v_mfma_f32_16x16x32_bf16 v[56:59], v[36:39], v[208:211], v[56:59]
ds_read_b64_tr_b16 v[32:33], v6 offset:57344
ds_read_b64_tr_b16 v[34:35], v6 offset:57856
v_mul_f32 v99, v99, v107
v_mfma_f32_16x16x32_bf16 v[60:63], v[36:39], v[212:215], v[60:63]
buffer_load_dwordx4 a[120:123], v8, s[32:35], s100 offen offset:2048 sc1
v_exp_f32 v115, -v115
v_mfma_f32_16x16x32_bf16 v[48:51], v[40:43], v[216:219], v[48:51]
ds_read_b64_tr_b16 v[36:37], v11 offset:57344
ds_read_b64_tr_b16 v[38:39], v11 offset:57856
v_add_f32 v115, 1.0, v115
v_mfma_f32_16x16x32_bf16 v[52:55], v[40:43], v[220:223], v[52:55]
v_rcp_f32 v100, v100
v_cvt_pk_bf16_f32 v97, v98, v99
v_mfma_f32_16x16x32_bf16 v[56:59], v[44:47], v[216:219], v[56:59]
ds_read_b64_tr_b16 v[40:41], v6 offset:61440
ds_read_b64_tr_b16 v[42:43], v6 offset:61952
v_mul_f32 v100, v100, v108
v_mfma_f32_16x16x32_bf16 v[60:63], v[44:47], v[220:223], v[60:63]
buffer_load_dwordx4 a[124:127], v8, s[32:35], s100 offen offset:3072 sc1
s_waitcnt lgkmcnt(6)
v_mfma_f32_16x16x32_bf16 v[48:51], v[16:19], v[224:227], v[48:51]
ds_read_b64_tr_b16 v[44:45], v11 offset:61440
ds_read_b64_tr_b16 v[46:47], v11 offset:61952
v_mfma_f32_16x16x32_bf16 v[52:55], v[16:19], v[228:231], v[52:55]
v_exp_f32 v116, -v116
v_mfma_f32_16x16x32_bf16 v[56:59], v[20:23], v[224:227], v[56:59]
ds_read_b64_tr_b16 v[16:17], v7 offset:0
ds_read_b64_tr_b16 v[18:19], v7 offset:512
v_add_f32 v116, 1.0, v116
v_mfma_f32_16x16x32_bf16 v[60:63], v[20:23], v[228:231], v[60:63]
s_add_u32 s100, s87, 32768
buffer_load_dwordx4 a[128:131], v8, s[32:35], s100 offen offset:0 sc1
v_mfma_f32_16x16x32_bf16 v[48:51], v[24:27], v[232:235], v[48:51]
ds_read_b64_tr_b16 v[20:21], v12 offset:0
ds_read_b64_tr_b16 v[22:23], v12 offset:512
v_mfma_f32_16x16x32_bf16 v[52:55], v[24:27], v[236:239], v[52:55]
v_rcp_f32 v101, v101
v_mfma_f32_16x16x32_bf16 v[56:59], v[28:31], v[232:235], v[56:59]
ds_read_b64_tr_b16 v[24:25], v7 offset:4096
ds_read_b64_tr_b16 v[26:27], v7 offset:4608
v_mul_f32 v101, v101, v109
v_mfma_f32_16x16x32_bf16 v[60:63], v[28:31], v[236:239], v[60:63]
buffer_load_dwordx4 a[132:135], v8, s[32:35], s100 offen offset:1024 sc1
s_waitcnt lgkmcnt(6)
v_cvt_pk_bf16_f32 v98, v100, v101
v_mfma_f32_16x16x32_bf16 v[48:51], v[32:35], v[240:243], v[48:51]
ds_read_b64_tr_b16 v[28:29], v12 offset:4096
ds_read_b64_tr_b16 v[30:31], v12 offset:4608
v_permlane16_swap_b32 v96, v98
v_mfma_f32_16x16x32_bf16 v[52:55], v[32:35], v[244:247], v[52:55]
v_exp_f32 v117, -v117
v_mfma_f32_16x16x32_bf16 v[56:59], v[36:39], v[240:243], v[56:59]
ds_read_b64_tr_b16 v[32:33], v7 offset:8192
ds_read_b64_tr_b16 v[34:35], v7 offset:8704
v_add_f32 v117, 1.0, v117
v_mfma_f32_16x16x32_bf16 v[60:63], v[36:39], v[244:247], v[60:63]
buffer_load_dwordx4 a[136:139], v8, s[32:35], s100 offen offset:2048 sc1
v_rcp_f32 v102, v102
v_mfma_f32_16x16x32_bf16 v[48:51], v[40:43], v[248:251], v[48:51]
ds_read_b64_tr_b16 v[36:37], v12 offset:8192
ds_read_b64_tr_b16 v[38:39], v12 offset:8704
v_mul_f32 v102, v102, v110
v_mfma_f32_16x16x32_bf16 v[52:55], v[40:43], v[252:255], v[52:55]
v_exp_f32 v118, -v118
v_mfma_f32_16x16x32_bf16 v[56:59], v[44:47], v[248:251], v[56:59]
ds_read_b64_tr_b16 v[40:41], v7 offset:12288
ds_read_b64_tr_b16 v[42:43], v7 offset:12800
v_add_f32 v118, 1.0, v118
v_mfma_f32_16x16x32_bf16 v[60:63], v[44:47], v[252:255], v[60:63]
buffer_load_dwordx4 a[140:143], v8, s[32:35], s100 offen offset:3072 sc1
s_waitcnt lgkmcnt(6)
v_mfma_f32_16x16x32_bf16 v[64:67], v[16:19], v[128:131], 0
ds_read_b64_tr_b16 v[44:45], v12 offset:12288
ds_read_b64_tr_b16 v[46:47], v12 offset:12800
v_mfma_f32_16x16x32_bf16 v[68:71], v[16:19], v[132:135], 0
v_rcp_f32 v103, v103
v_mfma_f32_16x16x32_bf16 v[72:75], v[20:23], v[128:131], 0
ds_read_b64_tr_b16 v[16:17], v7 offset:16384
ds_read_b64_tr_b16 v[18:19], v7 offset:16896
v_mul_f32 v103, v103, v111
v_mfma_f32_16x16x32_bf16 v[76:79], v[20:23], v[132:135], 0
s_add_u32 s100, s87, 36864
buffer_load_dwordx4 a[144:147], v8, s[32:35], s100 offen offset:0 sc1
v_cvt_pk_bf16_f32 v99, v102, v103
v_mfma_f32_16x16x32_bf16 v[64:67], v[24:27], v[136:139], v[64:67]
ds_read_b64_tr_b16 v[20:21], v12 offset:16384
ds_read_b64_tr_b16 v[22:23], v12 offset:16896
v_permlane16_swap_b32 v97, v99
v_mfma_f32_16x16x32_bf16 v[68:71], v[24:27], v[140:143], v[68:71]
buffer_store_dwordx4 v[96:99], v8, s[32:35], s75 offen sc1
v_mfma_f32_16x16x32_bf16 v[72:75], v[28:31], v[136:139], v[72:75]
ds_read_b64_tr_b16 v[24:25], v7 offset:20480
ds_read_b64_tr_b16 v[26:27], v7 offset:20992
v_mfma_f32_16x16x32_bf16 v[76:79], v[28:31], v[140:143], v[76:79]
buffer_load_dwordx4 a[148:151], v8, s[32:35], s100 offen offset:1024 sc1
s_waitcnt lgkmcnt(6)
v_mfma_f32_16x16x32_bf16 v[64:67], v[32:35], v[144:147], v[64:67]
ds_read_b64_tr_b16 v[28:29], v12 offset:20480
ds_read_b64_tr_b16 v[30:31], v12 offset:20992
v_mfma_f32_16x16x32_bf16 v[68:71], v[32:35], v[148:151], v[68:71]
v_exp_f32 v119, -v119
v_mfma_f32_16x16x32_bf16 v[72:75], v[36:39], v[144:147], v[72:75]
ds_read_b64_tr_b16 v[32:33], v7 offset:24576
ds_read_b64_tr_b16 v[34:35], v7 offset:25088
v_add_f32 v119, 1.0, v119
v_mfma_f32_16x16x32_bf16 v[76:79], v[36:39], v[148:151], v[76:79]
buffer_load_dwordx4 a[152:155], v8, s[32:35], s100 offen offset:2048 sc1
v_rcp_f32 v112, v112
v_mfma_f32_16x16x32_bf16 v[64:67], v[40:43], v[152:155], v[64:67]
ds_read_b64_tr_b16 v[36:37], v12 offset:24576
ds_read_b64_tr_b16 v[38:39], v12 offset:25088
v_mul_f32 v112, v112, v120
v_mfma_f32_16x16x32_bf16 v[68:71], v[40:43], v[156:159], v[68:71]
v_exp_f32 v48, -v48
v_mfma_f32_16x16x32_bf16 v[72:75], v[44:47], v[152:155], v[72:75]
ds_read_b64_tr_b16 v[40:41], v7 offset:28672
ds_read_b64_tr_b16 v[42:43], v7 offset:29184
v_add_f32 v48, 1.0, v48
v_mfma_f32_16x16x32_bf16 v[76:79], v[44:47], v[156:159], v[76:79]
buffer_load_dwordx4 a[156:159], v8, s[32:35], s100 offen offset:3072 sc1
s_waitcnt lgkmcnt(6)
v_mfma_f32_16x16x32_bf16 v[64:67], v[16:19], v[160:163], v[64:67]
ds_read_b64_tr_b16 v[44:45], v12 offset:28672
ds_read_b64_tr_b16 v[46:47], v12 offset:29184
v_mfma_f32_16x16x32_bf16 v[68:71], v[16:19], v[164:167], v[68:71]
v_rcp_f32 v113, v113
v_mfma_f32_16x16x32_bf16 v[72:75], v[20:23], v[160:163], v[72:75]
ds_read_b64_tr_b16 v[16:17], v7 offset:32768
ds_read_b64_tr_b16 v[18:19], v7 offset:33280
v_mul_f32 v113, v113, v121
v_mfma_f32_16x16x32_bf16 v[76:79], v[20:23], v[164:167], v[76:79]
s_add_u32 s100, s87, 40960
buffer_load_dwordx4 a[160:163], v8, s[32:35], s100 offen offset:0 sc1
v_cvt_pk_bf16_f32 v112, v112, v113
v_mfma_f32_16x16x32_bf16 v[64:67], v[24:27], v[168:171], v[64:67]
ds_read_b64_tr_b16 v[20:21], v12 offset:32768
ds_read_b64_tr_b16 v[22:23], v12 offset:33280
v_mfma_f32_16x16x32_bf16 v[68:71], v[24:27], v[172:175], v[68:71]
v_exp_f32 v49, -v49
v_mfma_f32_16x16x32_bf16 v[72:75], v[28:31], v[168:171], v[72:75]
ds_read_b64_tr_b16 v[24:25], v7 offset:36864
ds_read_b64_tr_b16 v[26:27], v7 offset:37376
v_add_f32 v49, 1.0, v49
v_mfma_f32_16x16x32_bf16 v[76:79], v[28:31], v[172:175], v[76:79]
buffer_load_dwordx4 a[164:167], v8, s[32:35], s100 offen offset:1024 sc1
s_waitcnt lgkmcnt(6)
v_mfma_f32_16x16x32_bf16 v[64:67], v[32:35], v[176:179], v[64:67]
ds_read_b64_tr_b16 v[28:29], v12 offset:36864
ds_read_b64_tr_b16 v[30:31], v12 offset:37376
v_mfma_f32_16x16x32_bf16 v[68:71], v[32:35], v[180:183], v[68:71]
v_rcp_f32 v114, v114
v_mfma_f32_16x16x32_bf16 v[72:75], v[36:39], v[176:179], v[72:75]
ds_read_b64_tr_b16 v[32:33], v7 offset:40960
ds_read_b64_tr_b16 v[34:35], v7 offset:41472
v_mul_f32 v114, v114, v122
v_mfma_f32_16x16x32_bf16 v[76:79], v[36:39], v[180:183], v[76:79]
buffer_load_dwordx4 a[168:171], v8, s[32:35], s100 offen offset:2048 sc1
v_exp_f32 v50, -v50
v_mfma_f32_16x16x32_bf16 v[64:67], v[40:43], v[184:187], v[64:67]
ds_read_b64_tr_b16 v[36:37], v12 offset:40960
ds_read_b64_tr_b16 v[38:39], v12 offset:41472
v_add_f32 v50, 1.0, v50
v_mfma_f32_16x16x32_bf16 v[68:71], v[40:43], v[188:191], v[68:71]
v_rcp_f32 v115, v115
v_mfma_f32_16x16x32_bf16 v[72:75], v[44:47], v[184:187], v[72:75]
ds_read_b64_tr_b16 v[40:41], v7 offset:45056
ds_read_b64_tr_b16 v[42:43], v7 offset:45568
v_mul_f32 v115, v115, v123
v_mfma_f32_16x16x32_bf16 v[76:79], v[44:47], v[188:191], v[76:79]
buffer_load_dwordx4 a[172:175], v8, s[32:35], s100 offen offset:3072 sc1
s_waitcnt lgkmcnt(6)
v_cvt_pk_bf16_f32 v113, v114, v115
v_mfma_f32_16x16x32_bf16 v[64:67], v[16:19], v[192:195], v[64:67]
ds_read_b64_tr_b16 v[44:45], v12 offset:45056
ds_read_b64_tr_b16 v[46:47], v12 offset:45568
v_mfma_f32_16x16x32_bf16 v[68:71], v[16:19], v[196:199], v[68:71]
v_exp_f32 v51, -v51
v_mfma_f32_16x16x32_bf16 v[72:75], v[20:23], v[192:195], v[72:75]
ds_read_b64_tr_b16 v[16:17], v7 offset:49152
ds_read_b64_tr_b16 v[18:19], v7 offset:49664
v_add_f32 v51, 1.0, v51
v_mfma_f32_16x16x32_bf16 v[76:79], v[20:23], v[196:199], v[76:79]
s_add_u32 s100, s87, 45056
buffer_load_dwordx4 a[176:179], v8, s[32:35], s100 offen offset:0 sc1
v_mfma_f32_16x16x32_bf16 v[64:67], v[24:27], v[200:203], v[64:67]
ds_read_b64_tr_b16 v[20:21], v12 offset:49152
ds_read_b64_tr_b16 v[22:23], v12 offset:49664
v_mfma_f32_16x16x32_bf16 v[68:71], v[24:27], v[204:207], v[68:71]
v_rcp_f32 v116, v116
v_mfma_f32_16x16x32_bf16 v[72:75], v[28:31], v[200:203], v[72:75]
ds_read_b64_tr_b16 v[24:25], v7 offset:53248
ds_read_b64_tr_b16 v[26:27], v7 offset:53760
v_mul_f32 v116, v116, v124
v_mfma_f32_16x16x32_bf16 v[76:79], v[28:31], v[204:207], v[76:79]
buffer_load_dwordx4 a[180:183], v8, s[32:35], s100 offen offset:1024 sc1
s_waitcnt lgkmcnt(6)
v_mfma_f32_16x16x32_bf16 v[64:67], v[32:35], v[208:211], v[64:67]
ds_read_b64_tr_b16 v[28:29], v12 offset:53248
ds_read_b64_tr_b16 v[30:31], v12 offset:53760
v_mfma_f32_16x16x32_bf16 v[68:71], v[32:35], v[212:215], v[68:71]
v_exp_f32 v52, -v52
v_mfma_f32_16x16x32_bf16 v[72:75], v[36:39], v[208:211], v[72:75]
ds_read_b64_tr_b16 v[32:33], v7 offset:57344
ds_read_b64_tr_b16 v[34:35], v7 offset:57856
v_add_f32 v52, 1.0, v52
v_mfma_f32_16x16x32_bf16 v[76:79], v[36:39], v[212:215], v[76:79]
buffer_load_dwordx4 a[184:187], v8, s[32:35], s100 offen offset:2048 sc1
v_rcp_f32 v117, v117
v_mfma_f32_16x16x32_bf16 v[64:67], v[40:43], v[216:219], v[64:67]
ds_read_b64_tr_b16 v[36:37], v12 offset:57344
ds_read_b64_tr_b16 v[38:39], v12 offset:57856
v_mul_f32 v117, v117, v125
v_mfma_f32_16x16x32_bf16 v[68:71], v[40:43], v[220:223], v[68:71]
v_exp_f32 v53, -v53
v_cvt_pk_bf16_f32 v114, v116, v117
v_mfma_f32_16x16x32_bf16 v[72:75], v[44:47], v[216:219], v[72:75]
ds_read_b64_tr_b16 v[40:41], v7 offset:61440
ds_read_b64_tr_b16 v[42:43], v7 offset:61952
v_add_f32 v53, 1.0, v53
v_mfma_f32_16x16x32_bf16 v[76:79], v[44:47], v[220:223], v[76:79]
buffer_load_dwordx4 a[188:191], v8, s[32:35], s100 offen offset:3072 sc1
s_waitcnt lgkmcnt(6)
v_permlane16_swap_b32 v112, v114
v_mfma_f32_16x16x32_bf16 v[64:67], v[16:19], v[224:227], v[64:67]
ds_read_b64_tr_b16 v[44:45], v12 offset:61440
ds_read_b64_tr_b16 v[46:47], v12 offset:61952
v_mfma_f32_16x16x32_bf16 v[68:71], v[16:19], v[228:231], v[68:71]
v_rcp_f32 v118, v118
v_mfma_f32_16x16x32_bf16 v[72:75], v[20:23], v[224:227], v[72:75]
v_exp_f32 v54, -v54
v_mul_f32 v118, v118, v126
v_mfma_f32_16x16x32_bf16 v[76:79], v[20:23], v[228:231], v[76:79]
s_add_u32 s100, s87, 49152
buffer_load_dwordx4 a[192:195], v8, s[32:35], s100 offen offset:0 sc1
v_add_f32 v54, 1.0, v54
v_mfma_f32_16x16x32_bf16 v[64:67], v[24:27], v[232:235], v[64:67]
v_rcp_f32 v119, v119
v_mfma_f32_16x16x32_bf16 v[68:71], v[24:27], v[236:239], v[68:71]
v_exp_f32 v55, -v55
v_mul_f32 v119, v119, v127
v_mfma_f32_16x16x32_bf16 v[72:75], v[28:31], v[232:235], v[72:75]
v_rcp_f32 v48, v48
v_add_f32 v55, 1.0, v55
v_mfma_f32_16x16x32_bf16 v[76:79], v[28:31], v[236:239], v[76:79]
buffer_load_dwordx4 a[196:199], v8, s[32:35], s100 offen offset:1024 sc1
s_waitcnt lgkmcnt(0)
v_mul_f32 v48, v48, v56
v_mfma_f32_16x16x32_bf16 v[64:67], v[32:35], v[240:243], v[64:67]
v_rcp_f32 v49, v49
v_cvt_pk_bf16_f32 v115, v118, v119
v_mfma_f32_16x16x32_bf16 v[68:71], v[32:35], v[244:247], v[68:71]
v_rcp_f32 v50, v50
v_mul_f32 v49, v49, v57
v_mfma_f32_16x16x32_bf16 v[72:75], v[36:39], v[240:243], v[72:75]
v_rcp_f32 v51, v51
v_mul_f32 v50, v50, v58
v_mfma_f32_16x16x32_bf16 v[76:79], v[36:39], v[244:247], v[76:79]
buffer_load_dwordx4 a[200:203], v8, s[32:35], s100 offen offset:2048 sc1
v_rcp_f32 v52, v52
v_mfma_f32_16x16x32_bf16 v[64:67], v[40:43], v[248:251], v[64:67]
v_rcp_f32 v53, v53
v_mul_f32 v51, v51, v59
v_mfma_f32_16x16x32_bf16 v[68:71], v[40:43], v[252:255], v[68:71]
v_accvgpr_read_b32 v14, a244
buffer_load_dword v15, v14, s[32:35], 0 offen sc1
v_permlane16_swap_b32 v113, v115
v_mfma_f32_16x16x32_bf16 v[72:75], v[44:47], v[248:251], v[72:75]
buffer_store_dwordx4 v[112:115], v8, s[32:35], s76 offen sc1
v_mul_f32 v52, v52, v60
v_mfma_f32_16x16x32_bf16 v[76:79], v[44:47], v[252:255], v[76:79]
buffer_load_dwordx4 a[204:207], v8, s[32:35], s100 offen offset:3072 sc1
v_rcp_f32 v54, v54
s_add_u32 s100, s87, 53248
buffer_load_dwordx4 a[208:211], v8, s[32:35], s100 offen offset:0 sc1
buffer_load_dwordx4 a[212:215], v8, s[32:35], s100 offen offset:1024 sc1
buffer_load_dwordx4 a[216:219], v8, s[32:35], s100 offen offset:2048 sc1
buffer_load_dwordx4 a[220:223], v8, s[32:35], s100 offen offset:3072 sc1
v_rcp_f32 v55, v55
v_mul_f32 v53, v53, v61
v_cvt_pk_bf16_f32 v48, v48, v49
v_mul_f32 v54, v54, v62
v_cvt_pk_bf16_f32 v49, v50, v51
v_mul_f32 v55, v55, v63
v_cvt_pk_bf16_f32 v50, v52, v53
v_cvt_pk_bf16_f32 v51, v54, v55
s_nop 0
v_permlane16_swap_b32 v48, v50
v_permlane16_swap_b32 v49, v51
buffer_store_dwordx4 v[48:51], v8, s[32:35], s77 offen sc1
G1j_34:
v_mov_b32 v5, v13
s_lshl_b32 s54, s52, 13
s_add_u32 s54, s54, 131072
v_lshrrev_b32 v12, 5, v1
v_lshlrev_b32 v13, 10, v12
v_bfe_u32 v14, v1, 4, 1
v_lshl_add_u32 v13, v14, 9, v13
v_and_b32 v14, 15, v1
v_lshl_add_u32 v5, v14, 4, v13
v_lshlrev_b32 v12, 7, v12
v_xor_b32 v12, v12, v5
v_add_u32 v4, s54, v12
v_and_b32 v12, 7, v1
v_lshrrev_b32 v13, 3, v1
s_lshl_b32 s54, s52, 7
v_lshl_add_u32 v6, v12, 4, s54
v_bfe_u32 v14, v13, 1, 1
v_lshlrev_b32 v14, 7, v14
v_xor_b32 v6, v6, v14
v_lshrrev_b32 v14, 1, v13
v_lshl_add_u32 v6, v14, 10, v6
v_and_b32 v14, 1, v13
v_lshl_add_u32 v6, v14, 9, v6
v_add_u32 v6, 131072, v6
v_lshlrev_b32 v9, 4, v12
v_lshl_add_u32 v9, v14, 3, v9
v_lshrrev_b32 v14, 1, v13
v_lshl_add_u32 v9, v14, 9, v9
v_lshrrev_b32 v14, 5, v1
v_and_b32 v7, 31, v1
v_lshlrev_b32 v7, 4, v7
v_lshl_add_u32 v7, v14, 10, v7
v_lshrrev_b32 v14, 4, v1
v_lshlrev_b32 v10, 4, v12
v_lshl_add_u32 v10, v14, 10, v10
v_lshlrev_b32 v11, 3, v12
v_lshrrev_b32 v12, 4, v1
v_bfe_u32 v13, v1, 1, 1
v_lshlrev_b32 v13, 2, v13
v_lshl_add_u32 v12, v12, 3, v13
v_bfe_u32 v13, v1, 2, 2
v_add_u32 v12, v12, v13
v_lshlrev_b32 v12, 6, v12
v_and_b32 v13, 1, v1
v_lshl_add_u32 v12, v13, 3, v12
s_lshl_b32 s54, s52, 4
s_add_u32 s54, s54, 135168
v_add_u32 v12, s54, v12
ds_read_b64_tr_b16 a[224:225], v12 offset:0
ds_read_b64_tr_b16 a[226:227], v12 offset:2048
ds_read_b64_tr_b16 a[228:229], v12 offset:4096
ds_read_b64_tr_b16 a[230:231], v12 offset:6144
s_waitcnt lgkmcnt(0)
v_exp_f32 v64, -v64
v_exp_f32 v65, -v65
v_exp_f32 v66, -v66
v_exp_f32 v67, -v67
v_exp_f32 v68, -v68
v_exp_f32 v69, -v69
v_exp_f32 v70, -v70
v_exp_f32 v71, -v71
v_add_f32 v64, 1.0, v64
v_add_f32 v65, 1.0, v65
v_add_f32 v66, 1.0, v66
v_add_f32 v67, 1.0, v67
v_add_f32 v68, 1.0, v68
v_add_f32 v69, 1.0, v69
v_add_f32 v70, 1.0, v70
v_add_f32 v71, 1.0, v71
v_rcp_f32 v64, v64
v_rcp_f32 v65, v65
v_rcp_f32 v66, v66
v_rcp_f32 v67, v67
v_rcp_f32 v68, v68
v_rcp_f32 v69, v69
v_rcp_f32 v70, v70
v_rcp_f32 v71, v71
v_mul_f32 v64, v64, v72
v_mul_f32 v65, v65, v73
v_mul_f32 v66, v66, v74
v_mul_f32 v67, v67, v75
v_mul_f32 v68, v68, v76
v_mul_f32 v69, v69, v77
v_mul_f32 v70, v70, v78
v_mul_f32 v71, v71, v79
v_cvt_pk_bf16_f32 v64, v64, v65
v_cvt_pk_bf16_f32 v65, v66, v67
v_cvt_pk_bf16_f32 v66, v68, v69
v_cvt_pk_bf16_f32 v67, v70, v71
s_nop 0
v_permlane16_swap_b32 v64, v66
v_permlane16_swap_b32 v65, v67
buffer_store_dwordx4 v[64:67], v8, s[32:35], s78 offen sc1
s_add_u32 s96, s53, 4
s_waitcnt vmcnt(8)
v_cmp_ne_u32 vcc, s96, v15
s_nop 0
s_cbranch_vccnz HZ_39
HZb_40:
s_mov_b32 s54, s82
buffer_load_dwordx4 v[128:131], v5, s[32:35], s54 offen offset:0 sc1
buffer_load_dwordx4 v[132:135], v5, s[32:35], s54 offen offset:256 sc1
buffer_load_dwordx4 v[136:139], v5, s[32:35], s54 offen offset:2048 sc1
buffer_load_dwordx4 v[140:143], v5, s[32:35], s54 offen offset:2304 sc1
s_add_u32 s54, s54, 4096
buffer_load_dwordx4 v[144:147], v5, s[32:35], s54 offen offset:0 sc1
buffer_load_dwordx4 v[148:151], v5, s[32:35], s54 offen offset:256 sc1
buffer_load_dwordx4 v[152:155], v5, s[32:35], s54 offen offset:2048 sc1
buffer_load_dwordx4 v[156:159], v5, s[32:35], s54 offen offset:2304 sc1
s_add_u32 s54, s54, 4096
buffer_load_dwordx4 v[160:163], v5, s[32:35], s54 offen offset:0 sc1
buffer_load_dwordx4 v[164:167], v5, s[32:35], s54 offen offset:256 sc1
buffer_load_dwordx2 a[240:241], v11, s[32:35], s95 offen offset:0 sc1
buffer_load_dwordx2 a[242:243], v11, s[32:35], s95 offen offset:1024 sc1
s_mul_i32 s57, s52, 896
s_sub_u32 s57, s98, s57
s_add_u32 s57, s57, 6291456
s_add_u32 s58, s57, 131072
s_mov_b32 s59, 0xffff0000
s_mov_b32 s60, 0x3f317218
s_mov_b32 s61, 0x3f317218
s_lshr_b32 s63, s31, 2
s_lshl_b32 s63, s63, 7
s_add_u32 s63, s63, s93
s_waitcnt vmcnt(10)
v_add_u32_e64 v2, s53, 4
s_cmp_eq_u32 s71, 1
s_cbranch_scc0 OS_42
buffer_store_dword v2, off, s[32:35], s99 offset:512
OSb_43:
v_mfma_f32_16x16x32_bf16 v[16:19], a[0:3], v[128:131], 0
buffer_load_dwordx4 v[168:171], v5, s[32:35], s54 offen offset:2048 sc1
v_mfma_f32_16x16x32_bf16 v[20:23], a[0:3], v[132:135], 0
v_mfma_f32_16x16x32_bf16 v[32:35], a[8:11], v[128:131], 0
buffer_load_dwordx4 v[172:175], v5, s[32:35], s54 offen offset:2304 sc1
v_mfma_f32_16x16x32_bf16 v[36:39], a[8:11], v[132:135], 0
v_mfma_f32_16x16x32_bf16 v[24:27], a[4:7], v[128:131], 0
s_add_u32 s54, s54, 4096
buffer_load_dwordx4 v[176:179], v5, s[32:35], s54 offen offset:0 sc1
v_mfma_f32_16x16x32_bf16 v[28:31], a[4:7], v[132:135], 0
v_mfma_f32_16x16x32_bf16 v[40:43], a[12:15], v[128:131], 0
buffer_load_dwordx4 v[180:183], v5, s[32:35], s54 offen offset:256 sc1
v_mfma_f32_16x16x32_bf16 v[44:47], a[12:15], v[132:135], 0
s_waitcnt vmcnt(13)
v_mfma_f32_16x16x32_bf16 v[16:19], a[16:19], v[136:139], v[16:19]
buffer_load_dwordx4 v[184:187], v5, s[32:35], s54 offen offset:2048 sc1
v_mfma_f32_16x16x32_bf16 v[20:23], a[16:19], v[140:143], v[20:23]
v_mfma_f32_16x16x32_bf16 v[32:35], a[24:27], v[136:139], v[32:35]
buffer_load_dwordx4 v[188:191], v5, s[32:35], s54 offen offset:2304 sc1
v_mfma_f32_16x16x32_bf16 v[36:39], a[24:27], v[140:143], v[36:39]
v_mfma_f32_16x16x32_bf16 v[24:27], a[20:23], v[136:139], v[24:27]
s_add_u32 s86, s98, 2097152
buffer_load_dwordx4 a[232:235], v8, s[32:35], s86 offen sc1
v_mfma_f32_16x16x32_bf16 v[28:31], a[20:23], v[140:143], v[28:31]
v_mfma_f32_16x16x32_bf16 v[40:43], a[28:31], v[136:139], v[40:43]
s_add_u32 s86, s98, 2228224
buffer_load_dwordx4 a[236:239], v8, s[32:35], s86 offen sc1
v_mfma_f32_16x16x32_bf16 v[44:47], a[28:31], v[140:143], v[44:47]
s_waitcnt vmcnt(15)
v_mfma_f32_16x16x32_bf16 v[16:19], a[32:35], v[144:147], v[16:19]
s_add_u32 s54, s54, 4096
buffer_load_dwordx4 v[112:115], v5, s[32:35], s54 offen offset:0 sc1
v_mfma_f32_16x16x32_bf16 v[20:23], a[32:35], v[148:151], v[20:23]
v_mfma_f32_16x16x32_bf16 v[32:35], a[40:43], v[144:147], v[32:35]
buffer_load_dwordx4 v[116:119], v5, s[32:35], s54 offen offset:256 sc1
v_mfma_f32_16x16x32_bf16 v[36:39], a[40:43], v[148:151], v[36:39]
v_mfma_f32_16x16x32_bf16 v[24:27], a[36:39], v[144:147], v[24:27]
v_mfma_f32_16x16x32_bf16 v[28:31], a[36:39], v[148:151], v[28:31]
v_mfma_f32_16x16x32_bf16 v[40:43], a[44:47], v[144:147], v[40:43]
v_mfma_f32_16x16x32_bf16 v[44:47], a[44:47], v[148:151], v[44:47]
s_waitcnt vmcnt(15)
v_mfma_f32_16x16x32_bf16 v[16:19], a[48:51], v[152:155], v[16:19]
buffer_load_dwordx4 v[120:123], v5, s[32:35], s54 offen offset:2048 sc1
v_mfma_f32_16x16x32_bf16 v[20:23], a[48:51], v[156:159], v[20:23]
v_mfma_f32_16x16x32_bf16 v[32:35], a[56:59], v[152:155], v[32:35]
buffer_load_dwordx4 v[124:127], v5, s[32:35], s54 offen offset:2304 sc1
v_mfma_f32_16x16x32_bf16 v[36:39], a[56:59], v[156:159], v[36:39]
v_mfma_f32_16x16x32_bf16 v[24:27], a[52:55], v[152:155], v[24:27]
v_mfma_f32_16x16x32_bf16 v[28:31], a[52:55], v[156:159], v[28:31]
v_mfma_f32_16x16x32_bf16 v[40:43], a[60:63], v[152:155], v[40:43]
v_mfma_f32_16x16x32_bf16 v[44:47], a[60:63], v[156:159], v[44:47]
s_waitcnt vmcnt(15)
v_mfma_f32_16x16x32_bf16 v[16:19], a[64:67], v[160:163], v[16:19]
s_add_u32 s54, s54, 4096
buffer_load_dwordx4 v[192:195], v5, s[32:35], s54 offen offset:0 sc1
v_mfma_f32_16x16x32_bf16 v[20:23], a[64:67], v[164:167], v[20:23]
v_mfma_f32_16x16x32_bf16 v[32:35], a[72:75], v[160:163], v[32:35]
buffer_load_dwordx4 v[196:199], v5, s[32:35], s54 offen offset:256 sc1
v_mfma_f32_16x16x32_bf16 v[36:39], a[72:75], v[164:167], v[36:39]
v_mfma_f32_16x16x32_bf16 v[24:27], a[68:71], v[160:163], v[24:27]
v_mfma_f32_16x16x32_bf16 v[28:31], a[68:71], v[164:167], v[28:31]
v_mfma_f32_16x16x32_bf16 v[40:43], a[76:79], v[160:163], v[40:43]
v_mfma_f32_16x16x32_bf16 v[44:47], a[76:79], v[164:167], v[44:47]
s_waitcnt vmcnt(12)
v_mfma_f32_16x16x32_bf16 v[16:19], a[80:83], v[168:171], v[16:19]
buffer_load_dwordx4 v[200:203], v5, s[32:35], s54 offen offset:2048 sc1
v_mfma_f32_16x16x32_bf16 v[20:23], a[80:83], v[172:175], v[20:23]
v_mfma_f32_16x16x32_bf16 v[32:35], a[88:91], v[168:171], v[32:35]
buffer_load_dwordx4 v[204:207], v5, s[32:35], s54 offen offset:2304 sc1
v_mfma_f32_16x16x32_bf16 v[36:39], a[88:91], v[172:175], v[36:39]
v_mfma_f32_16x16x32_bf16 v[24:27], a[84:87], v[168:171], v[24:27]
v_mfma_f32_16x16x32_bf16 v[28:31], a[84:87], v[172:175], v[28:31]
v_mfma_f32_16x16x32_bf16 v[40:43], a[92:95], v[168:171], v[40:43]
v_mfma_f32_16x16x32_bf16 v[44:47], a[92:95], v[172:175], v[44:47]
s_waitcnt vmcnt(12)
v_mfma_f32_16x16x32_bf16 v[16:19], a[96:99], v[176:179], v[16:19]
s_add_u32 s54, s54, 4096
buffer_load_dwordx4 v[208:211], v5, s[32:35], s54 offen offset:0 sc1
v_mfma_f32_16x16x32_bf16 v[20:23], a[96:99], v[180:183], v[20:23]
v_mfma_f32_16x16x32_bf16 v[32:35], a[104:107], v[176:179], v[32:35]
buffer_load_dwordx4 v[212:215], v5, s[32:35], s54 offen offset:256 sc1
v_mfma_f32_16x16x32_bf16 v[36:39], a[104:107], v[180:183], v[36:39]
v_mfma_f32_16x16x32_bf16 v[24:27], a[100:103], v[176:179], v[24:27]
buffer_load_dwordx4 v[216:219], v5, s[32:35], s54 offen offset:2048 sc1
v_mfma_f32_16x16x32_bf16 v[28:31], a[100:103], v[180:183], v[28:31]
v_mfma_f32_16x16x32_bf16 v[40:43], a[108:111], v[176:179], v[40:43]
buffer_load_dwordx4 v[220:223], v5, s[32:35], s54 offen offset:2304 sc1
v_mfma_f32_16x16x32_bf16 v[44:47], a[108:111], v[180:183], v[44:47]
s_waitcnt vmcnt(14)
v_mfma_f32_16x16x32_bf16 v[16:19], a[112:115], v[184:187], v[16:19]
v_mfma_f32_16x16x32_bf16 v[20:23], a[112:115], v[188:191], v[20:23]
v_mfma_f32_16x16x32_bf16 v[32:35], a[120:123], v[184:187], v[32:35]
v_mfma_f32_16x16x32_bf16 v[36:39], a[120:123], v[188:191], v[36:39]
v_mfma_f32_16x16x32_bf16 v[24:27], a[116:119], v[184:187], v[24:27]
v_accvgpr_read_b32 v14, a245
buffer_load_dword v15, v14, s[32:35], 0 offen sc1
v_mfma_f32_16x16x32_bf16 v[28:31], a[116:119], v[188:191], v[28:31]
v_mfma_f32_16x16x32_bf16 v[40:43], a[124:127], v[184:187], v[40:43]
v_mfma_f32_16x16x32_bf16 v[44:47], a[124:127], v[188:191], v[44:47]
s_waitcnt vmcnt(11)
v_mfma_f32_16x16x32_bf16 v[16:19], a[128:131], v[112:115], v[16:19]
v_mfma_f32_16x16x32_bf16 v[20:23], a[128:131], v[116:119], v[20:23]
v_mfma_f32_16x16x32_bf16 v[32:35], a[136:139], v[112:115], v[32:35]
v_mfma_f32_16x16x32_bf16 v[36:39], a[136:139], v[116:119], v[36:39]
v_mfma_f32_16x16x32_bf16 v[24:27], a[132:135], v[112:115], v[24:27]
v_mfma_f32_16x16x32_bf16 v[28:31], a[132:135], v[116:119], v[28:31]
v_mfma_f32_16x16x32_bf16 v[40:43], a[140:143], v[112:115], v[40:43]
v_mfma_f32_16x16x32_bf16 v[44:47], a[140:143], v[116:119], v[44:47]
s_waitcnt vmcnt(9)
v_mfma_f32_16x16x32_bf16 v[16:19], a[144:147], v[120:123], v[16:19]
v_mfma_f32_16x16x32_bf16 v[20:23], a[144:147], v[124:127], v[20:23]
v_mfma_f32_16x16x32_bf16 v[32:35], a[152:155], v[120:123], v[32:35]
v_mfma_f32_16x16x32_bf16 v[36:39], a[152:155], v[124:127], v[36:39]
v_mfma_f32_16x16x32_bf16 v[24:27], a[148:151], v[120:123], v[24:27]
v_mfma_f32_16x16x32_bf16 v[28:31], a[148:151], v[124:127], v[28:31]
v_mfma_f32_16x16x32_bf16 v[40:43], a[156:159], v[120:123], v[40:43]
v_mfma_f32_16x16x32_bf16 v[44:47], a[156:159], v[124:127], v[44:47]
s_waitcnt vmcnt(7)
v_mfma_f32_16x16x32_bf16 v[16:19], a[160:163], v[192:195], v[16:19]
v_mfma_f32_16x16x32_bf16 v[20:23], a[160:163], v[196:199], v[20:23]
v_mfma_f32_16x16x32_bf16 v[32:35], a[168:171], v[192:195], v[32:35]
v_mfma_f32_16x16x32_bf16 v[36:39], a[168:171], v[196:199], v[36:39]
v_mfma_f32_16x16x32_bf16 v[24:27], a[164:167], v[192:195], v[24:27]
s_add_u32 s96, s53, 4
s_waitcnt vmcnt(0)
v_cmp_ne_u32 vcc, s96, v15
v_mfma_f32_16x16x32_bf16 v[28:31], a[164:167], v[196:199], v[28:31]
v_mfma_f32_16x16x32_bf16 v[40:43], a[172:175], v[192:195], v[40:43]
s_cbranch_vccnz HZ_44
HZb_45:
s_add_u32 s54, s82, 458752
buffer_load_dwordx4 v[224:227], v5, s[32:35], s54 offen offset:0 sc1
v_mfma_f32_16x16x32_bf16 v[44:47], a[172:175], v[196:199], v[44:47]
v_mfma_f32_16x16x32_bf16 v[16:19], a[176:179], v[200:203], v[16:19]
buffer_load_dwordx4 v[228:231], v5, s[32:35], s54 offen offset:256 sc1
v_mfma_f32_16x16x32_bf16 v[20:23], a[176:179], v[204:207], v[20:23]
v_mfma_f32_16x16x32_bf16 v[32:35], a[184:187], v[200:203], v[32:35]
buffer_load_dwordx4 v[232:235], v5, s[32:35], s54 offen offset:2048 sc1
v_mfma_f32_16x16x32_bf16 v[36:39], a[184:187], v[204:207], v[36:39]
v_mfma_f32_16x16x32_bf16 v[24:27], a[180:183], v[200:203], v[24:27]
buffer_load_dwordx4 v[236:239], v5, s[32:35], s54 offen offset:2304 sc1
v_mfma_f32_16x16x32_bf16 v[28:31], a[180:183], v[204:207], v[28:31]
v_mfma_f32_16x16x32_bf16 v[40:43], a[188:191], v[200:203], v[40:43]
s_add_u32 s54, s54, 4096
buffer_load_dwordx4 v[240:243], v5, s[32:35], s54 offen offset:0 sc1
v_mfma_f32_16x16x32_bf16 v[44:47], a[188:191], v[204:207], v[44:47]
v_mfma_f32_16x16x32_bf16 v[16:19], a[192:195], v[208:211], v[16:19]
buffer_load_dwordx4 v[244:247], v5, s[32:35], s54 offen offset:256 sc1
v_mfma_f32_16x16x32_bf16 v[20:23], a[192:195], v[212:215], v[20:23]
v_mfma_f32_16x16x32_bf16 v[24:27], a[196:199], v[208:211], v[24:27]
buffer_load_dwordx4 v[248:251], v5, s[32:35], s54 offen offset:2048 sc1
v_mfma_f32_16x16x32_bf16 v[28:31], a[196:199], v[212:215], v[28:31]
v_mfma_f32_16x16x32_bf16 v[16:19], a[208:211], v[216:219], v[16:19]
buffer_load_dwordx4 v[252:255], v5, s[32:35], s54 offen offset:2304 sc1
v_mfma_f32_16x16x32_bf16 v[20:23], a[208:211], v[220:223], v[20:23]
v_mfma_f32_16x16x32_bf16 v[24:27], a[212:215], v[216:219], v[24:27]
s_add_u32 s54, s54, 4096
buffer_load_dwordx4 v[128:131], v5, s[32:35], s54 offen offset:0 sc1
v_mfma_f32_16x16x32_bf16 v[28:31], a[212:215], v[220:223], v[28:31]
v_mfma_f32_16x16x32_bf16 v[32:35], a[200:203], v[208:211], v[32:35]
buffer_load_dwordx4 v[132:135], v5, s[32:35], s54 offen offset:256 sc1
v_mfma_f32_16x16x32_bf16 v[36:39], a[200:203], v[212:215], v[36:39]
v_mfma_f32_16x16x32_bf16 v[40:43], a[204:207], v[208:211], v[40:43]
buffer_load_dwordx4 v[136:139], v5, s[32:35], s54 offen offset:2048 sc1
v_mfma_f32_16x16x32_bf16 v[44:47], a[204:207], v[212:215], v[44:47]
ds_write_b128 v4, v[16:19] offset:0
v_mfma_f32_16x16x32_bf16 v[32:35], a[216:219], v[216:219], v[32:35]
buffer_load_dwordx4 v[140:143], v5, s[32:35], s54 offen offset:2304 sc1
v_mfma_f32_16x16x32_bf16 v[36:39], a[216:219], v[220:223], v[36:39]
ds_write_b128 v4, v[20:23] offset:256
v_mfma_f32_16x16x32_bf16 v[40:43], a[220:223], v[216:219], v[40:43]
v_mfma_f32_16x16x32_bf16 v[44:47], a[220:223], v[220:223], v[44:47]
ds_write_b128 v4, v[24:27] offset:2048
s_waitcnt vmcnt(10)
v_mfma_f32_16x16x32_bf16 v[48:51], a[0:3], v[224:227], 0
s_add_u32 s54, s54, 4096
buffer_load_dwordx4 v[144:147], v5, s[32:35], s54 offen offset:0 sc1
v_mfma_f32_16x16x32_bf16 v[52:55], a[0:3], v[228:231], 0
ds_write_b128 v4, v[28:31] offset:2304
v_accvgpr_read_b32 v208, a232
v_mfma_f32_16x16x32_bf16 v[64:67], a[8:11], v[224:227], 0
buffer_load_dwordx4 v[148:151], v5, s[32:35], s54 offen offset:256 sc1
v_mfma_f32_16x16x32_bf16 v[68:71], a[8:11], v[228:231], 0
ds_write_b128 v4, v[32:35] offset:4096
v_accvgpr_read_b32 v209, a233
v_mfma_f32_16x16x32_bf16 v[56:59], a[4:7], v[224:227], 0
v_accvgpr_read_b32 v210, a234
v_accvgpr_read_b32 v211, a235
v_mfma_f32_16x16x32_bf16 v[60:63], a[4:7], v[228:231], 0
ds_write_b128 v4, v[36:39] offset:4352
v_lshlrev_b32 v192, 16, v208
v_mfma_f32_16x16x32_bf16 v[72:75], a[12:15], v[224:227], 0
v_and_b32 v193, s59, v208
v_lshlrev_b32 v194, 16, v209
v_mfma_f32_16x16x32_bf16 v[76:79], a[12:15], v[228:231], 0
ds_write_b128 v4, v[40:43] offset:6144
s_waitcnt vmcnt(10)
v_mfma_f32_16x16x32_bf16 v[48:51], a[16:19], v[232:235], v[48:51]
buffer_load_dwordx4 v[152:155], v5, s[32:35], s54 offen offset:2048 sc1
v_mfma_f32_16x16x32_bf16 v[52:55], a[16:19], v[236:239], v[52:55]
ds_write_b128 v4, v[44:47] offset:6400
v_and_b32 v195, s59, v209
v_mfma_f32_16x16x32_bf16 v[64:67], a[24:27], v[232:235], v[64:67]
buffer_load_dwordx4 v[156:159], v5, s[32:35], s54 offen offset:2304 sc1
v_mfma_f32_16x16x32_bf16 v[68:71], a[24:27], v[236:239], v[68:71]
v_lshlrev_b32 v196, 16, v210
v_and_b32 v197, s59, v210
v_lshlrev_b32 v198, 16, v211
v_and_b32 v199, s59, v211
v_mfma_f32_16x16x32_bf16 v[56:59], a[20:23], v[232:235], v[56:59]
v_accvgpr_read_b32 v212, a224
v_accvgpr_read_b32 v213, a225
v_mfma_f32_16x16x32_bf16 v[60:63], a[20:23], v[236:239], v[60:63]
s_waitcnt lgkmcnt(0)
s_barrier
v_accvgpr_read_b32 v214, a226
v_accvgpr_read_b32 v215, a227
v_mfma_f32_16x16x32_bf16 v[72:75], a[28:31], v[232:235], v[72:75]
v_lshlrev_b32 v200, 16, v212
v_and_b32 v201, s59, v212
v_mfma_f32_16x16x32_bf16 v[76:79], a[28:31], v[236:239], v[76:79]
ds_read_b128 v[80:83], v6 offset:0
s_waitcnt vmcnt(10)
v_lshlrev_b32 v202, 16, v213
v_and_b32 v203, s59, v213
v_mfma_f32_16x16x32_bf16 v[48:51], a[32:35], v[240:243], v[48:51]
s_add_u32 s54, s54, 4096
buffer_load_dwordx4 v[160:163], v5, s[32:35], s54 offen offset:0 sc1
v_mfma_f32_16x16x32_bf16 v[52:55], a[32:35], v[244:247], v[52:55]
ds_read_b128 v[84:87], v6 offset:8192
v_lshlrev_b32 v204, 16, v214
v_and_b32 v205, s59, v214
v_lshlrev_b32 v206, 16, v215
v_mfma_f32_16x16x32_bf16 v[64:67], a[40:43], v[240:243], v[64:67]
buffer_load_dwordx4 v[164:167], v5, s[32:35], s54 offen offset:256 sc1
v_mfma_f32_16x16x32_bf16 v[68:71], a[40:43], v[244:247], v[68:71]
ds_read_b128 v[88:91], v6 offset:16384
v_and_b32 v207, s59, v215
v_mfma_f32_16x16x32_bf16 v[56:59], a[36:39], v[240:243], v[56:59]
v_mfma_f32_16x16x32_bf16 v[60:63], a[36:39], v[244:247], v[60:63]
ds_read_b128 v[92:95], v6 offset:24576
v_mfma_f32_16x16x32_bf16 v[72:75], a[44:47], v[240:243], v[72:75]
v_mfma_f32_16x16x32_bf16 v[76:79], a[44:47], v[244:247], v[76:79]
ds_read_b128 v[96:99], v6 offset:4096
s_waitcnt vmcnt(10)
v_mfma_f32_16x16x32_bf16 v[48:51], a[48:51], v[248:251], v[48:51]
buffer_load_dwordx4 v[168:171], v5, s[32:35], s54 offen offset:2048 sc1
v_mfma_f32_16x16x32_bf16 v[52:55], a[48:51], v[252:255], v[52:55]
ds_read_b128 v[100:103], v6 offset:12288
v_mfma_f32_16x16x32_bf16 v[64:67], a[56:59], v[248:251], v[64:67]
buffer_load_dwordx4 v[172:175], v5, s[32:35], s54 offen offset:2304 sc1
v_mfma_f32_16x16x32_bf16 v[68:71], a[56:59], v[252:255], v[68:71]
ds_read_b128 v[104:107], v6 offset:20480
v_mfma_f32_16x16x32_bf16 v[56:59], a[52:55], v[248:251], v[56:59]
v_mfma_f32_16x16x32_bf16 v[60:63], a[52:55], v[252:255], v[60:63]
ds_read_b128 v[108:111], v6 offset:28672
v_mfma_f32_16x16x32_bf16 v[72:75], a[60:63], v[248:251], v[72:75]
v_mfma_f32_16x16x32_bf16 v[76:79], a[60:63], v[252:255], v[76:79]
s_waitcnt vmcnt(10)
v_mfma_f32_16x16x32_bf16 v[48:51], a[64:67], v[128:131], v[48:51]
s_add_u32 s54, s54, 4096
buffer_load_dwordx4 v[176:179], v5, s[32:35], s54 offen offset:0 sc1
v_mfma_f32_16x16x32_bf16 v[52:55], a[64:67], v[132:135], v[52:55]
s_waitcnt lgkmcnt(0)
v_add_f32 v80, v80, v84
v_add_f32 v81, v81, v85
v_add_f32 v82, v82, v86
v_mfma_f32_16x16x32_bf16 v[64:67], a[72:75], v[128:131], v[64:67]
buffer_load_dwordx4 v[180:183], v5, s[32:35], s54 offen offset:256 sc1
v_mfma_f32_16x16x32_bf16 v[68:71], a[72:75], v[132:135], v[68:71]
v_add_f32 v83, v83, v87
v_add_f32 v88, v88, v92
v_add_f32 v89, v89, v93
v_add_f32 v90, v90, v94
v_mfma_f32_16x16x32_bf16 v[56:59], a[68:71], v[128:131], v[56:59]
buffer_load_dwordx4 v[184:187], v5, s[32:35], s54 offen offset:2048 sc1
v_mfma_f32_16x16x32_bf16 v[60:63], a[68:71], v[132:135], v[60:63]
v_add_f32 v91, v91, v95
v_add_f32 v80, v80, v88
v_add_f32 v81, v81, v89
v_add_f32 v82, v82, v90
v_mfma_f32_16x16x32_bf16 v[72:75], a[76:79], v[128:131], v[72:75]
buffer_load_dwordx4 v[188:191], v5, s[32:35], s54 offen offset:2304 sc1
v_mfma_f32_16x16x32_bf16 v[76:79], a[76:79], v[132:135], v[76:79]
s_waitcnt vmcnt(12)
v_add_f32 v83, v83, v91
v_fma_f32 v192, v80, s60, v192
v_fma_f32 v193, v81, s60, v193
v_mfma_f32_16x16x32_bf16 v[48:51], a[80:83], v[136:139], v[48:51]
s_add_u32 s54, s54, 4096
buffer_load_dwordx4 v[112:115], v5, s[32:35], s54 offen offset:0 sc1
v_mfma_f32_16x16x32_bf16 v[52:55], a[80:83], v[140:143], v[52:55]
v_fma_f32 v194, v82, s60, v194
v_fma_f32 v195, v83, s60, v195
v_add_f32 v96, v96, v100
v_add_f32 v97, v97, v101
v_mfma_f32_16x16x32_bf16 v[64:67], a[88:91], v[136:139], v[64:67]
buffer_load_dwordx4 v[116:119], v5, s[32:35], s54 offen offset:256 sc1
v_mfma_f32_16x16x32_bf16 v[68:71], a[88:91], v[140:143], v[68:71]
v_add_f32 v98, v98, v102
v_add_f32 v99, v99, v103
v_add_f32 v104, v104, v108
v_add_f32 v105, v105, v109
v_mfma_f32_16x16x32_bf16 v[56:59], a[84:87], v[136:139], v[56:59]
buffer_load_dwordx4 v[120:123], v5, s[32:35], s54 offen offset:2048 sc1
v_mfma_f32_16x16x32_bf16 v[60:63], a[84:87], v[140:143], v[60:63]
v_add_f32 v106, v106, v110
v_add_f32 v107, v107, v111
v_add_f32 v96, v96, v104
v_add_f32 v97, v97, v105
v_mfma_f32_16x16x32_bf16 v[72:75], a[92:95], v[136:139], v[72:75]
buffer_load_dwordx4 v[124:127], v5, s[32:35], s54 offen offset:2304 sc1
v_mfma_f32_16x16x32_bf16 v[76:79], a[92:95], v[140:143], v[76:79]
s_waitcnt vmcnt(14)
v_add_f32 v98, v98, v106
v_add_f32 v99, v99, v107
v_fma_f32 v196, v96, s60, v196
v_mfma_f32_16x16x32_bf16 v[48:51], a[96:99], v[144:147], v[48:51]
v_fma_f32 v197, v97, s60, v197
v_fma_f32 v198, v98, s60, v198
v_mfma_f32_16x16x32_bf16 v[52:55], a[96:99], v[148:151], v[52:55]
v_fma_f32 v199, v99, s60, v199
v_mul_f32 v208, v192, v200
v_mul_f32 v209, v193, v201
v_mul_f32 v210, v194, v202
v_mfma_f32_16x16x32_bf16 v[64:67], a[104:107], v[144:147], v[64:67]
v_mul_f32 v211, v195, v203
v_mul_f32 v217, v192, v192
v_mfma_f32_16x16x32_bf16 v[68:71], a[104:107], v[148:151], v[68:71]
v_mul_f32 v220, v208, v192
v_mul_f32 v221, v208, v208
v_mul_f32 v222, v208, v200
v_add_f32 v216, v192, v193
v_mfma_f32_16x16x32_bf16 v[56:59], a[100:103], v[144:147], v[56:59]
v_add_f32 v218, v208, v209
v_fma_f32 v217, v193, v193, v217
v_mfma_f32_16x16x32_bf16 v[60:63], a[100:103], v[148:151], v[60:63]
v_fma_f32 v220, v209, v193, v220
v_fma_f32 v221, v209, v209, v221
v_fma_f32 v222, v209, v201, v222
v_add_f32 v216, v216, v194
v_mfma_f32_16x16x32_bf16 v[72:75], a[108:111], v[144:147], v[72:75]
v_add_f32 v218, v218, v210
v_fma_f32 v217, v194, v194, v217
v_mfma_f32_16x16x32_bf16 v[76:79], a[108:111], v[148:151], v[76:79]
s_waitcnt vmcnt(12)
v_fma_f32 v220, v210, v194, v220
v_fma_f32 v221, v210, v210, v221
v_fma_f32 v222, v210, v202, v222
v_mfma_f32_16x16x32_bf16 v[48:51], a[112:115], v[152:155], v[48:51]
v_add_f32 v216, v216, v195
v_add_f32 v218, v218, v211
v_mfma_f32_16x16x32_bf16 v[52:55], a[112:115], v[156:159], v[52:55]
v_fma_f32 v217, v195, v195, v217
v_fma_f32 v220, v211, v195, v220
v_fma_f32 v221, v211, v211, v221
v_fma_f32 v222, v211, v203, v222
v_mfma_f32_16x16x32_bf16 v[64:67], a[120:123], v[152:155], v[64:67]
v_mul_f32 v212, v196, v204
v_mul_f32 v213, v197, v205
v_mfma_f32_16x16x32_bf16 v[68:71], a[120:123], v[156:159], v[68:71]
v_mul_f32 v214, v198, v206
v_mul_f32 v215, v199, v207
v_add_f32 v216, v216, v196
v_add_f32 v218, v218, v212
v_mfma_f32_16x16x32_bf16 v[56:59], a[116:119], v[152:155], v[56:59]
v_fma_f32 v217, v196, v196, v217
v_fma_f32 v220, v212, v196, v220
v_mfma_f32_16x16x32_bf16 v[60:63], a[116:119], v[156:159], v[60:63]
v_fma_f32 v221, v212, v212, v221
v_fma_f32 v222, v212, v204, v222
v_add_f32 v216, v216, v197
v_add_f32 v218, v218, v213
v_mfma_f32_16x16x32_bf16 v[72:75], a[124:127], v[152:155], v[72:75]
v_fma_f32 v217, v197, v197, v217
v_fma_f32 v220, v213, v197, v220
v_mfma_f32_16x16x32_bf16 v[76:79], a[124:127], v[156:159], v[76:79]
s_waitcnt vmcnt(10)
v_fma_f32 v221, v213, v213, v221
v_fma_f32 v222, v213, v205, v222
v_add_f32 v216, v216, v198
v_mfma_f32_16x16x32_bf16 v[48:51], a[128:131], v[160:163], v[48:51]
v_add_f32 v218, v218, v214
v_fma_f32 v217, v198, v198, v217
v_mfma_f32_16x16x32_bf16 v[52:55], a[128:131], v[164:167], v[52:55]
v_fma_f32 v220, v214, v198, v220
v_fma_f32 v221, v214, v214, v221
v_fma_f32 v222, v214, v206, v222
v_add_f32 v216, v216, v199
v_mfma_f32_16x16x32_bf16 v[64:67], a[136:139], v[160:163], v[64:67]
v_add_f32 v218, v218, v215
v_fma_f32 v217, v199, v199, v217
v_mfma_f32_16x16x32_bf16 v[68:71], a[136:139], v[164:167], v[68:71]
v_fma_f32 v220, v215, v199, v220
v_fma_f32 v221, v215, v215, v221
v_fma_f32 v222, v215, v207, v222
v_add_f32_dpp v216, v216, v216 row_ror:8 row_mask:0xf bank_mask:0xf
v_mfma_f32_16x16x32_bf16 v[56:59], a[132:135], v[160:163], v[56:59]
v_add_f32_dpp v220, v220, v220 row_ror:8 row_mask:0xf bank_mask:0xf
v_add_f32_dpp v217, v217, v217 row_ror:8 row_mask:0xf bank_mask:0xf
v_mfma_f32_16x16x32_bf16 v[60:63], a[132:135], v[164:167], v[60:63]
v_add_f32_dpp v221, v221, v221 row_ror:8 row_mask:0xf bank_mask:0xf
v_add_f32_dpp v218, v218, v218 row_ror:8 row_mask:0xf bank_mask:0xf
v_add_f32_dpp v222, v222, v222 row_ror:8 row_mask:0xf bank_mask:0xf
v_mov_b32 v219, s94
v_mfma_f32_16x16x32_bf16 v[72:75], a[140:143], v[160:163], v[72:75]
v_permlane16_swap_b32 v216, v220
v_permlane16_swap_b32 v217, v221
v_mfma_f32_16x16x32_bf16 v[76:79], a[140:143], v[164:167], v[76:79]
s_waitcnt vmcnt(8)
v_permlane16_swap_b32 v218, v222
v_add_f32 v216, v216, v220
v_add_f32 v217, v217, v221
v_mfma_f32_16x16x32_bf16 v[48:51], a[144:147], v[168:171], v[48:51]
v_add_f32 v218, v218, v222
v_mov_b32 v220, v216
v_mfma_f32_16x16x32_bf16 v[52:55], a[144:147], v[172:175], v[52:55]
v_mov_b32 v221, v217
v_mov_b32 v222, v218
v_permlane32_swap_b32 v216, v220
v_permlane32_swap_b32 v217, v221
v_mfma_f32_16x16x32_bf16 v[64:67], a[152:155], v[168:171], v[64:67]
v_permlane32_swap_b32 v218, v222
v_add_f32 v216, v216, v220
v_mfma_f32_16x16x32_bf16 v[68:71], a[152:155], v[172:175], v[68:71]
v_add_f32 v217, v217, v221
v_add_f32 v218, v218, v222
s_mov_b32 exec_lo, 0x00ff00ff
s_mov_b32 exec_hi, 0
s_cmp_eq_u32 s71, 1
s_cbranch_scc0 OS_49
buffer_store_dwordx4 v[216:219], v10, s[32:35], s63 offen offset:0
OSb_50:
s_mov_b64 exec, -1
v_mfma_f32_16x16x32_bf16 v[56:59], a[148:151], v[168:171], v[56:59]
v_accvgpr_read_b32 v240, a236
v_accvgpr_read_b32 v241, a237
v_mfma_f32_16x16x32_bf16 v[60:63], a[148:151], v[172:175], v[60:63]
v_accvgpr_read_b32 v242, a238
v_accvgpr_read_b32 v243, a239
v_lshlrev_b32 v224, 16, v240
v_and_b32 v225, s59, v240
v_mfma_f32_16x16x32_bf16 v[72:75], a[156:159], v[168:171], v[72:75]
v_lshlrev_b32 v226, 16, v241
v_and_b32 v227, s59, v241
v_mfma_f32_16x16x32_bf16 v[76:79], a[156:159], v[172:175], v[76:79]
s_waitcnt vmcnt(7)
v_lshlrev_b32 v228, 16, v242
v_and_b32 v229, s59, v242
v_lshlrev_b32 v230, 16, v243
v_mfma_f32_16x16x32_bf16 v[48:51], a[160:163], v[176:179], v[48:51]
v_and_b32 v231, s59, v243
v_accvgpr_read_b32 v244, a228
v_accvgpr_read_b32 v245, a229
v_mfma_f32_16x16x32_bf16 v[52:55], a[160:163], v[180:183], v[52:55]
v_accvgpr_read_b32 v246, a230
v_accvgpr_read_b32 v247, a231
v_lshlrev_b32 v232, 16, v244
v_and_b32 v233, s59, v244
v_mfma_f32_16x16x32_bf16 v[56:59], a[164:167], v[176:179], v[56:59]
v_lshlrev_b32 v234, 16, v245
v_and_b32 v235, s59, v245
v_lshlrev_b32 v236, 16, v246
v_mfma_f32_16x16x32_bf16 v[60:63], a[164:167], v[180:183], v[60:63]
s_waitcnt vmcnt(5)
v_and_b32 v237, s59, v246
v_lshlrev_b32 v238, 16, v247
v_and_b32 v239, s59, v247
v_mfma_f32_16x16x32_bf16 v[48:51], a[176:179], v[184:187], v[48:51]
v_mfma_f32_16x16x32_bf16 v[52:55], a[176:179], v[188:191], v[52:55]
v_mfma_f32_16x16x32_bf16 v[56:59], a[180:183], v[184:187], v[56:59]
v_mfma_f32_16x16x32_bf16 v[60:63], a[180:183], v[188:191], v[60:63]
s_waitcnt vmcnt(3)
v_mfma_f32_16x16x32_bf16 v[48:51], a[192:195], v[112:115], v[48:51]
v_mfma_f32_16x16x32_bf16 v[52:55], a[192:195], v[116:119], v[52:55]
v_mfma_f32_16x16x32_bf16 v[56:59], a[196:199], v[112:115], v[56:59]
v_mfma_f32_16x16x32_bf16 v[60:63], a[196:199], v[116:119], v[60:63]
s_waitcnt vmcnt(1)
v_mfma_f32_16x16x32_bf16 v[48:51], a[208:211], v[120:123], v[48:51]
v_mfma_f32_16x16x32_bf16 v[52:55], a[208:211], v[124:127], v[52:55]
v_mfma_f32_16x16x32_bf16 v[56:59], a[212:215], v[120:123], v[56:59]
v_mfma_f32_16x16x32_bf16 v[60:63], a[212:215], v[124:127], v[60:63]
v_mfma_f32_16x16x32_bf16 v[64:67], a[168:171], v[176:179], v[64:67]
v_mfma_f32_16x16x32_bf16 v[68:71], a[168:171], v[180:183], v[68:71]
s_barrier
v_mfma_f32_16x16x32_bf16 v[72:75], a[172:175], v[176:179], v[72:75]
v_mfma_f32_16x16x32_bf16 v[76:79], a[172:175], v[180:183], v[76:79]
ds_write_b128 v4, v[48:51] offset:0
v_mfma_f32_16x16x32_bf16 v[64:67], a[184:187], v[184:187], v[64:67]
v_mfma_f32_16x16x32_bf16 v[68:71], a[184:187], v[188:191], v[68:71]
ds_write_b128 v4, v[52:55] offset:256
v_mfma_f32_16x16x32_bf16 v[72:75], a[188:191], v[184:187], v[72:75]
v_mfma_f32_16x16x32_bf16 v[76:79], a[188:191], v[188:191], v[76:79]
ds_write_b128 v4, v[56:59] offset:2048
v_mfma_f32_16x16x32_bf16 v[64:67], a[200:203], v[112:115], v[64:67]
v_mfma_f32_16x16x32_bf16 v[68:71], a[200:203], v[116:119], v[68:71]
ds_write_b128 v4, v[60:63] offset:2304
v_mfma_f32_16x16x32_bf16 v[72:75], a[204:207], v[112:115], v[72:75]
v_mfma_f32_16x16x32_bf16 v[76:79], a[204:207], v[116:119], v[76:79]
s_waitcnt lgkmcnt(0)
s_barrier
v_mfma_f32_16x16x32_bf16 v[64:67], a[216:219], v[120:123], v[64:67]
v_mfma_f32_16x16x32_bf16 v[68:71], a[216:219], v[124:127], v[68:71]
ds_read_b128 v[80:83], v6 offset:0
v_mfma_f32_16x16x32_bf16 v[72:75], a[220:223], v[120:123], v[72:75]
v_mfma_f32_16x16x32_bf16 v[76:79], a[220:223], v[124:127], v[76:79]
ds_read_b128 v[84:87], v6 offset:8192
ds_read_b128 v[88:91], v6 offset:16384
ds_read_b128 v[92:95], v6 offset:24576
s_nop 0
ds_write_b128 v4, v[64:67] offset:4096
ds_write_b128 v4, v[68:71] offset:4352
s_nop 0
ds_write_b128 v4, v[72:75] offset:6144
ds_write_b128 v4, v[76:79] offset:6400
buffer_load_dwordx4 v[16:19], v7, s[32:35], s93 offen offset:0 sc1
buffer_load_dwordx4 v[20:23], v7, s[32:35], s93 offen offset:512 sc1
s_waitcnt lgkmcnt(4)
v_pk_add_f32 v[80:81], v[80:81], v[84:85]
v_pk_add_f32 v[82:83], v[82:83], v[86:87]
v_pk_add_f32 v[88:89], v[88:89], v[92:93]
v_pk_add_f32 v[90:91], v[90:91], v[94:95]
v_pk_add_f32 v[80:81], v[80:81], v[88:89]
v_pk_add_f32 v[82:83], v[82:83], v[90:91]
v_pk_fma_f32 v[224:225], v[80:81], s[60:61], v[224:225]
v_pk_fma_f32 v[226:227], v[82:83], s[60:61], v[226:227]
s_waitcnt lgkmcnt(0)
s_barrier
ds_read_b128 v[96:99], v6 offset:4096
ds_read_b128 v[100:103], v6 offset:12288
ds_read_b128 v[104:107], v6 offset:20480
ds_read_b128 v[108:111], v6 offset:28672
v_pk_mul_f32 v[240:241], v[224:225], v[232:233]
v_pk_mul_f32 v[242:243], v[226:227], v[234:235]
v_pk_add_f32 v[48:49], v[224:225], v[226:227]
v_pk_mul_f32 v[50:51], v[224:225], v[224:225]
v_pk_mul_f32 v[54:55], v[240:241], v[224:225]
v_pk_add_f32 v[52:53], v[240:241], v[242:243]
v_pk_mul_f32 v[56:57], v[240:241], v[240:241]
v_pk_mul_f32 v[58:59], v[240:241], v[232:233]
v_pk_fma_f32 v[50:51], v[226:227], v[226:227], v[50:51]
v_pk_fma_f32 v[54:55], v[242:243], v[226:227], v[54:55]
v_pk_fma_f32 v[56:57], v[242:243], v[242:243], v[56:57]
v_pk_fma_f32 v[58:59], v[242:243], v[234:235], v[58:59]
s_waitcnt lgkmcnt(0)
v_pk_add_f32 v[96:97], v[96:97], v[100:101]
v_pk_add_f32 v[98:99], v[98:99], v[102:103]
v_pk_add_f32 v[104:105], v[104:105], v[108:109]
v_pk_add_f32 v[106:107], v[106:107], v[110:111]
v_pk_add_f32 v[96:97], v[96:97], v[104:105]
v_pk_add_f32 v[98:99], v[98:99], v[106:107]
v_pk_fma_f32 v[228:229], v[96:97], s[60:61], v[228:229]
v_pk_fma_f32 v[230:231], v[98:99], s[60:61], v[230:231]
v_pk_mul_f32 v[244:245], v[228:229], v[236:237]
v_pk_mul_f32 v[246:247], v[230:231], v[238:239]
v_pk_add_f32 v[48:49], v[48:49], v[228:229]
v_pk_fma_f32 v[50:51], v[228:229], v[228:229], v[50:51]
v_pk_fma_f32 v[54:55], v[244:245], v[228:229], v[54:55]
v_pk_add_f32 v[52:53], v[52:53], v[244:245]
v_pk_fma_f32 v[56:57], v[244:245], v[244:245], v[56:57]
v_pk_fma_f32 v[58:59], v[244:245], v[236:237], v[58:59]
v_pk_add_f32 v[48:49], v[48:49], v[230:231]
v_pk_add_f32 v[52:53], v[52:53], v[246:247]
v_pk_fma_f32 v[50:51], v[230:231], v[230:231], v[50:51]
v_pk_fma_f32 v[54:55], v[246:247], v[230:231], v[54:55]
v_pk_fma_f32 v[56:57], v[246:247], v[246:247], v[56:57]
v_pk_fma_f32 v[58:59], v[246:247], v[238:239], v[58:59]
v_add_f32 v248, v48, v49
v_add_f32 v249, v50, v51
v_add_f32 v250, v52, v53
v_add_f32 v252, v54, v55
v_add_f32 v253, v56, v57
v_add_f32 v254, v58, v59
v_add_f32_dpp v248, v248, v248 row_ror:8 row_mask:0xf bank_mask:0xf
v_add_f32_dpp v252, v252, v252 row_ror:8 row_mask:0xf bank_mask:0xf
v_add_f32_dpp v249, v249, v249 row_ror:8 row_mask:0xf bank_mask:0xf
v_add_f32_dpp v253, v253, v253 row_ror:8 row_mask:0xf bank_mask:0xf
v_add_f32_dpp v250, v250, v250 row_ror:8 row_mask:0xf bank_mask:0xf
v_add_f32_dpp v254, v254, v254 row_ror:8 row_mask:0xf bank_mask:0xf
v_mov_b32 v251, s94
v_permlane16_swap_b32 v248, v252
v_permlane16_swap_b32 v249, v253
v_permlane16_swap_b32 v250, v254
v_add_f32 v248, v248, v252
v_add_f32 v249, v249, v253
v_add_f32 v250, v250, v254
v_mov_b32 v252, v248
v_mov_b32 v253, v249
v_mov_b32 v254, v250
v_permlane32_swap_b32 v248, v252
v_permlane32_swap_b32 v249, v253
v_permlane32_swap_b32 v250, v254
v_add_f32 v248, v248, v252
v_add_f32 v249, v249, v253
v_add_f32 v250, v250, v254
s_mov_b32 exec_lo, 0x00ff00ff
s_mov_b32 exec_hi, 0
s_cmp_eq_u32 s71, 1
s_cbranch_scc0 OS_53
buffer_store_dwordx4 v[248:251], v10, s[32:35], s63 offen offset:2048
OSb_54:
s_mov_b64 exec, -1
buffer_load_dwordx4 v[24:27], v7, s[32:35], s93 offen offset:2048 sc1
buffer_load_dwordx4 v[28:31], v7, s[32:35], s93 offen offset:2560 sc1
s_waitcnt vmcnt(3)
v_cmp_eq_u32 vcc, s94, v19
v_cmp_eq_u32 s[64:65], s94, v23
s_nop 0
s_and_b64 vcc, vcc, s[64:65]
s_cmp_eq_u64 vcc, exec
s_cbranch_scc0 SPo_57
SPd_56:
v_accvgpr_read_b32 v45, a240
v_accvgpr_read_b32 v46, a241
v_add_f32 v16, v16, v20
v_add_f32 v17, v17, v21
v_add_f32 v18, v18, v22
v_add_f32_dpp v16, v16, v16 row_ror:8 row_mask:0xf bank_mask:0xf
v_add_f32_dpp v17, v17, v17 row_ror:8 row_mask:0xf bank_mask:0xf
v_add_f32_dpp v18, v18, v18 row_ror:8 row_mask:0xf bank_mask:0xf
v_mov_b32 v20, v16
v_mov_b32 v21, v17
v_mov_b32 v22, v18
v_permlane16_swap_b32 v16, v20
v_permlane16_swap_b32 v17, v21
v_permlane16_swap_b32 v18, v22
v_add_f32 v16, v16, v20
v_add_f32 v17, v17, v21
v_add_f32 v18, v18, v22
v_mov_b32 v20, v16
v_mov_b32 v21, v17
v_mov_b32 v22, v18
v_permlane32_swap_b32 v16, v20
v_permlane32_swap_b32 v17, v21
v_permlane32_swap_b32 v18, v22
buffer_load_dwordx4 v[80:83], v7, s[32:35], s93 offen offset:2048 sc1
buffer_load_dwordx4 v[84:87], v7, s[32:35], s93 offen offset:2560 sc1
v_mul_f32 v32, 0x3b000000, v16
v_mul_f32 v34, 0x3b000000, v17
v_fma_f32 v34, -v32, v32, v34
v_fma_f32 v42, -v32, v45, v18
v_max_f32 v34, 0, v34
v_fma_f32 v43, -v32, v18, v20
v_add_f32 v34, 0x3727c5ac, v34
v_fma_f32 v46, v32, v46, -v22
v_rsq_f32 v34, v34
v_sub_f32 v46, v46, v22
v_fma_f32 v46, v32, v46, v21
v_fma_f32 v44, v34, v42, v16
v_fma_f32 v46, v34, v46, v43
v_mul_f32 v44, 0x3b000000, v44
v_add_f32 v46, v46, v43
v_mul_f32 v36, v32, v34
v_fma_f32 v46, v34, v46, v17
v_sub_f32 v36, 0, v36
v_mul_f32 v46, 0x3b000000, v46
v_fma_f32 v46, -v44, v44, v46
v_pk_fma_f32 v[192:193], v[208:209], v[34:35], v[192:193] op_sel_hi:[1,0,1]
v_max_f32 v46, 0, v46
v_pk_fma_f32 v[194:195], v[210:211], v[34:35], v[194:195] op_sel_hi:[1,0,1]
v_add_f32 v46, 0x3727c5ac, v46
v_pk_fma_f32 v[196:197], v[212:213], v[34:35], v[196:197] op_sel_hi:[1,0,1]
v_rsq_f32 v38, v46
v_pk_fma_f32 v[198:199], v[214:215], v[34:35], v[198:199] op_sel_hi:[1,0,1]
v_pk_fma_f32 v[192:193], v[200:201], v[36:37], v[192:193] op_sel_hi:[1,0,1]
v_mul_f32 v38, 0x3fb8aa3b, v38
v_pk_fma_f32 v[194:195], v[202:203], v[36:37], v[194:195] op_sel_hi:[1,0,1]
v_mul_f32 v40, v44, v38
v_pk_fma_f32 v[196:197], v[204:205], v[36:37], v[196:197] op_sel_hi:[1,0,1]
v_sub_f32 v40, 0, v40
v_pk_fma_f32 v[198:199], v[206:207], v[36:37], v[198:199] op_sel_hi:[1,0,1]
v_pk_fma_f32 v[208:209], v[192:193], v[38:39], v[40:41] op_sel_hi:[1,0,0]
v_pk_fma_f32 v[210:211], v[194:195], v[38:39], v[40:41] op_sel_hi:[1,0,0]
v_pk_fma_f32 v[212:213], v[196:197], v[38:39], v[40:41] op_sel_hi:[1,0,0]
v_pk_fma_f32 v[214:215], v[198:199], v[38:39], v[40:41] op_sel_hi:[1,0,0]
v_cvt_pk_bf16_f32 v200, v208, v209
v_cvt_pk_bf16_f32 v201, v210, v211
v_cvt_pk_bf16_f32 v202, v212, v213
v_cvt_pk_bf16_f32 v203, v214, v215
buffer_store_dwordx2 v[200:201], v9, s[32:35], s57 offen offset:0
buffer_store_dwordx2 v[202:203], v9, s[32:35], s57 offen offset:2048
s_mov_b32 s62, 0
s_waitcnt vmcnt(4)
v_cmp_eq_u32 vcc, s94, v27
v_cmp_eq_u32 s[64:65], s94, v31
s_nop 0
s_and_b64 vcc, vcc, s[64:65]
s_cmp_eq_u64 vcc, exec
s_cbranch_scc1 SPd_59
s_waitcnt vmcnt(2)
v_mov_b32 v24, v80
v_mov_b32 v25, v81
v_mov_b32 v26, v82
v_mov_b32 v27, v83
v_mov_b32 v28, v84
v_mov_b32 v29, v85
v_mov_b32 v30, v86
v_mov_b32 v31, v87
SPl_58:
v_cmp_eq_u32 vcc, s94, v27
v_cmp_eq_u32 s[64:65], s94, v31
s_nop 0
s_and_b64 vcc, vcc, s[64:65]
s_cmp_eq_u64 vcc, exec
s_cbranch_scc1 SPd_59
buffer_load_dwordx4 v[24:27], v7, s[32:35], s93 offen offset:2048 sc1
buffer_load_dwordx4 v[28:31], v7, s[32:35], s93 offen offset:2560 sc1
s_waitcnt vmcnt(0)
s_add_u32 s62, s62, 1
s_cmp_lt_u32 s62, 65536
s_cbranch_scc1 SPl_58
SPd_59:
v_accvgpr_read_b32 v45, a242
v_accvgpr_read_b32 v46, a243
v_add_f32 v24, v24, v28
v_add_f32 v25, v25, v29
v_add_f32 v26, v26, v30
v_add_f32_dpp v24, v24, v24 row_ror:8 row_mask:0xf bank_mask:0xf
v_add_f32_dpp v25, v25, v25 row_ror:8 row_mask:0xf bank_mask:0xf
v_add_f32_dpp v26, v26, v26 row_ror:8 row_mask:0xf bank_mask:0xf
v_mov_b32 v28, v24
v_mov_b32 v29, v25
s_waitcnt vmcnt(0)
s_add_u32 s96, s99, 8192
v_add_u32_e64 v2, s53, 6
s_cmp_eq_u32 s71, 1
s_cbranch_scc0 OS_61
buffer_store_dword v2, off, s[32:35], s96 offset:0
OSb_62:
v_mov_b32 v30, v26
v_permlane16_swap_b32 v24, v28
v_permlane16_swap_b32 v25, v29
v_permlane16_swap_b32 v26, v30
v_add_f32 v24, v24, v28
v_add_f32 v25, v25, v29
v_add_f32 v26, v26, v30
v_mov_b32 v28, v24
v_mov_b32 v29, v25
v_mov_b32 v30, v26
v_permlane32_swap_b32 v24, v28
v_permlane32_swap_b32 v25, v29
v_permlane32_swap_b32 v26, v30
v_mul_f32 v32, 0x3b000000, v24
v_mul_f32 v34, 0x3b000000, v25
v_fma_f32 v34, -v32, v32, v34
v_fma_f32 v42, -v32, v45, v26
v_max_f32 v34, 0, v34
v_fma_f32 v43, -v32, v26, v28
v_add_f32 v34, 0x3727c5ac, v34
v_fma_f32 v46, v32, v46, -v30
v_rsq_f32 v34, v34
v_sub_f32 v46, v46, v30
v_fma_f32 v46, v32, v46, v29
v_fma_f32 v44, v34, v42, v24
v_fma_f32 v46, v34, v46, v43
v_mul_f32 v44, 0x3b000000, v44
v_add_f32 v46, v46, v43
v_mul_f32 v36, v32, v34
v_fma_f32 v46, v34, v46, v25
v_sub_f32 v36, 0, v36
v_mul_f32 v46, 0x3b000000, v46
v_fma_f32 v46, -v44, v44, v46
v_pk_fma_f32 v[224:225], v[240:241], v[34:35], v[224:225] op_sel_hi:[1,0,1]
v_max_f32 v46, 0, v46
v_pk_fma_f32 v[226:227], v[242:243], v[34:35], v[226:227] op_sel_hi:[1,0,1]
v_add_f32 v46, 0x3727c5ac, v46
v_pk_fma_f32 v[228:229], v[244:245], v[34:35], v[228:229] op_sel_hi:[1,0,1]
v_rsq_f32 v38, v46
v_pk_fma_f32 v[230:231], v[246:247], v[34:35], v[230:231] op_sel_hi:[1,0,1]
v_pk_fma_f32 v[224:225], v[232:233], v[36:37], v[224:225] op_sel_hi:[1,0,1]
v_mul_f32 v38, 0x3fb8aa3b, v38
v_pk_fma_f32 v[226:227], v[234:235], v[36:37], v[226:227] op_sel_hi:[1,0,1]
v_mul_f32 v40, v44, v38
v_pk_fma_f32 v[228:229], v[236:237], v[36:37], v[228:229] op_sel_hi:[1,0,1]
v_sub_f32 v40, 0, v40
v_pk_fma_f32 v[230:231], v[238:239], v[36:37], v[230:231] op_sel_hi:[1,0,1]
v_pk_fma_f32 v[240:241], v[224:225], v[38:39], v[40:41] op_sel_hi:[1,0,0]
v_pk_fma_f32 v[242:243], v[226:227], v[38:39], v[40:41] op_sel_hi:[1,0,0]
v_pk_fma_f32 v[244:245], v[228:229], v[38:39], v[40:41] op_sel_hi:[1,0,0]
v_pk_fma_f32 v[246:247], v[230:231], v[38:39], v[40:41] op_sel_hi:[1,0,0]
v_cvt_pk_bf16_f32 v232, v240, v241
v_cvt_pk_bf16_f32 v233, v242, v243
v_cvt_pk_bf16_f32 v234, v244, v245
v_cvt_pk_bf16_f32 v235, v246, v247
buffer_store_dwordx2 v[232:233], v9, s[32:35], s58 offen offset:0
buffer_store_dwordx2 v[234:235], v9, s[32:35], s58 offen offset:2048
v_accvgpr_read_b32 v14, a246
buffer_load_dword v15, v14, s[32:35], 0 offen sc1
v_accvgpr_write_b32 a224, v192
v_accvgpr_write_b32 a225, v193
v_accvgpr_write_b32 a226, v194
v_accvgpr_write_b32 a227, v195
v_accvgpr_write_b32 a228, v196
v_accvgpr_write_b32 a229, v197
v_accvgpr_write_b32 a230, v198
v_accvgpr_write_b32 a231, v199
v_accvgpr_write_b32 a232, v224
v_accvgpr_write_b32 a233, v225
v_accvgpr_write_b32 a234, v226
v_accvgpr_write_b32 a235, v227
v_accvgpr_write_b32 a236, v228
v_accvgpr_write_b32 a237, v229
v_accvgpr_write_b32 a238, v230
v_accvgpr_write_b32 a239, v231
v_lshrrev_b32 v3, 4, v1
v_bfe_u32 v2, v1, 2, 2
v_lshl_add_u32 v3, v3, 3, v2
v_lshlrev_b32 v3, 7, v3
v_and_b32 v2, 1, v1
v_lshl_add_u32 v3, v2, 4, v3
v_bfe_u32 v2, v1, 1, 1
v_lshl_add_u32 v3, v2, 3, v3
v_bfe_u32 v2, v1, 4, 1
v_bfe_u32 v13, v1, 3, 1
v_lshl_add_u32 v2, v13, 1, v2
v_xor_b32 v13, 0, v2
v_lshl_add_u32 v4, v13, 5, v3
v_add_u32 v9, 0x10000, v4
v_xor_b32 v13, 1, v2
v_lshl_add_u32 v5, v13, 5, v3
v_add_u32 v10, 0x10000, v5
v_xor_b32 v13, 2, v2
v_lshl_add_u32 v6, v13, 5, v3
v_add_u32 v11, 0x10000, v6
v_xor_b32 v13, 3, v2
v_lshl_add_u32 v7, v13, 5, v3
v_add_u32 v12, 0x10000, v7
v_lshrrev_b32 v2, 5, v1
v_lshlrev_b32 v2, 10, v2
v_bfe_u32 v3, v1, 4, 1
v_lshl_add_u32 v2, v3, 9, v2
v_and_b32 v3, 15, v1
v_lshl_add_u32 v13, v3, 4, v2
s_mov_b32 s40, s24
s_and_b32 s41, s25, 0xffff
s_mov_b32 s42, 0x200000
s_mov_b32 s43, 0x00020000
s_add_u32 s96, s53, 6
s_waitcnt vmcnt(0)
v_cmp_ne_u32 vcc, s96, v15
s_nop 0
s_cbranch_vccnz HZ_63
HZb_64:
s_mov_b32 s54, s80
buffer_load_dwordx4 v[128:131], v13, s[32:35], s54 offen offset:0 sc1
buffer_load_dwordx4 v[132:135], v13, s[32:35], s54 offen offset:256 sc1
buffer_load_dwordx4 v[136:139], v13, s[32:35], s54 offen offset:2048 sc1
buffer_load_dwordx4 v[140:143], v13, s[32:35], s54 offen offset:2304 sc1
s_add_u32 s54, s54, 4096
buffer_load_dwordx4 v[144:147], v13, s[32:35], s54 offen offset:0 sc1
buffer_load_dwordx4 v[148:151], v13, s[32:35], s54 offen offset:256 sc1
buffer_load_dwordx4 v[152:155], v13, s[32:35], s54 offen offset:2048 sc1
buffer_load_dwordx4 v[156:159], v13, s[32:35], s54 offen offset:2304 sc1
s_barrier
s_cmp_eq_u32 s70, 1
s_cbranch_scc1 G1o_66
ds_read_b64_tr_b16 v[16:17], v4 offset:0
ds_read_b64_tr_b16 v[18:19], v4 offset:512
ds_read_b64_tr_b16 v[20:21], v9 offset:0
ds_read_b64_tr_b16 v[22:23], v9 offset:512
ds_read_b64_tr_b16 v[24:25], v5 offset:0
ds_read_b64_tr_b16 v[26:27], v5 offset:512
ds_read_b64_tr_b16 v[28:29], v10 offset:0
ds_read_b64_tr_b16 v[30:31], v10 offset:512
ds_read_b64_tr_b16 v[32:33], v6 offset:0
ds_read_b64_tr_b16 v[34:35], v6 offset:512
ds_read_b64_tr_b16 v[36:37], v11 offset:0
ds_read_b64_tr_b16 v[38:39], v11 offset:512
ds_read_b64_tr_b16 v[40:41], v4 offset:4096
ds_read_b64_tr_b16 v[42:43], v4 offset:4608
s_waitcnt vmcnt(6) lgkmcnt(6)
v_mfma_f32_16x16x32_bf16 v[48:51], v[16:19], v[128:131], 0
ds_read_b64_tr_b16 v[44:45], v9 offset:4096
ds_read_b64_tr_b16 v[46:47], v9 offset:4608
v_mfma_f32_16x16x32_bf16 v[52:55], v[16:19], v[132:135], 0
s_add_u32 s54, s54, 4096
buffer_load_dwordx4 v[160:163], v13, s[32:35], s54 offen offset:0 sc1
v_mfma_f32_16x16x32_bf16 v[56:59], v[20:23], v[128:131], 0
ds_read_b64_tr_b16 v[16:17], v5 offset:4096
ds_read_b64_tr_b16 v[18:19], v5 offset:4608
v_mfma_f32_16x16x32_bf16 v[60:63], v[20:23], v[132:135], 0
v_mfma_f32_16x16x32_bf16 v[64:67], v[24:27], v[128:131], 0
ds_read_b64_tr_b16 v[20:21], v10 offset:4096
ds_read_b64_tr_b16 v[22:23], v10 offset:4608
v_mfma_f32_16x16x32_bf16 v[68:71], v[24:27], v[132:135], 0
buffer_load_dwordx4 v[164:167], v13, s[32:35], s54 offen offset:256 sc1
v_mfma_f32_16x16x32_bf16 v[72:75], v[28:31], v[128:131], 0
ds_read_b64_tr_b16 v[24:25], v6 offset:4096
ds_read_b64_tr_b16 v[26:27], v6 offset:4608
v_mfma_f32_16x16x32_bf16 v[76:79], v[28:31], v[132:135], 0
s_waitcnt lgkmcnt(6)
v_mfma_f32_16x16x32_bf16 v[80:83], v[32:35], v[128:131], 0
ds_read_b64_tr_b16 v[28:29], v11 offset:4096
ds_read_b64_tr_b16 v[30:31], v11 offset:4608
v_mfma_f32_16x16x32_bf16 v[84:87], v[32:35], v[132:135], 0
buffer_load_dwordx4 v[168:171], v13, s[32:35], s54 offen offset:2048 sc1
v_mfma_f32_16x16x32_bf16 v[88:91], v[36:39], v[128:131], 0
ds_read_b64_tr_b16 v[32:33], v4 offset:8192
ds_read_b64_tr_b16 v[34:35], v4 offset:8704
v_mfma_f32_16x16x32_bf16 v[92:95], v[36:39], v[132:135], 0
s_waitcnt vmcnt(7)
v_mfma_f32_16x16x32_bf16 v[48:51], v[40:43], v[136:139], v[48:51]
ds_read_b64_tr_b16 v[36:37], v9 offset:8192
ds_read_b64_tr_b16 v[38:39], v9 offset:8704
v_mfma_f32_16x16x32_bf16 v[52:55], v[40:43], v[140:143], v[52:55]
buffer_load_dwordx4 v[172:175], v13, s[32:35], s54 offen offset:2304 sc1
v_mfma_f32_16x16x32_bf16 v[56:59], v[44:47], v[136:139], v[56:59]
ds_read_b64_tr_b16 v[40:41], v5 offset:8192
ds_read_b64_tr_b16 v[42:43], v5 offset:8704
v_mfma_f32_16x16x32_bf16 v[60:63], v[44:47], v[140:143], v[60:63]
s_waitcnt lgkmcnt(6)
v_mfma_f32_16x16x32_bf16 v[64:67], v[16:19], v[136:139], v[64:67]
ds_read_b64_tr_b16 v[44:45], v10 offset:8192
ds_read_b64_tr_b16 v[46:47], v10 offset:8704
v_mfma_f32_16x16x32_bf16 v[68:71], v[16:19], v[140:143], v[68:71]
s_add_u32 s54, s54, 4096
buffer_load_dwordx4 v[176:179], v13, s[32:35], s54 offen offset:0 sc1
v_mfma_f32_16x16x32_bf16 v[72:75], v[20:23], v[136:139], v[72:75]
ds_read_b64_tr_b16 v[16:17], v6 offset:8192
ds_read_b64_tr_b16 v[18:19], v6 offset:8704
v_mfma_f32_16x16x32_bf16 v[76:79], v[20:23], v[140:143], v[76:79]
v_mfma_f32_16x16x32_bf16 v[80:83], v[24:27], v[136:139], v[80:83]
ds_read_b64_tr_b16 v[20:21], v11 offset:8192
ds_read_b64_tr_b16 v[22:23], v11 offset:8704
v_mfma_f32_16x16x32_bf16 v[84:87], v[24:27], v[140:143], v[84:87]
buffer_load_dwordx4 v[180:183], v13, s[32:35], s54 offen offset:256 sc1
v_mfma_f32_16x16x32_bf16 v[88:91], v[28:31], v[136:139], v[88:91]
ds_read_b64_tr_b16 v[24:25], v4 offset:12288
ds_read_b64_tr_b16 v[26:27], v4 offset:12800
v_mfma_f32_16x16x32_bf16 v[92:95], v[28:31], v[140:143], v[92:95]
s_waitcnt vmcnt(8) lgkmcnt(6)
v_mfma_f32_16x16x32_bf16 v[48:51], v[32:35], v[144:147], v[48:51]
ds_read_b64_tr_b16 v[28:29], v9 offset:12288
ds_read_b64_tr_b16 v[30:31], v9 offset:12800
v_mfma_f32_16x16x32_bf16 v[52:55], v[32:35], v[148:151], v[52:55]
s_add_u32 s96, s99, 8192
v_add_u32_e64 v2, s53, 6
s_cmp_eq_u32 s71, 1
s_cbranch_scc0 OS_68
buffer_store_dword v2, off, s[32:35], s96 offset:512
OSb_69:
v_mfma_f32_16x16x32_bf16 v[56:59], v[36:39], v[144:147], v[56:59]
ds_read_b64_tr_b16 v[32:33], v5 offset:12288
ds_read_b64_tr_b16 v[34:35], v5 offset:12800
v_mfma_f32_16x16x32_bf16 v[60:63], v[36:39], v[148:151], v[60:63]
buffer_load_dwordx4 v[184:187], v13, s[32:35], s54 offen offset:2048 sc1
v_mfma_f32_16x16x32_bf16 v[64:67], v[40:43], v[144:147], v[64:67]
ds_read_b64_tr_b16 v[36:37], v10 offset:12288
ds_read_b64_tr_b16 v[38:39], v10 offset:12800
v_mfma_f32_16x16x32_bf16 v[68:71], v[40:43], v[148:151], v[68:71]
v_mfma_f32_16x16x32_bf16 v[72:75], v[44:47], v[144:147], v[72:75]
ds_read_b64_tr_b16 v[40:41], v6 offset:12288
ds_read_b64_tr_b16 v[42:43], v6 offset:12800
v_mfma_f32_16x16x32_bf16 v[76:79], v[44:47], v[148:151], v[76:79]
buffer_load_dwordx4 v[188:191], v13, s[32:35], s54 offen offset:2304 sc1
s_waitcnt lgkmcnt(6)
v_mfma_f32_16x16x32_bf16 v[80:83], v[16:19], v[144:147], v[80:83]
ds_read_b64_tr_b16 v[44:45], v11 offset:12288
ds_read_b64_tr_b16 v[46:47], v11 offset:12800
v_mfma_f32_16x16x32_bf16 v[84:87], v[16:19], v[148:151], v[84:87]
v_mfma_f32_16x16x32_bf16 v[88:91], v[20:23], v[144:147], v[88:91]
ds_read_b64_tr_b16 v[16:17], v4 offset:16384
ds_read_b64_tr_b16 v[18:19], v4 offset:16896
v_mfma_f32_16x16x32_bf16 v[92:95], v[20:23], v[148:151], v[92:95]
s_add_u32 s54, s54, 4096
buffer_load_dwordx4 v[192:195], v13, s[32:35], s54 offen offset:0 sc1
s_waitcnt vmcnt(10)
v_mfma_f32_16x16x32_bf16 v[48:51], v[24:27], v[152:155], v[48:51]
ds_read_b64_tr_b16 v[20:21], v9 offset:16384
ds_read_b64_tr_b16 v[22:23], v9 offset:16896
v_mfma_f32_16x16x32_bf16 v[52:55], v[24:27], v[156:159], v[52:55]
v_mfma_f32_16x16x32_bf16 v[56:59], v[28:31], v[152:155], v[56:59]
ds_read_b64_tr_b16 v[24:25], v5 offset:16384
ds_read_b64_tr_b16 v[26:27], v5 offset:16896
v_mfma_f32_16x16x32_bf16 v[60:63], v[28:31], v[156:159], v[60:63]
buffer_load_dwordx4 v[196:199], v13, s[32:35], s54 offen offset:256 sc1
s_waitcnt lgkmcnt(6)
v_mfma_f32_16x16x32_bf16 v[64:67], v[32:35], v[152:155], v[64:67]
ds_read_b64_tr_b16 v[28:29], v10 offset:16384
ds_read_b64_tr_b16 v[30:31], v10 offset:16896
v_mfma_f32_16x16x32_bf16 v[68:71], v[32:35], v[156:159], v[68:71]
v_mfma_f32_16x16x32_bf16 v[72:75], v[36:39], v[152:155], v[72:75]
ds_read_b64_tr_b16 v[32:33], v6 offset:16384
ds_read_b64_tr_b16 v[34:35], v6 offset:16896
v_mfma_f32_16x16x32_bf16 v[76:79], v[36:39], v[156:159], v[76:79]
buffer_load_dwordx4 v[200:203], v13, s[32:35], s54 offen offset:2048 sc1
v_mfma_f32_16x16x32_bf16 v[80:83], v[40:43], v[152:155], v[80:83]
ds_read_b64_tr_b16 v[36:37], v11 offset:16384
ds_read_b64_tr_b16 v[38:39], v11 offset:16896
v_mfma_f32_16x16x32_bf16 v[84:87], v[40:43], v[156:159], v[84:87]
v_mfma_f32_16x16x32_bf16 v[88:91], v[44:47], v[152:155], v[88:91]
ds_read_b64_tr_b16 v[40:41], v4 offset:20480
ds_read_b64_tr_b16 v[42:43], v4 offset:20992
v_mfma_f32_16x16x32_bf16 v[92:95], v[44:47], v[156:159], v[92:95]
buffer_load_dwordx4 v[204:207], v13, s[32:35], s54 offen offset:2304 sc1
s_waitcnt vmcnt(11) lgkmcnt(6)
v_mfma_f32_16x16x32_bf16 v[48:51], v[16:19], v[160:163], v[48:51]
ds_read_b64_tr_b16 v[44:45], v9 offset:20480
ds_read_b64_tr_b16 v[46:47], v9 offset:20992
v_mfma_f32_16x16x32_bf16 v[52:55], v[16:19], v[164:167], v[52:55]
v_mfma_f32_16x16x32_bf16 v[56:59], v[20:23], v[160:163], v[56:59]
ds_read_b64_tr_b16 v[16:17], v5 offset:20480
ds_read_b64_tr_b16 v[18:19], v5 offset:20992
v_mfma_f32_16x16x32_bf16 v[60:63], v[20:23], v[164:167], v[60:63]
s_add_u32 s54, s54, 4096
buffer_load_dwordx4 v[208:211], v13, s[32:35], s54 offen offset:0 sc1
v_mfma_f32_16x16x32_bf16 v[64:67], v[24:27], v[160:163], v[64:67]
ds_read_b64_tr_b16 v[20:21], v10 offset:20480
ds_read_b64_tr_b16 v[22:23], v10 offset:20992
v_mfma_f32_16x16x32_bf16 v[68:71], v[24:27], v[164:167], v[68:71]
v_accvgpr_read_b32 v14, a247
buffer_load_dword v15, v14, s[32:35], 0 offen sc1
v_mfma_f32_16x16x32_bf16 v[72:75], v[28:31], v[160:163], v[72:75]
ds_read_b64_tr_b16 v[24:25], v6 offset:20480
ds_read_b64_tr_b16 v[26:27], v6 offset:20992
v_mfma_f32_16x16x32_bf16 v[76:79], v[28:31], v[164:167], v[76:79]
buffer_load_dwordx4 v[212:215], v13, s[32:35], s54 offen offset:256 sc1
s_waitcnt lgkmcnt(6)
v_mfma_f32_16x16x32_bf16 v[80:83], v[32:35], v[160:163], v[80:83]
ds_read_b64_tr_b16 v[28:29], v11 offset:20480
ds_read_b64_tr_b16 v[30:31], v11 offset:20992
v_mfma_f32_16x16x32_bf16 v[84:87], v[32:35], v[164:167], v[84:87]
v_mfma_f32_16x16x32_bf16 v[88:91], v[36:39], v[160:163], v[88:91]
ds_read_b64_tr_b16 v[32:33], v4 offset:24576
ds_read_b64_tr_b16 v[34:35], v4 offset:25088
v_mfma_f32_16x16x32_bf16 v[92:95], v[36:39], v[164:167], v[92:95]
buffer_load_dwordx4 v[216:219], v13, s[32:35], s54 offen offset:2048 sc1
s_waitcnt vmcnt(13)
v_mfma_f32_16x16x32_bf16 v[48:51], v[40:43], v[168:171], v[48:51]
ds_read_b64_tr_b16 v[36:37], v9 offset:24576
ds_read_b64_tr_b16 v[38:39], v9 offset:25088
v_mfma_f32_16x16x32_bf16 v[52:55], v[40:43], v[172:175], v[52:55]
v_mfma_f32_16x16x32_bf16 v[56:59], v[44:47], v[168:171], v[56:59]
ds_read_b64_tr_b16 v[40:41], v5 offset:24576
ds_read_b64_tr_b16 v[42:43], v5 offset:25088
v_mfma_f32_16x16x32_bf16 v[60:63], v[44:47], v[172:175], v[60:63]
buffer_load_dwordx4 v[220:223], v13, s[32:35], s54 offen offset:2304 sc1
s_waitcnt lgkmcnt(6)
v_mfma_f32_16x16x32_bf16 v[64:67], v[16:19], v[168:171], v[64:67]
ds_read_b64_tr_b16 v[44:45], v10 offset:24576
ds_read_b64_tr_b16 v[46:47], v10 offset:25088
v_mfma_f32_16x16x32_bf16 v[68:71], v[16:19], v[172:175], v[68:71]
v_mfma_f32_16x16x32_bf16 v[72:75], v[20:23], v[168:171], v[72:75]
ds_read_b64_tr_b16 v[16:17], v6 offset:24576
ds_read_b64_tr_b16 v[18:19], v6 offset:25088
v_mfma_f32_16x16x32_bf16 v[76:79], v[20:23], v[172:175], v[76:79]
s_add_u32 s54, s54, 4096
buffer_load_dwordx4 v[224:227], v13, s[32:35], s54 offen offset:0 sc1
v_mfma_f32_16x16x32_bf16 v[80:83], v[24:27], v[168:171], v[80:83]
ds_read_b64_tr_b16 v[20:21], v11 offset:24576
ds_read_b64_tr_b16 v[22:23], v11 offset:25088
v_mfma_f32_16x16x32_bf16 v[84:87], v[24:27], v[172:175], v[84:87]
v_mfma_f32_16x16x32_bf16 v[88:91], v[28:31], v[168:171], v[88:91]
ds_read_b64_tr_b16 v[24:25], v4 offset:28672
ds_read_b64_tr_b16 v[26:27], v4 offset:29184
v_mfma_f32_16x16x32_bf16 v[92:95], v[28:31], v[172:175], v[92:95]
buffer_load_dwordx4 v[228:231], v13, s[32:35], s54 offen offset:256 sc1
s_waitcnt vmcnt(14) lgkmcnt(6)
v_mfma_f32_16x16x32_bf16 v[48:51], v[32:35], v[176:179], v[48:51]
ds_read_b64_tr_b16 v[28:29], v9 offset:28672
ds_read_b64_tr_b16 v[30:31], v9 offset:29184
v_mfma_f32_16x16x32_bf16 v[52:55], v[32:35], v[180:183], v[52:55]
v_mfma_f32_16x16x32_bf16 v[56:59], v[36:39], v[176:179], v[56:59]
ds_read_b64_tr_b16 v[32:33], v5 offset:28672
ds_read_b64_tr_b16 v[34:35], v5 offset:29184
v_mfma_f32_16x16x32_bf16 v[60:63], v[36:39], v[180:183], v[60:63]
buffer_load_dwordx4 v[232:235], v13, s[32:35], s54 offen offset:2048 sc1
v_mfma_f32_16x16x32_bf16 v[64:67], v[40:43], v[176:179], v[64:67]
ds_read_b64_tr_b16 v[36:37], v10 offset:28672
ds_read_b64_tr_b16 v[38:39], v10 offset:29184
v_mfma_f32_16x16x32_bf16 v[68:71], v[40:43], v[180:183], v[68:71]
v_mfma_f32_16x16x32_bf16 v[72:75], v[44:47], v[176:179], v[72:75]
ds_read_b64_tr_b16 v[40:41], v6 offset:28672
ds_read_b64_tr_b16 v[42:43], v6 offset:29184
v_mfma_f32_16x16x32_bf16 v[76:79], v[44:47], v[180:183], v[76:79]
buffer_load_dwordx4 v[236:239], v13, s[32:35], s54 offen offset:2304 sc1
s_waitcnt lgkmcnt(6)
v_mfma_f32_16x16x32_bf16 v[80:83], v[16:19], v[176:179], v[80:83]
ds_read_b64_tr_b16 v[44:45], v11 offset:28672
ds_read_b64_tr_b16 v[46:47], v11 offset:29184
v_mfma_f32_16x16x32_bf16 v[84:87], v[16:19], v[180:183], v[84:87]
s_add_u32 s96, s53, 6
s_waitcnt vmcnt(7)
v_cmp_ne_u32 vcc, s96, v15
v_mfma_f32_16x16x32_bf16 v[88:91], v[20:23], v[176:179], v[88:91]
ds_read_b64_tr_b16 v[16:17], v4 offset:32768
ds_read_b64_tr_b16 v[18:19], v4 offset:33280
v_mfma_f32_16x16x32_bf16 v[92:95], v[20:23], v[180:183], v[92:95]
s_cbranch_vccnz HZ_70
HZb_71:
v_mfma_f32_16x16x32_bf16 v[48:51], v[24:27], v[184:187], v[48:51]
ds_read_b64_tr_b16 v[20:21], v9 offset:32768
ds_read_b64_tr_b16 v[22:23], v9 offset:33280
v_mfma_f32_16x16x32_bf16 v[52:55], v[24:27], v[188:191], v[52:55]
s_add_u32 s54, s54, 4096
buffer_load_dwordx4 v[240:243], v13, s[32:35], s54 offen offset:0 sc1
v_mfma_f32_16x16x32_bf16 v[56:59], v[28:31], v[184:187], v[56:59]
ds_read_b64_tr_b16 v[24:25], v5 offset:32768
ds_read_b64_tr_b16 v[26:27], v5 offset:33280
v_mfma_f32_16x16x32_bf16 v[60:63], v[28:31], v[188:191], v[60:63]
s_waitcnt lgkmcnt(6)
v_mfma_f32_16x16x32_bf16 v[64:67], v[32:35], v[184:187], v[64:67]
ds_read_b64_tr_b16 v[28:29], v10 offset:32768
ds_read_b64_tr_b16 v[30:31], v10 offset:33280
v_mfma_f32_16x16x32_bf16 v[68:71], v[32:35], v[188:191], v[68:71]
buffer_load_dwordx4 v[244:247], v13, s[32:35], s54 offen offset:256 sc1
v_mfma_f32_16x16x32_bf16 v[72:75], v[36:39], v[184:187], v[72:75]
ds_read_b64_tr_b16 v[32:33], v6 offset:32768
ds_read_b64_tr_b16 v[34:35], v6 offset:33280
v_mfma_f32_16x16x32_bf16 v[76:79], v[36:39], v[188:191], v[76:79]
v_mfma_f32_16x16x32_bf16 v[80:83], v[40:43], v[184:187], v[80:83]
ds_read_b64_tr_b16 v[36:37], v11 offset:32768
ds_read_b64_tr_b16 v[38:39], v11 offset:33280
v_mfma_f32_16x16x32_bf16 v[84:87], v[40:43], v[188:191], v[84:87]
buffer_load_dwordx4 v[248:251], v13, s[32:35], s54 offen offset:2048 sc1
v_mfma_f32_16x16x32_bf16 v[88:91], v[44:47], v[184:187], v[88:91]
ds_read_b64_tr_b16 v[40:41], v4 offset:36864
ds_read_b64_tr_b16 v[42:43], v4 offset:37376
v_mfma_f32_16x16x32_bf16 v[92:95], v[44:47], v[188:191], v[92:95]
s_waitcnt lgkmcnt(6)
v_mfma_f32_16x16x32_bf16 v[48:51], v[16:19], v[192:195], v[48:51]
ds_read_b64_tr_b16 v[44:45], v9 offset:36864
ds_read_b64_tr_b16 v[46:47], v9 offset:37376
v_mfma_f32_16x16x32_bf16 v[52:55], v[16:19], v[196:199], v[52:55]
buffer_load_dwordx4 v[252:255], v13, s[32:35], s54 offen offset:2304 sc1
v_mfma_f32_16x16x32_bf16 v[56:59], v[20:23], v[192:195], v[56:59]
ds_read_b64_tr_b16 v[16:17], v5 offset:36864
ds_read_b64_tr_b16 v[18:19], v5 offset:37376
v_mfma_f32_16x16x32_bf16 v[60:63], v[20:23], v[196:199], v[60:63]
v_mfma_f32_16x16x32_bf16 v[64:67], v[24:27], v[192:195], v[64:67]
ds_read_b64_tr_b16 v[20:21], v10 offset:36864
ds_read_b64_tr_b16 v[22:23], v10 offset:37376
v_mfma_f32_16x16x32_bf16 v[68:71], v[24:27], v[196:199], v[68:71]
v_mfma_f32_16x16x32_bf16 v[72:75], v[28:31], v[192:195], v[72:75]
ds_read_b64_tr_b16 v[24:25], v6 offset:36864
ds_read_b64_tr_b16 v[26:27], v6 offset:37376
v_mfma_f32_16x16x32_bf16 v[76:79], v[28:31], v[196:199], v[76:79]
s_waitcnt lgkmcnt(6)
v_mfma_f32_16x16x32_bf16 v[80:83], v[32:35], v[192:195], v[80:83]
ds_read_b64_tr_b16 v[28:29], v11 offset:36864
ds_read_b64_tr_b16 v[30:31], v11 offset:37376
v_mfma_f32_16x16x32_bf16 v[84:87], v[32:35], v[196:199], v[84:87]
v_mfma_f32_16x16x32_bf16 v[88:91], v[36:39], v[192:195], v[88:91]
ds_read_b64_tr_b16 v[32:33], v4 offset:40960
ds_read_b64_tr_b16 v[34:35], v4 offset:41472
v_mfma_f32_16x16x32_bf16 v[92:95], v[36:39], v[196:199], v[92:95]
v_mfma_f32_16x16x32_bf16 v[48:51], v[40:43], v[200:203], v[48:51]
ds_read_b64_tr_b16 v[36:37], v9 offset:40960
ds_read_b64_tr_b16 v[38:39], v9 offset:41472
v_mfma_f32_16x16x32_bf16 v[52:55], v[40:43], v[204:207], v[52:55]
v_mfma_f32_16x16x32_bf16 v[56:59], v[44:47], v[200:203], v[56:59]
ds_read_b64_tr_b16 v[40:41], v4 offset:45056
ds_read_b64_tr_b16 v[42:43], v4 offset:45568
v_mfma_f32_16x16x32_bf16 v[60:63], v[44:47], v[204:207], v[60:63]
s_waitcnt lgkmcnt(6)
v_mfma_f32_16x16x32_bf16 v[64:67], v[16:19], v[200:203], v[64:67]
ds_read_b64_tr_b16 v[44:45], v9 offset:45056
ds_read_b64_tr_b16 v[46:47], v9 offset:45568
v_mfma_f32_16x16x32_bf16 v[68:71], v[16:19], v[204:207], v[68:71]
v_mfma_f32_16x16x32_bf16 v[72:75], v[20:23], v[200:203], v[72:75]
ds_read_b64_tr_b16 v[16:17], v4 offset:49152
ds_read_b64_tr_b16 v[18:19], v4 offset:49664
v_mfma_f32_16x16x32_bf16 v[76:79], v[20:23], v[204:207], v[76:79]
v_mfma_f32_16x16x32_bf16 v[80:83], v[24:27], v[200:203], v[80:83]
ds_read_b64_tr_b16 v[20:21], v9 offset:49152
ds_read_b64_tr_b16 v[22:23], v9 offset:49664
v_mfma_f32_16x16x32_bf16 v[84:87], v[24:27], v[204:207], v[84:87]
v_mfma_f32_16x16x32_bf16 v[88:91], v[28:31], v[200:203], v[88:91]
ds_read_b64_tr_b16 v[24:25], v4 offset:53248
ds_read_b64_tr_b16 v[26:27], v4 offset:53760
v_mfma_f32_16x16x32_bf16 v[92:95], v[28:31], v[204:207], v[92:95]
s_waitcnt vmcnt(10) lgkmcnt(6)
v_mfma_f32_16x16x32_bf16 v[48:51], v[32:35], v[208:211], v[48:51]
ds_read_b64_tr_b16 v[28:29], v9 offset:53248
ds_read_b64_tr_b16 v[30:31], v9 offset:53760
v_mfma_f32_16x16x32_bf16 v[52:55], v[32:35], v[212:215], v[52:55]
v_mfma_f32_16x16x32_bf16 v[56:59], v[36:39], v[208:211], v[56:59]
ds_read_b64_tr_b16 v[32:33], v4 offset:57344
ds_read_b64_tr_b16 v[34:35], v4 offset:57856
v_mfma_f32_16x16x32_bf16 v[60:63], v[36:39], v[212:215], v[60:63]
s_waitcnt vmcnt(8)
v_mfma_f32_16x16x32_bf16 v[48:51], v[40:43], v[216:219], v[48:51]
ds_read_b64_tr_b16 v[36:37], v9 offset:57344
ds_read_b64_tr_b16 v[38:39], v9 offset:57856
v_mfma_f32_16x16x32_bf16 v[52:55], v[40:43], v[220:223], v[52:55]
v_mfma_f32_16x16x32_bf16 v[56:59], v[44:47], v[216:219], v[56:59]
ds_read_b64_tr_b16 v[40:41], v4 offset:61440
ds_read_b64_tr_b16 v[42:43], v4 offset:61952
v_mfma_f32_16x16x32_bf16 v[60:63], v[44:47], v[220:223], v[60:63]
s_waitcnt vmcnt(6) lgkmcnt(6)
v_mfma_f32_16x16x32_bf16 v[48:51], v[16:19], v[224:227], v[48:51]
ds_read_b64_tr_b16 v[44:45], v9 offset:61440
ds_read_b64_tr_b16 v[46:47], v9 offset:61952
v_mfma_f32_16x16x32_bf16 v[52:55], v[16:19], v[228:231], v[52:55]
v_mfma_f32_16x16x32_bf16 v[56:59], v[20:23], v[224:227], v[56:59]
ds_read_b64_tr_b16 v[16:17], v5 offset:40960
ds_read_b64_tr_b16 v[18:19], v5 offset:41472
v_mfma_f32_16x16x32_bf16 v[60:63], v[20:23], v[228:231], v[60:63]
s_waitcnt vmcnt(4)
v_mfma_f32_16x16x32_bf16 v[48:51], v[24:27], v[232:235], v[48:51]
ds_read_b64_tr_b16 v[20:21], v10 offset:40960
ds_read_b64_tr_b16 v[22:23], v10 offset:41472
v_mfma_f32_16x16x32_bf16 v[52:55], v[24:27], v[236:239], v[52:55]
v_mfma_f32_16x16x32_bf16 v[56:59], v[28:31], v[232:235], v[56:59]
ds_read_b64_tr_b16 v[24:25], v5 offset:45056
ds_read_b64_tr_b16 v[26:27], v5 offset:45568
v_mfma_f32_16x16x32_bf16 v[60:63], v[28:31], v[236:239], v[60:63]
s_waitcnt vmcnt(2) lgkmcnt(6)
v_mfma_f32_16x16x32_bf16 v[48:51], v[32:35], v[240:243], v[48:51]
ds_read_b64_tr_b16 v[28:29], v10 offset:45056
ds_read_b64_tr_b16 v[30:31], v10 offset:45568
v_mfma_f32_16x16x32_bf16 v[52:55], v[32:35], v[244:247], v[52:55]
v_mfma_f32_16x16x32_bf16 v[56:59], v[36:39], v[240:243], v[56:59]
ds_read_b64_tr_b16 v[32:33], v5 offset:49152
ds_read_b64_tr_b16 v[34:35], v5 offset:49664
v_mfma_f32_16x16x32_bf16 v[60:63], v[36:39], v[244:247], v[60:63]
s_waitcnt vmcnt(0)
v_mfma_f32_16x16x32_bf16 v[48:51], v[40:43], v[248:251], v[48:51]
ds_read_b64_tr_b16 v[36:37], v10 offset:49152
ds_read_b64_tr_b16 v[38:39], v10 offset:49664
v_mfma_f32_16x16x32_bf16 v[52:55], v[40:43], v[252:255], v[52:55]
v_mfma_f32_16x16x32_bf16 v[56:59], v[44:47], v[248:251], v[56:59]
ds_read_b64_tr_b16 v[40:41], v5 offset:53248
ds_read_b64_tr_b16 v[42:43], v5 offset:53760
v_mfma_f32_16x16x32_bf16 v[60:63], v[44:47], v[252:255], v[60:63]
s_waitcnt lgkmcnt(6)
v_mfma_f32_16x16x32_bf16 v[64:67], v[16:19], v[208:211], v[64:67]
ds_read_b64_tr_b16 v[44:45], v10 offset:53248
ds_read_b64_tr_b16 v[46:47], v10 offset:53760
v_mfma_f32_16x16x32_bf16 v[68:71], v[16:19], v[212:215], v[68:71]
v_mfma_f32_16x16x32_bf16 v[72:75], v[20:23], v[208:211], v[72:75]
ds_read_b64_tr_b16 v[16:17], v5 offset:57344
ds_read_b64_tr_b16 v[18:19], v5 offset:57856
v_mfma_f32_16x16x32_bf16 v[76:79], v[20:23], v[212:215], v[76:79]
v_mfma_f32_16x16x32_bf16 v[64:67], v[24:27], v[216:219], v[64:67]
ds_read_b64_tr_b16 v[20:21], v10 offset:57344
ds_read_b64_tr_b16 v[22:23], v10 offset:57856
v_mfma_f32_16x16x32_bf16 v[68:71], v[24:27], v[220:223], v[68:71]
v_exp_f32 v48, -v48
v_mfma_f32_16x16x32_bf16 v[72:75], v[28:31], v[216:219], v[72:75]
ds_read_b64_tr_b16 v[24:25], v5 offset:61440
ds_read_b64_tr_b16 v[26:27], v5 offset:61952
v_add_f32 v48, 1.0, v48
v_mfma_f32_16x16x32_bf16 v[76:79], v[28:31], v[220:223], v[76:79]
s_waitcnt lgkmcnt(6)
v_exp_f32 v49, -v49
v_mfma_f32_16x16x32_bf16 v[64:67], v[32:35], v[224:227], v[64:67]
ds_read_b64_tr_b16 v[28:29], v10 offset:61440
ds_read_b64_tr_b16 v[30:31], v10 offset:61952
v_add_f32 v49, 1.0, v49
v_mfma_f32_16x16x32_bf16 v[68:71], v[32:35], v[228:231], v[68:71]
v_exp_f32 v50, -v50
v_mfma_f32_16x16x32_bf16 v[72:75], v[36:39], v[224:227], v[72:75]
ds_read_b64_tr_b16 v[32:33], v6 offset:40960
ds_read_b64_tr_b16 v[34:35], v6 offset:41472
v_add_f32 v50, 1.0, v50
v_mfma_f32_16x16x32_bf16 v[76:79], v[36:39], v[228:231], v[76:79]
v_exp_f32 v51, -v51
v_mfma_f32_16x16x32_bf16 v[64:67], v[40:43], v[232:235], v[64:67]
ds_read_b64_tr_b16 v[36:37], v11 offset:40960
ds_read_b64_tr_b16 v[38:39], v11 offset:41472
v_add_f32 v51, 1.0, v51
v_mfma_f32_16x16x32_bf16 v[68:71], v[40:43], v[236:239], v[68:71]
v_exp_f32 v52, -v52
v_mfma_f32_16x16x32_bf16 v[72:75], v[44:47], v[232:235], v[72:75]
ds_read_b64_tr_b16 v[40:41], v6 offset:45056
ds_read_b64_tr_b16 v[42:43], v6 offset:45568
v_add_f32 v52, 1.0, v52
v_mfma_f32_16x16x32_bf16 v[76:79], v[44:47], v[236:239], v[76:79]
s_waitcnt lgkmcnt(6)
v_exp_f32 v53, -v53
v_mfma_f32_16x16x32_bf16 v[64:67], v[16:19], v[240:243], v[64:67]
ds_read_b64_tr_b16 v[44:45], v11 offset:45056
ds_read_b64_tr_b16 v[46:47], v11 offset:45568
v_add_f32 v53, 1.0, v53
v_mfma_f32_16x16x32_bf16 v[68:71], v[16:19], v[244:247], v[68:71]
v_exp_f32 v54, -v54
v_mfma_f32_16x16x32_bf16 v[72:75], v[20:23], v[240:243], v[72:75]
ds_read_b64_tr_b16 v[16:17], v6 offset:49152
ds_read_b64_tr_b16 v[18:19], v6 offset:49664
v_add_f32 v54, 1.0, v54
v_mfma_f32_16x16x32_bf16 v[76:79], v[20:23], v[244:247], v[76:79]
v_exp_f32 v55, -v55
v_mfma_f32_16x16x32_bf16 v[64:67], v[24:27], v[248:251], v[64:67]
ds_read_b64_tr_b16 v[20:21], v11 offset:49152
ds_read_b64_tr_b16 v[22:23], v11 offset:49664
v_add_f32 v55, 1.0, v55
v_mfma_f32_16x16x32_bf16 v[68:71], v[24:27], v[252:255], v[68:71]
v_rcp_f32 v48, v48
v_mfma_f32_16x16x32_bf16 v[72:75], v[28:31], v[248:251], v[72:75]
ds_read_b64_tr_b16 v[24:25], v6 offset:53248
ds_read_b64_tr_b16 v[26:27], v6 offset:53760
v_mul_f32 v48, v48, v56
v_mfma_f32_16x16x32_bf16 v[76:79], v[28:31], v[252:255], v[76:79]
s_waitcnt lgkmcnt(6)
v_rcp_f32 v49, v49
v_mfma_f32_16x16x32_bf16 v[80:83], v[32:35], v[208:211], v[80:83]
ds_read_b64_tr_b16 v[28:29], v11 offset:53248
ds_read_b64_tr_b16 v[30:31], v11 offset:53760
v_mul_f32 v49, v49, v57
v_mfma_f32_16x16x32_bf16 v[84:87], v[32:35], v[212:215], v[84:87]
v_rcp_f32 v50, v50
v_cvt_pk_bf16_f32 v48, v48, v49
v_mfma_f32_16x16x32_bf16 v[88:91], v[36:39], v[208:211], v[88:91]
ds_read_b64_tr_b16 v[32:33], v6 offset:57344
ds_read_b64_tr_b16 v[34:35], v6 offset:57856
v_mul_f32 v50, v50, v58
v_mfma_f32_16x16x32_bf16 v[92:95], v[36:39], v[212:215], v[92:95]
v_rcp_f32 v51, v51
v_mfma_f32_16x16x32_bf16 v[80:83], v[40:43], v[216:219], v[80:83]
ds_read_b64_tr_b16 v[36:37], v11 offset:57344
ds_read_b64_tr_b16 v[38:39], v11 offset:57856
v_mul_f32 v51, v51, v59
v_mfma_f32_16x16x32_bf16 v[84:87], v[40:43], v[220:223], v[84:87]
v_exp_f32 v64, -v64
v_cvt_pk_bf16_f32 v49, v50, v51
v_mfma_f32_16x16x32_bf16 v[88:91], v[44:47], v[216:219], v[88:91]
ds_read_b64_tr_b16 v[40:41], v6 offset:61440
ds_read_b64_tr_b16 v[42:43], v6 offset:61952
v_add_f32 v64, 1.0, v64
v_mfma_f32_16x16x32_bf16 v[92:95], v[44:47], v[220:223], v[92:95]
s_waitcnt lgkmcnt(6)
v_exp_f32 v65, -v65
v_mfma_f32_16x16x32_bf16 v[80:83], v[16:19], v[224:227], v[80:83]
ds_read_b64_tr_b16 v[44:45], v11 offset:61440
ds_read_b64_tr_b16 v[46:47], v11 offset:61952
v_add_f32 v65, 1.0, v65
v_mfma_f32_16x16x32_bf16 v[84:87], v[16:19], v[228:231], v[84:87]
v_exp_f32 v66, -v66
v_mfma_f32_16x16x32_bf16 v[88:91], v[20:23], v[224:227], v[88:91]
ds_read_b64_tr_b16 v[16:17], v7 offset:0
ds_read_b64_tr_b16 v[18:19], v7 offset:512
v_add_f32 v66, 1.0, v66
v_mfma_f32_16x16x32_bf16 v[92:95], v[20:23], v[228:231], v[92:95]
v_exp_f32 v67, -v67
v_mfma_f32_16x16x32_bf16 v[80:83], v[24:27], v[232:235], v[80:83]
ds_read_b64_tr_b16 v[20:21], v12 offset:0
ds_read_b64_tr_b16 v[22:23], v12 offset:512
v_add_f32 v67, 1.0, v67
v_mfma_f32_16x16x32_bf16 v[84:87], v[24:27], v[236:239], v[84:87]
v_rcp_f32 v52, v52
v_mfma_f32_16x16x32_bf16 v[88:91], v[28:31], v[232:235], v[88:91]
ds_read_b64_tr_b16 v[24:25], v7 offset:4096
ds_read_b64_tr_b16 v[26:27], v7 offset:4608
v_mul_f32 v52, v52, v60
v_mfma_f32_16x16x32_bf16 v[92:95], v[28:31], v[236:239], v[92:95]
s_waitcnt lgkmcnt(6)
v_exp_f32 v68, -v68
v_mfma_f32_16x16x32_bf16 v[80:83], v[32:35], v[240:243], v[80:83]
ds_read_b64_tr_b16 v[28:29], v12 offset:4096
ds_read_b64_tr_b16 v[30:31], v12 offset:4608
v_add_f32 v68, 1.0, v68
v_mfma_f32_16x16x32_bf16 v[84:87], v[32:35], v[244:247], v[84:87]
v_rcp_f32 v53, v53
v_mfma_f32_16x16x32_bf16 v[88:91], v[36:39], v[240:243], v[88:91]
ds_read_b64_tr_b16 v[32:33], v7 offset:8192
ds_read_b64_tr_b16 v[34:35], v7 offset:8704
v_mul_f32 v53, v53, v61
v_mfma_f32_16x16x32_bf16 v[92:95], v[36:39], v[244:247], v[92:95]
v_exp_f32 v69, -v69
v_cvt_pk_bf16_f32 v50, v52, v53
v_mfma_f32_16x16x32_bf16 v[80:83], v[40:43], v[248:251], v[80:83]
ds_read_b64_tr_b16 v[36:37], v12 offset:8192
ds_read_b64_tr_b16 v[38:39], v12 offset:8704
v_add_f32 v69, 1.0, v69
v_mfma_f32_16x16x32_bf16 v[84:87], v[40:43], v[252:255], v[84:87]
v_rcp_f32 v54, v54
v_permlane16_swap_b32 v48, v50
v_mfma_f32_16x16x32_bf16 v[88:91], v[44:47], v[248:251], v[88:91]
ds_read_b64_tr_b16 v[40:41], v7 offset:12288
ds_read_b64_tr_b16 v[42:43], v7 offset:12800
v_mul_f32 v54, v54, v62
v_mfma_f32_16x16x32_bf16 v[92:95], v[44:47], v[252:255], v[92:95]
s_waitcnt lgkmcnt(6)
v_exp_f32 v70, -v70
v_mfma_f32_16x16x32_bf16 v[96:99], v[16:19], v[128:131], 0
ds_read_b64_tr_b16 v[44:45], v12 offset:12288
ds_read_b64_tr_b16 v[46:47], v12 offset:12800
v_add_f32 v70, 1.0, v70
v_mfma_f32_16x16x32_bf16 v[100:103], v[16:19], v[132:135], 0
v_rcp_f32 v55, v55
v_mfma_f32_16x16x32_bf16 v[104:107], v[20:23], v[128:131], 0
ds_read_b64_tr_b16 v[16:17], v7 offset:16384
ds_read_b64_tr_b16 v[18:19], v7 offset:16896
v_mul_f32 v55, v55, v63
v_mfma_f32_16x16x32_bf16 v[108:111], v[20:23], v[132:135], 0
v_exp_f32 v71, -v71
v_cvt_pk_bf16_f32 v51, v54, v55
v_mfma_f32_16x16x32_bf16 v[96:99], v[24:27], v[136:139], v[96:99]
ds_read_b64_tr_b16 v[20:21], v12 offset:16384
ds_read_b64_tr_b16 v[22:23], v12 offset:16896
v_add_f32 v71, 1.0, v71
v_mfma_f32_16x16x32_bf16 v[100:103], v[24:27], v[140:143], v[100:103]
s_mov_b32 s55, s81
buffer_load_dwordx4 v[128:131], v13, s[32:35], s55 offen offset:0 sc1
v_permlane16_swap_b32 v49, v51
v_mfma_f32_16x16x32_bf16 v[104:107], v[28:31], v[136:139], v[104:107]
ds_read_b64_tr_b16 v[24:25], v7 offset:20480
ds_read_b64_tr_b16 v[26:27], v7 offset:20992
v_mfma_f32_16x16x32_bf16 v[108:111], v[28:31], v[140:143], v[108:111]
buffer_store_dwordx4 v[48:51], v8, s[32:35], s72 offen sc1
s_waitcnt lgkmcnt(6)
v_mfma_f32_16x16x32_bf16 v[96:99], v[32:35], v[144:147], v[96:99]
ds_read_b64_tr_b16 v[28:29], v12 offset:20480
ds_read_b64_tr_b16 v[30:31], v12 offset:20992
v_mfma_f32_16x16x32_bf16 v[100:103], v[32:35], v[148:151], v[100:103]
buffer_load_dwordx4 v[132:135], v13, s[32:35], s55 offen offset:256 sc1
v_rcp_f32 v64, v64
v_mfma_f32_16x16x32_bf16 v[104:107], v[36:39], v[144:147], v[104:107]
ds_read_b64_tr_b16 v[32:33], v7 offset:24576
ds_read_b64_tr_b16 v[34:35], v7 offset:25088
v_mul_f32 v64, v64, v72
v_mfma_f32_16x16x32_bf16 v[108:111], v[36:39], v[148:151], v[108:111]
v_exp_f32 v80, -v80
v_mfma_f32_16x16x32_bf16 v[96:99], v[40:43], v[152:155], v[96:99]
ds_read_b64_tr_b16 v[36:37], v12 offset:24576
ds_read_b64_tr_b16 v[38:39], v12 offset:25088
v_add_f32 v80, 1.0, v80
v_mfma_f32_16x16x32_bf16 v[100:103], v[40:43], v[156:159], v[100:103]
buffer_load_dwordx4 v[136:139], v13, s[32:35], s55 offen offset:2048 sc1
v_rcp_f32 v65, v65
v_mfma_f32_16x16x32_bf16 v[104:107], v[44:47], v[152:155], v[104:107]
ds_read_b64_tr_b16 v[40:41], v7 offset:28672
ds_read_b64_tr_b16 v[42:43], v7 offset:29184
v_mul_f32 v65, v65, v73
v_mfma_f32_16x16x32_bf16 v[108:111], v[44:47], v[156:159], v[108:111]
s_waitcnt lgkmcnt(6)
v_exp_f32 v81, -v81
v_mfma_f32_16x16x32_bf16 v[96:99], v[16:19], v[160:163], v[96:99]
ds_read_b64_tr_b16 v[44:45], v12 offset:28672
ds_read_b64_tr_b16 v[46:47], v12 offset:29184
v_add_f32 v81, 1.0, v81
v_mfma_f32_16x16x32_bf16 v[100:103], v[16:19], v[164:167], v[100:103]
buffer_load_dwordx4 v[140:143], v13, s[32:35], s55 offen offset:2304 sc1
v_rcp_f32 v66, v66
v_mfma_f32_16x16x32_bf16 v[104:107], v[20:23], v[160:163], v[104:107]
ds_read_b64_tr_b16 v[16:17], v7 offset:32768
ds_read_b64_tr_b16 v[18:19], v7 offset:33280
v_mul_f32 v66, v66, v74
v_mfma_f32_16x16x32_bf16 v[108:111], v[20:23], v[164:167], v[108:111]
v_exp_f32 v82, -v82
v_cvt_pk_bf16_f32 v64, v64, v65
v_mfma_f32_16x16x32_bf16 v[96:99], v[24:27], v[168:171], v[96:99]
ds_read_b64_tr_b16 v[20:21], v12 offset:32768
ds_read_b64_tr_b16 v[22:23], v12 offset:33280
v_add_f32 v82, 1.0, v82
v_mfma_f32_16x16x32_bf16 v[100:103], v[24:27], v[172:175], v[100:103]
s_add_u32 s55, s55, 4096
buffer_load_dwordx4 v[144:147], v13, s[32:35], s55 offen offset:0 sc1
v_mfma_f32_16x16x32_bf16 v[104:107], v[28:31], v[168:171], v[104:107]
ds_read_b64_tr_b16 v[24:25], v7 offset:36864
ds_read_b64_tr_b16 v[26:27], v7 offset:37376
v_mfma_f32_16x16x32_bf16 v[108:111], v[28:31], v[172:175], v[108:111]
s_waitcnt lgkmcnt(6)
v_rcp_f32 v67, v67
v_mfma_f32_16x16x32_bf16 v[96:99], v[32:35], v[176:179], v[96:99]
ds_read_b64_tr_b16 v[28:29], v12 offset:36864
ds_read_b64_tr_b16 v[30:31], v12 offset:37376
v_mul_f32 v67, v67, v75
v_mfma_f32_16x16x32_bf16 v[100:103], v[32:35], v[180:183], v[100:103]
buffer_load_dwordx4 v[148:151], v13, s[32:35], s55 offen offset:256 sc1
v_exp_f32 v83, -v83
v_mfma_f32_16x16x32_bf16 v[104:107], v[36:39], v[176:179], v[104:107]
ds_read_b64_tr_b16 v[32:33], v7 offset:40960
ds_read_b64_tr_b16 v[34:35], v7 offset:41472
v_add_f32 v83, 1.0, v83
v_mfma_f32_16x16x32_bf16 v[108:111], v[36:39], v[180:183], v[108:111]
v_rcp_f32 v68, v68
v_cvt_pk_bf16_f32 v65, v66, v67
v_mfma_f32_16x16x32_bf16 v[96:99], v[40:43], v[184:187], v[96:99]
ds_read_b64_tr_b16 v[36:37], v12 offset:40960
ds_read_b64_tr_b16 v[38:39], v12 offset:41472
v_mul_f32 v68, v68, v76
v_mfma_f32_16x16x32_bf16 v[100:103], v[40:43], v[188:191], v[100:103]
buffer_load_dwordx4 v[152:155], v13, s[32:35], s55 offen offset:2048 sc1
v_exp_f32 v84, -v84
v_mfma_f32_16x16x32_bf16 v[104:107], v[44:47], v[184:187], v[104:107]
ds_read_b64_tr_b16 v[40:41], v7 offset:45056
ds_read_b64_tr_b16 v[42:43], v7 offset:45568
v_add_f32 v84, 1.0, v84
v_mfma_f32_16x16x32_bf16 v[108:111], v[44:47], v[188:191], v[108:111]
s_waitcnt lgkmcnt(6)
v_rcp_f32 v69, v69
v_mfma_f32_16x16x32_bf16 v[96:99], v[16:19], v[192:195], v[96:99]
ds_read_b64_tr_b16 v[44:45], v12 offset:45056
ds_read_b64_tr_b16 v[46:47], v12 offset:45568
v_mul_f32 v69, v69, v77
v_mfma_f32_16x16x32_bf16 v[100:103], v[16:19], v[196:199], v[100:103]
buffer_load_dwordx4 v[156:159], v13, s[32:35], s55 offen offset:2304 sc1
v_exp_f32 v85, -v85
v_mfma_f32_16x16x32_bf16 v[104:107], v[20:23], v[192:195], v[104:107]
ds_read_b64_tr_b16 v[16:17], v7 offset:49152
ds_read_b64_tr_b16 v[18:19], v7 offset:49664
v_add_f32 v85, 1.0, v85
v_mfma_f32_16x16x32_bf16 v[108:111], v[20:23], v[196:199], v[108:111]
v_rcp_f32 v70, v70
v_cvt_pk_bf16_f32 v66, v68, v69
v_mfma_f32_16x16x32_bf16 v[96:99], v[24:27], v[200:203], v[96:99]
ds_read_b64_tr_b16 v[20:21], v12 offset:49152
ds_read_b64_tr_b16 v[22:23], v12 offset:49664
v_mul_f32 v70, v70, v78
v_mfma_f32_16x16x32_bf16 v[100:103], v[24:27], v[204:207], v[100:103]
s_add_u32 s55, s55, 4096
buffer_load_dwordx4 v[160:163], v13, s[32:35], s55 offen offset:0 sc1
v_permlane16_swap_b32 v64, v66
v_mfma_f32_16x16x32_bf16 v[104:107], v[28:31], v[200:203], v[104:107]
ds_read_b64_tr_b16 v[24:25], v7 offset:53248
ds_read_b64_tr_b16 v[26:27], v7 offset:53760
v_mfma_f32_16x16x32_bf16 v[108:111], v[28:31], v[204:207], v[108:111]
s_waitcnt lgkmcnt(6)
v_exp_f32 v86, -v86
v_mfma_f32_16x16x32_bf16 v[96:99], v[32:35], v[208:211], v[96:99]
ds_read_b64_tr_b16 v[28:29], v12 offset:53248
ds_read_b64_tr_b16 v[30:31], v12 offset:53760
v_add_f32 v86, 1.0, v86
v_mfma_f32_16x16x32_bf16 v[100:103], v[32:35], v[212:215], v[100:103]
buffer_load_dwordx4 v[164:167], v13, s[32:35], s55 offen offset:256 sc1
v_rcp_f32 v71, v71
v_mfma_f32_16x16x32_bf16 v[104:107], v[36:39], v[208:211], v[104:107]
ds_read_b64_tr_b16 v[32:33], v7 offset:57344
ds_read_b64_tr_b16 v[34:35], v7 offset:57856
v_mul_f32 v71, v71, v79
v_mfma_f32_16x16x32_bf16 v[108:111], v[36:39], v[212:215], v[108:111]
v_exp_f32 v87, -v87
v_cvt_pk_bf16_f32 v67, v70, v71
v_mfma_f32_16x16x32_bf16 v[96:99], v[40:43], v[216:219], v[96:99]
ds_read_b64_tr_b16 v[36:37], v12 offset:57344
ds_read_b64_tr_b16 v[38:39], v12 offset:57856
v_add_f32 v87, 1.0, v87
v_mfma_f32_16x16x32_bf16 v[100:103], v[40:43], v[220:223], v[100:103]
buffer_load_dwordx4 v[168:171], v13, s[32:35], s55 offen offset:2048 sc1
v_rcp_f32 v80, v80
v_mfma_f32_16x16x32_bf16 v[104:107], v[44:47], v[216:219], v[104:107]
ds_read_b64_tr_b16 v[40:41], v7 offset:61440
ds_read_b64_tr_b16 v[42:43], v7 offset:61952
v_mul_f32 v80, v80, v88
v_mfma_f32_16x16x32_bf16 v[108:111], v[44:47], v[220:223], v[108:111]
s_waitcnt lgkmcnt(6)
v_rcp_f32 v81, v81
v_mfma_f32_16x16x32_bf16 v[96:99], v[16:19], v[224:227], v[96:99]
ds_read_b64_tr_b16 v[44:45], v12 offset:61440
ds_read_b64_tr_b16 v[46:47], v12 offset:61952
v_mul_f32 v81, v81, v89
v_mfma_f32_16x16x32_bf16 v[100:103], v[16:19], v[228:231], v[100:103]
buffer_load_dwordx4 v[172:175], v13, s[32:35], s55 offen offset:2304 sc1
v_rcp_f32 v82, v82
v_mfma_f32_16x16x32_bf16 v[104:107], v[20:23], v[224:227], v[104:107]
ds_read_b64_tr_b16 v[16:17], v4 offset:0
ds_read_b64_tr_b16 v[18:19], v4 offset:512
v_mul_f32 v82, v82, v90
v_mfma_f32_16x16x32_bf16 v[108:111], v[20:23], v[228:231], v[108:111]
v_rcp_f32 v83, v83
v_permlane16_swap_b32 v65, v67
v_mfma_f32_16x16x32_bf16 v[96:99], v[24:27], v[232:235], v[96:99]
ds_read_b64_tr_b16 v[20:21], v9 offset:0
ds_read_b64_tr_b16 v[22:23], v9 offset:512
v_mul_f32 v83, v83, v91
v_mfma_f32_16x16x32_bf16 v[100:103], v[24:27], v[236:239], v[100:103]
s_add_u32 s55, s55, 4096
buffer_load_dwordx4 v[176:179], v13, s[32:35], s55 offen offset:0 sc1
v_cvt_pk_bf16_f32 v80, v80, v81
v_mfma_f32_16x16x32_bf16 v[104:107], v[28:31], v[232:235], v[104:107]
ds_read_b64_tr_b16 v[24:25], v5 offset:0
ds_read_b64_tr_b16 v[26:27], v5 offset:512
v_cvt_pk_bf16_f32 v81, v82, v83
v_mfma_f32_16x16x32_bf16 v[108:111], v[28:31], v[236:239], v[108:111]
buffer_store_dwordx4 v[64:67], v8, s[32:35], s73 offen sc1
s_waitcnt lgkmcnt(6)
v_mfma_f32_16x16x32_bf16 v[96:99], v[32:35], v[240:243], v[96:99]
ds_read_b64_tr_b16 v[28:29], v10 offset:0
ds_read_b64_tr_b16 v[30:31], v10 offset:512
v_mfma_f32_16x16x32_bf16 v[100:103], v[32:35], v[244:247], v[100:103]
buffer_load_dwordx4 v[180:183], v13, s[32:35], s55 offen offset:256 sc1
v_rcp_f32 v84, v84
v_mfma_f32_16x16x32_bf16 v[104:107], v[36:39], v[240:243], v[104:107]
ds_read_b64_tr_b16 v[32:33], v4 offset:4096
ds_read_b64_tr_b16 v[34:35], v4 offset:4608
v_mul_f32 v84, v84, v92
v_mfma_f32_16x16x32_bf16 v[108:111], v[36:39], v[244:247], v[108:111]
v_rcp_f32 v85, v85
v_mfma_f32_16x16x32_bf16 v[96:99], v[40:43], v[248:251], v[96:99]
ds_read_b64_tr_b16 v[36:37], v9 offset:4096
ds_read_b64_tr_b16 v[38:39], v9 offset:4608
v_mul_f32 v85, v85, v93
v_mfma_f32_16x16x32_bf16 v[100:103], v[40:43], v[252:255], v[100:103]
buffer_load_dwordx4 v[184:187], v13, s[32:35], s55 offen offset:2048 sc1
v_rcp_f32 v86, v86
v_mfma_f32_16x16x32_bf16 v[104:107], v[44:47], v[248:251], v[104:107]
ds_read_b64_tr_b16 v[40:41], v5 offset:4096
ds_read_b64_tr_b16 v[42:43], v5 offset:4608
v_mul_f32 v86, v86, v94
v_mfma_f32_16x16x32_bf16 v[108:111], v[44:47], v[252:255], v[108:111]
s_waitcnt vmcnt(14) lgkmcnt(6)
v_rcp_f32 v87, v87
v_mfma_f32_16x16x32_bf16 v[112:115], v[16:19], v[128:131], 0
ds_read_b64_tr_b16 v[44:45], v10 offset:4096
ds_read_b64_tr_b16 v[46:47], v10 offset:4608
v_mul_f32 v87, v87, v95
v_mfma_f32_16x16x32_bf16 v[116:119], v[16:19], v[132:135], 0
buffer_load_dwordx4 v[188:191], v13, s[32:35], s55 offen offset:2304 sc1
v_cvt_pk_bf16_f32 v82, v84, v85
v_cvt_pk_bf16_f32 v83, v86, v87
v_mfma_f32_16x16x32_bf16 v[120:123], v[20:23], v[128:131], 0
ds_read_b64_tr_b16 v[16:17], v4 offset:8192
ds_read_b64_tr_b16 v[18:19], v4 offset:8704
v_permlane16_swap_b32 v80, v82
v_mfma_f32_16x16x32_bf16 v[124:127], v[20:23], v[132:135], 0
v_permlane16_swap_b32 v81, v83
v_mfma_f32_16x16x32_bf16 v[48:51], v[24:27], v[128:131], 0
ds_read_b64_tr_b16 v[20:21], v9 offset:8192
ds_read_b64_tr_b16 v[22:23], v9 offset:8704
v_mfma_f32_16x16x32_bf16 v[52:55], v[24:27], v[132:135], 0
s_add_u32 s55, s55, 4096
buffer_load_dwordx4 v[192:195], v13, s[32:35], s55 offen offset:0 sc1
v_mfma_f32_16x16x32_bf16 v[56:59], v[28:31], v[128:131], 0
ds_read_b64_tr_b16 v[24:25], v5 offset:8192
ds_read_b64_tr_b16 v[26:27], v5 offset:8704
v_mfma_f32_16x16x32_bf16 v[60:63], v[28:31], v[132:135], 0
buffer_store_dwordx4 v[80:83], v8, s[32:35], s74 offen sc1
s_waitcnt vmcnt(15) lgkmcnt(6)
v_mfma_f32_16x16x32_bf16 v[112:115], v[32:35], v[136:139], v[112:115]
ds_read_b64_tr_b16 v[28:29], v10 offset:8192
ds_read_b64_tr_b16 v[30:31], v10 offset:8704
v_mfma_f32_16x16x32_bf16 v[116:119], v[32:35], v[140:143], v[116:119]
buffer_load_dwordx4 v[196:199], v13, s[32:35], s55 offen offset:256 sc1
v_exp_f32 v96, -v96
v_mfma_f32_16x16x32_bf16 v[120:123], v[36:39], v[136:139], v[120:123]
ds_read_b64_tr_b16 v[32:33], v4 offset:12288
ds_read_b64_tr_b16 v[34:35], v4 offset:12800
v_add_f32 v96, 1.0, v96
v_mfma_f32_16x16x32_bf16 v[124:127], v[36:39], v[140:143], v[124:127]
v_exp_f32 v97, -v97
v_mfma_f32_16x16x32_bf16 v[48:51], v[40:43], v[136:139], v[48:51]
ds_read_b64_tr_b16 v[36:37], v9 offset:12288
ds_read_b64_tr_b16 v[38:39], v9 offset:12800
v_add_f32 v97, 1.0, v97
v_mfma_f32_16x16x32_bf16 v[52:55], v[40:43], v[140:143], v[52:55]
buffer_load_dwordx4 v[200:203], v13, s[32:35], s55 offen offset:2048 sc1
v_exp_f32 v98, -v98
v_mfma_f32_16x16x32_bf16 v[56:59], v[44:47], v[136:139], v[56:59]
ds_read_b64_tr_b16 v[40:41], v5 offset:12288
ds_read_b64_tr_b16 v[42:43], v5 offset:12800
v_add_f32 v98, 1.0, v98
v_mfma_f32_16x16x32_bf16 v[60:63], v[44:47], v[140:143], v[60:63]
s_waitcnt vmcnt(15) lgkmcnt(6)
v_exp_f32 v99, -v99
v_mfma_f32_16x16x32_bf16 v[112:115], v[16:19], v[144:147], v[112:115]
ds_read_b64_tr_b16 v[44:45], v10 offset:12288
ds_read_b64_tr_b16 v[46:47], v10 offset:12800
v_add_f32 v99, 1.0, v99
v_mfma_f32_16x16x32_bf16 v[116:119], v[16:19], v[148:151], v[116:119]
buffer_load_dwordx4 v[204:207], v13, s[32:35], s55 offen offset:2304 sc1
v_exp_f32 v100, -v100
v_mfma_f32_16x16x32_bf16 v[120:123], v[20:23], v[144:147], v[120:123]
ds_read_b64_tr_b16 v[16:17], v4 offset:16384
ds_read_b64_tr_b16 v[18:19], v4 offset:16896
v_add_f32 v100, 1.0, v100
v_mfma_f32_16x16x32_bf16 v[124:127], v[20:23], v[148:151], v[124:127]
v_exp_f32 v101, -v101
v_mfma_f32_16x16x32_bf16 v[48:51], v[24:27], v[144:147], v[48:51]
ds_read_b64_tr_b16 v[20:21], v9 offset:16384
ds_read_b64_tr_b16 v[22:23], v9 offset:16896
v_add_f32 v101, 1.0, v101
v_mfma_f32_16x16x32_bf16 v[52:55], v[24:27], v[148:151], v[52:55]
s_add_u32 s55, s55, 4096
buffer_load_dwordx4 v[208:211], v13, s[32:35], s55 offen offset:0 sc1
v_mfma_f32_16x16x32_bf16 v[56:59], v[28:31], v[144:147], v[56:59]
ds_read_b64_tr_b16 v[24:25], v5 offset:16384
ds_read_b64_tr_b16 v[26:27], v5 offset:16896
v_mfma_f32_16x16x32_bf16 v[60:63], v[28:31], v[148:151], v[60:63]
s_waitcnt vmcnt(15) lgkmcnt(6)
v_exp_f32 v102, -v102
v_mfma_f32_16x16x32_bf16 v[112:115], v[32:35], v[152:155], v[112:115]
ds_read_b64_tr_b16 v[28:29], v10 offset:16384
ds_read_b64_tr_b16 v[30:31], v10 offset:16896
v_add_f32 v102, 1.0, v102
v_mfma_f32_16x16x32_bf16 v[116:119], v[32:35], v[156:159], v[116:119]
buffer_load_dwordx4 v[212:215], v13, s[32:35], s55 offen offset:256 sc1
v_exp_f32 v103, -v103
v_mfma_f32_16x16x32_bf16 v[120:123], v[36:39], v[152:155], v[120:123]
ds_read_b64_tr_b16 v[32:33], v4 offset:20480
ds_read_b64_tr_b16 v[34:35], v4 offset:20992
v_add_f32 v103, 1.0, v103
v_mfma_f32_16x16x32_bf16 v[124:127], v[36:39], v[156:159], v[124:127]
v_rcp_f32 v96, v96
v_mfma_f32_16x16x32_bf16 v[48:51], v[40:43], v[152:155], v[48:51]
ds_read_b64_tr_b16 v[36:37], v9 offset:20480
ds_read_b64_tr_b16 v[38:39], v9 offset:20992
v_mul_f32 v96, v96, v104
v_mfma_f32_16x16x32_bf16 v[52:55], v[40:43], v[156:159], v[52:55]
buffer_load_dwordx4 v[216:219], v13, s[32:35], s55 offen offset:2048 sc1
v_rcp_f32 v97, v97
v_mfma_f32_16x16x32_bf16 v[56:59], v[44:47], v[152:155], v[56:59]
ds_read_b64_tr_b16 v[40:41], v5 offset:20480
ds_read_b64_tr_b16 v[42:43], v5 offset:20992
v_mul_f32 v97, v97, v105
v_mfma_f32_16x16x32_bf16 v[60:63], v[44:47], v[156:159], v[60:63]
s_waitcnt vmcnt(15) lgkmcnt(6)
v_rcp_f32 v98, v98
v_mfma_f32_16x16x32_bf16 v[112:115], v[16:19], v[160:163], v[112:115]
ds_read_b64_tr_b16 v[44:45], v10 offset:20480
ds_read_b64_tr_b16 v[46:47], v10 offset:20992
v_mul_f32 v98, v98, v106
v_mfma_f32_16x16x32_bf16 v[116:119], v[16:19], v[164:167], v[116:119]
buffer_load_dwordx4 v[220:223], v13, s[32:35], s55 offen offset:2304 sc1
v_rcp_f32 v99, v99
v_mfma_f32_16x16x32_bf16 v[120:123], v[20:23], v[160:163], v[120:123]
ds_read_b64_tr_b16 v[16:17], v4 offset:24576
ds_read_b64_tr_b16 v[18:19], v4 offset:25088
v_mul_f32 v99, v99, v107
v_mfma_f32_16x16x32_bf16 v[124:127], v[20:23], v[164:167], v[124:127]
v_rcp_f32 v100, v100
v_cvt_pk_bf16_f32 v96, v96, v97
v_mfma_f32_16x16x32_bf16 v[48:51], v[24:27], v[160:163], v[48:51]
ds_read_b64_tr_b16 v[20:21], v9 offset:24576
ds_read_b64_tr_b16 v[22:23], v9 offset:25088
v_mul_f32 v100, v100, v108
v_mfma_f32_16x16x32_bf16 v[52:55], v[24:27], v[164:167], v[52:55]
s_add_u32 s55, s55, 4096
buffer_load_dwordx4 v[224:227], v13, s[32:35], s55 offen offset:0 sc1
v_cvt_pk_bf16_f32 v97, v98, v99
v_mfma_f32_16x16x32_bf16 v[56:59], v[28:31], v[160:163], v[56:59]
ds_read_b64_tr_b16 v[24:25], v5 offset:24576
ds_read_b64_tr_b16 v[26:27], v5 offset:25088
v_mfma_f32_16x16x32_bf16 v[60:63], v[28:31], v[164:167], v[60:63]
s_waitcnt vmcnt(15) lgkmcnt(6)
v_rcp_f32 v101, v101
v_mfma_f32_16x16x32_bf16 v[112:115], v[32:35], v[168:171], v[112:115]
ds_read_b64_tr_b16 v[28:29], v10 offset:24576
ds_read_b64_tr_b16 v[30:31], v10 offset:25088
v_mul_f32 v101, v101, v109
v_mfma_f32_16x16x32_bf16 v[116:119], v[32:35], v[172:175], v[116:119]
buffer_load_dwordx4 v[228:231], v13, s[32:35], s55 offen offset:256 sc1
v_rcp_f32 v102, v102
v_mfma_f32_16x16x32_bf16 v[120:123], v[36:39], v[168:171], v[120:123]
ds_read_b64_tr_b16 v[32:33], v4 offset:28672
ds_read_b64_tr_b16 v[34:35], v4 offset:29184
v_mul_f32 v102, v102, v110
v_mfma_f32_16x16x32_bf16 v[124:127], v[36:39], v[172:175], v[124:127]
v_rcp_f32 v103, v103
v_cvt_pk_bf16_f32 v98, v100, v101
v_mfma_f32_16x16x32_bf16 v[48:51], v[40:43], v[168:171], v[48:51]
ds_read_b64_tr_b16 v[36:37], v9 offset:28672
ds_read_b64_tr_b16 v[38:39], v9 offset:29184
v_mul_f32 v103, v103, v111
v_mfma_f32_16x16x32_bf16 v[52:55], v[40:43], v[172:175], v[52:55]
buffer_load_dwordx4 v[232:235], v13, s[32:35], s55 offen offset:2048 sc1
v_cvt_pk_bf16_f32 v99, v102, v103
v_permlane16_swap_b32 v96, v98
v_mfma_f32_16x16x32_bf16 v[56:59], v[44:47], v[168:171], v[56:59]
ds_read_b64_tr_b16 v[40:41], v5 offset:28672
ds_read_b64_tr_b16 v[42:43], v5 offset:29184
v_permlane16_swap_b32 v97, v99
v_mfma_f32_16x16x32_bf16 v[60:63], v[44:47], v[172:175], v[60:63]
buffer_store_dwordx4 v[96:99], v8, s[32:35], s75 offen sc1
s_waitcnt vmcnt(15) lgkmcnt(6)
v_mfma_f32_16x16x32_bf16 v[112:115], v[16:19], v[176:179], v[112:115]
ds_read_b64_tr_b16 v[44:45], v10 offset:28672
ds_read_b64_tr_b16 v[46:47], v10 offset:29184
v_mfma_f32_16x16x32_bf16 v[116:119], v[16:19], v[180:183], v[116:119]
buffer_load_dwordx4 v[236:239], v13, s[32:35], s55 offen offset:2304 sc1
v_mfma_f32_16x16x32_bf16 v[120:123], v[20:23], v[176:179], v[120:123]
ds_read_b64_tr_b16 v[16:17], v4 offset:32768
ds_read_b64_tr_b16 v[18:19], v4 offset:33280
v_mfma_f32_16x16x32_bf16 v[124:127], v[20:23], v[180:183], v[124:127]
v_mfma_f32_16x16x32_bf16 v[48:51], v[24:27], v[176:179], v[48:51]
ds_read_b64_tr_b16 v[20:21], v9 offset:32768
ds_read_b64_tr_b16 v[22:23], v9 offset:33280
v_mfma_f32_16x16x32_bf16 v[52:55], v[24:27], v[180:183], v[52:55]
s_add_u32 s55, s55, 4096
buffer_load_dwordx4 v[240:243], v13, s[32:35], s55 offen offset:0 sc1
v_mfma_f32_16x16x32_bf16 v[56:59], v[28:31], v[176:179], v[56:59]
ds_read_b64_tr_b16 v[24:25], v4 offset:36864
ds_read_b64_tr_b16 v[26:27], v4 offset:37376
v_mfma_f32_16x16x32_bf16 v[60:63], v[28:31], v[180:183], v[60:63]
s_waitcnt vmcnt(15) lgkmcnt(6)
v_mfma_f32_16x16x32_bf16 v[112:115], v[32:35], v[184:187], v[112:115]
ds_read_b64_tr_b16 v[28:29], v9 offset:36864
ds_read_b64_tr_b16 v[30:31], v9 offset:37376
v_mfma_f32_16x16x32_bf16 v[116:119], v[32:35], v[188:191], v[116:119]
buffer_load_dwordx4 v[244:247], v13, s[32:35], s55 offen offset:256 sc1
v_mfma_f32_16x16x32_bf16 v[120:123], v[36:39], v[184:187], v[120:123]
ds_read_b64_tr_b16 v[32:33], v4 offset:40960
ds_read_b64_tr_b16 v[34:35], v4 offset:41472
v_mfma_f32_16x16x32_bf16 v[124:127], v[36:39], v[188:191], v[124:127]
v_mfma_f32_16x16x32_bf16 v[48:51], v[40:43], v[184:187], v[48:51]
ds_read_b64_tr_b16 v[36:37], v9 offset:40960
ds_read_b64_tr_b16 v[38:39], v9 offset:41472
v_mfma_f32_16x16x32_bf16 v[52:55], v[40:43], v[188:191], v[52:55]
buffer_load_dwordx4 v[248:251], v13, s[32:35], s55 offen offset:2048 sc1
v_mfma_f32_16x16x32_bf16 v[56:59], v[44:47], v[184:187], v[56:59]
ds_read_b64_tr_b16 v[40:41], v4 offset:45056
ds_read_b64_tr_b16 v[42:43], v4 offset:45568
v_mfma_f32_16x16x32_bf16 v[60:63], v[44:47], v[188:191], v[60:63]
s_waitcnt vmcnt(14) lgkmcnt(6)
v_mfma_f32_16x16x32_bf16 v[112:115], v[16:19], v[192:195], v[112:115]
ds_read_b64_tr_b16 v[44:45], v9 offset:45056
ds_read_b64_tr_b16 v[46:47], v9 offset:45568
v_mfma_f32_16x16x32_bf16 v[116:119], v[16:19], v[196:199], v[116:119]
buffer_load_dwordx4 v[252:255], v13, s[32:35], s55 offen offset:2304 sc1
v_mfma_f32_16x16x32_bf16 v[120:123], v[20:23], v[192:195], v[120:123]
ds_read_b64_tr_b16 v[16:17], v4 offset:49152
ds_read_b64_tr_b16 v[18:19], v4 offset:49664
v_mfma_f32_16x16x32_bf16 v[124:127], v[20:23], v[196:199], v[124:127]
s_waitcnt vmcnt(13)
v_mfma_f32_16x16x32_bf16 v[112:115], v[24:27], v[200:203], v[112:115]
ds_read_b64_tr_b16 v[20:21], v9 offset:49152
ds_read_b64_tr_b16 v[22:23], v9 offset:49664
v_mfma_f32_16x16x32_bf16 v[116:119], v[24:27], v[204:207], v[116:119]
v_mfma_f32_16x16x32_bf16 v[120:123], v[28:31], v[200:203], v[120:123]
ds_read_b64_tr_b16 v[24:25], v4 offset:53248
ds_read_b64_tr_b16 v[26:27], v4 offset:53760
v_mfma_f32_16x16x32_bf16 v[124:127], v[28:31], v[204:207], v[124:127]
s_waitcnt vmcnt(11) lgkmcnt(6)
v_mfma_f32_16x16x32_bf16 v[112:115], v[32:35], v[208:211], v[112:115]
ds_read_b64_tr_b16 v[28:29], v9 offset:53248
ds_read_b64_tr_b16 v[30:31], v9 offset:53760
v_mfma_f32_16x16x32_bf16 v[116:119], v[32:35], v[212:215], v[116:119]
s_cmp_eq_u32 s31, 31
s_cbranch_scc1 WBo_75
WB_73:
buffer_load_dword v3, off, s[32:35], 0
WBj_74:
v_mfma_f32_16x16x32_bf16 v[120:123], v[36:39], v[208:211], v[120:123]
ds_read_b64_tr_b16 v[32:33], v4 offset:57344
ds_read_b64_tr_b16 v[34:35], v4 offset:57856
v_mfma_f32_16x16x32_bf16 v[124:127], v[36:39], v[212:215], v[124:127]
s_waitcnt vmcnt(6)
v_add_u32_e64 v2, s53, 7
s_cmp_eq_u32 s71, 1
s_cbranch_scc0 OS_76
buffer_store_dword v2, off, s[32:35], s99 offset:0
OSb_77:
v_mfma_f32_16x16x32_bf16 v[112:115], v[40:43], v[216:219], v[112:115]
ds_read_b64_tr_b16 v[36:37], v9 offset:57344
ds_read_b64_tr_b16 v[38:39], v9 offset:57856
v_mfma_f32_16x16x32_bf16 v[116:119], v[40:43], v[220:223], v[116:119]
v_mfma_f32_16x16x32_bf16 v[120:123], v[44:47], v[216:219], v[120:123]
ds_read_b64_tr_b16 v[40:41], v4 offset:61440
ds_read_b64_tr_b16 v[42:43], v4 offset:61952
v_mfma_f32_16x16x32_bf16 v[124:127], v[44:47], v[220:223], v[124:127]
s_waitcnt lgkmcnt(6)
v_mfma_f32_16x16x32_bf16 v[112:115], v[16:19], v[224:227], v[112:115]
ds_read_b64_tr_b16 v[44:45], v9 offset:61440
ds_read_b64_tr_b16 v[46:47], v9 offset:61952
v_mfma_f32_16x16x32_bf16 v[116:119], v[16:19], v[228:231], v[116:119]
v_mfma_f32_16x16x32_bf16 v[120:123], v[20:23], v[224:227], v[120:123]
ds_read_b64_tr_b16 v[16:17], v5 offset:32768
ds_read_b64_tr_b16 v[18:19], v5 offset:33280
v_mfma_f32_16x16x32_bf16 v[124:127], v[20:23], v[228:231], v[124:127]
s_waitcnt vmcnt(6)
v_mfma_f32_16x16x32_bf16 v[112:115], v[24:27], v[232:235], v[112:115]
ds_read_b64_tr_b16 v[20:21], v10 offset:32768
ds_read_b64_tr_b16 v[22:23], v10 offset:33280
v_mfma_f32_16x16x32_bf16 v[116:119], v[24:27], v[236:239], v[116:119]
v_mfma_f32_16x16x32_bf16 v[120:123], v[28:31], v[232:235], v[120:123]
ds_read_b64_tr_b16 v[24:25], v5 offset:36864
ds_read_b64_tr_b16 v[26:27], v5 offset:37376
v_mfma_f32_16x16x32_bf16 v[124:127], v[28:31], v[236:239], v[124:127]
s_waitcnt vmcnt(4) lgkmcnt(6)
v_mfma_f32_16x16x32_bf16 v[112:115], v[32:35], v[240:243], v[112:115]
ds_read_b64_tr_b16 v[28:29], v10 offset:36864
ds_read_b64_tr_b16 v[30:31], v10 offset:37376
v_mfma_f32_16x16x32_bf16 v[116:119], v[32:35], v[244:247], v[116:119]
v_mfma_f32_16x16x32_bf16 v[120:123], v[36:39], v[240:243], v[120:123]
ds_read_b64_tr_b16 v[32:33], v5 offset:40960
ds_read_b64_tr_b16 v[34:35], v5 offset:41472
v_mfma_f32_16x16x32_bf16 v[124:127], v[36:39], v[244:247], v[124:127]
s_waitcnt vmcnt(2)
v_mfma_f32_16x16x32_bf16 v[112:115], v[40:43], v[248:251], v[112:115]
ds_read_b64_tr_b16 v[36:37], v10 offset:40960
ds_read_b64_tr_b16 v[38:39], v10 offset:41472
v_mfma_f32_16x16x32_bf16 v[116:119], v[40:43], v[252:255], v[116:119]
v_mfma_f32_16x16x32_bf16 v[120:123], v[44:47], v[248:251], v[120:123]
ds_read_b64_tr_b16 v[40:41], v5 offset:45056
ds_read_b64_tr_b16 v[42:43], v5 offset:45568
v_mfma_f32_16x16x32_bf16 v[124:127], v[44:47], v[252:255], v[124:127]
s_waitcnt lgkmcnt(6)
v_mfma_f32_16x16x32_bf16 v[48:51], v[16:19], v[192:195], v[48:51]
ds_read_b64_tr_b16 v[44:45], v10 offset:45056
ds_read_b64_tr_b16 v[46:47], v10 offset:45568
v_mfma_f32_16x16x32_bf16 v[52:55], v[16:19], v[196:199], v[52:55]
v_mfma_f32_16x16x32_bf16 v[56:59], v[20:23], v[192:195], v[56:59]
ds_read_b64_tr_b16 v[16:17], v5 offset:49152
ds_read_b64_tr_b16 v[18:19], v5 offset:49664
v_mfma_f32_16x16x32_bf16 v[60:63], v[20:23], v[196:199], v[60:63]
v_mfma_f32_16x16x32_bf16 v[48:51], v[24:27], v[200:203], v[48:51]
ds_read_b64_tr_b16 v[20:21], v10 offset:49152
ds_read_b64_tr_b16 v[22:23], v10 offset:49664
v_mfma_f32_16x16x32_bf16 v[52:55], v[24:27], v[204:207], v[52:55]
v_exp_f32 v112, -v112
v_mfma_f32_16x16x32_bf16 v[56:59], v[28:31], v[200:203], v[56:59]
ds_read_b64_tr_b16 v[24:25], v5 offset:53248
ds_read_b64_tr_b16 v[26:27], v5 offset:53760
v_add_f32 v112, 1.0, v112
v_mfma_f32_16x16x32_bf16 v[60:63], v[28:31], v[204:207], v[60:63]
s_waitcnt lgkmcnt(6)
v_exp_f32 v113, -v113
v_mfma_f32_16x16x32_bf16 v[48:51], v[32:35], v[208:211], v[48:51]
ds_read_b64_tr_b16 v[28:29], v10 offset:53248
ds_read_b64_tr_b16 v[30:31], v10 offset:53760
v_add_f32 v113, 1.0, v113
v_mfma_f32_16x16x32_bf16 v[52:55], v[32:35], v[212:215], v[52:55]
v_exp_f32 v114, -v114
v_mfma_f32_16x16x32_bf16 v[56:59], v[36:39], v[208:211], v[56:59]
ds_read_b64_tr_b16 v[32:33], v5 offset:57344
ds_read_b64_tr_b16 v[34:35], v5 offset:57856
v_add_f32 v114, 1.0, v114
v_mfma_f32_16x16x32_bf16 v[60:63], v[36:39], v[212:215], v[60:63]
v_exp_f32 v115, -v115
v_mfma_f32_16x16x32_bf16 v[48:51], v[40:43], v[216:219], v[48:51]
ds_read_b64_tr_b16 v[36:37], v10 offset:57344
ds_read_b64_tr_b16 v[38:39], v10 offset:57856
v_add_f32 v115, 1.0, v115
v_mfma_f32_16x16x32_bf16 v[52:55], v[40:43], v[220:223], v[52:55]
v_exp_f32 v116, -v116
v_mfma_f32_16x16x32_bf16 v[56:59], v[44:47], v[216:219], v[56:59]
ds_read_b64_tr_b16 v[40:41], v5 offset:61440
ds_read_b64_tr_b16 v[42:43], v5 offset:61952
v_add_f32 v116, 1.0, v116
v_mfma_f32_16x16x32_bf16 v[60:63], v[44:47], v[220:223], v[60:63]
s_waitcnt lgkmcnt(6)
v_exp_f32 v117, -v117
v_mfma_f32_16x16x32_bf16 v[48:51], v[16:19], v[224:227], v[48:51]
ds_read_b64_tr_b16 v[44:45], v10 offset:61440
ds_read_b64_tr_b16 v[46:47], v10 offset:61952
v_add_f32 v117, 1.0, v117
v_mfma_f32_16x16x32_bf16 v[52:55], v[16:19], v[228:231], v[52:55]
v_exp_f32 v118, -v118
v_mfma_f32_16x16x32_bf16 v[56:59], v[20:23], v[224:227], v[56:59]
ds_read_b64_tr_b16 v[16:17], v6 offset:0
ds_read_b64_tr_b16 v[18:19], v6 offset:512
v_add_f32 v118, 1.0, v118
v_mfma_f32_16x16x32_bf16 v[60:63], v[20:23], v[228:231], v[60:63]
v_exp_f32 v119, -v119
v_mfma_f32_16x16x32_bf16 v[48:51], v[24:27], v[232:235], v[48:51]
ds_read_b64_tr_b16 v[20:21], v11 offset:0
ds_read_b64_tr_b16 v[22:23], v11 offset:512
v_add_f32 v119, 1.0, v119
v_mfma_f32_16x16x32_bf16 v[52:55], v[24:27], v[236:239], v[52:55]
v_rcp_f32 v112, v112
v_mfma_f32_16x16x32_bf16 v[56:59], v[28:31], v[232:235], v[56:59]
ds_read_b64_tr_b16 v[24:25], v6 offset:4096
ds_read_b64_tr_b16 v[26:27], v6 offset:4608
v_mul_f32 v112, v112, v120
v_mfma_f32_16x16x32_bf16 v[60:63], v[28:31], v[236:239], v[60:63]
s_waitcnt lgkmcnt(6)
v_rcp_f32 v113, v113
v_mfma_f32_16x16x32_bf16 v[48:51], v[32:35], v[240:243], v[48:51]
ds_read_b64_tr_b16 v[28:29], v11 offset:4096
ds_read_b64_tr_b16 v[30:31], v11 offset:4608
v_mul_f32 v113, v113, v121
v_mfma_f32_16x16x32_bf16 v[52:55], v[32:35], v[244:247], v[52:55]
v_rcp_f32 v114, v114
v_cvt_pk_bf16_f32 v112, v112, v113
v_mfma_f32_16x16x32_bf16 v[56:59], v[36:39], v[240:243], v[56:59]
ds_read_b64_tr_b16 v[32:33], v6 offset:8192
ds_read_b64_tr_b16 v[34:35], v6 offset:8704
v_mul_f32 v114, v114, v122
v_mfma_f32_16x16x32_bf16 v[60:63], v[36:39], v[244:247], v[60:63]
v_rcp_f32 v115, v115
v_mfma_f32_16x16x32_bf16 v[48:51], v[40:43], v[248:251], v[48:51]
ds_read_b64_tr_b16 v[36:37], v11 offset:8192
ds_read_b64_tr_b16 v[38:39], v11 offset:8704
v_mul_f32 v115, v115, v123
v_mfma_f32_16x16x32_bf16 v[52:55], v[40:43], v[252:255], v[52:55]
v_accvgpr_read_b32 v14, a244
buffer_load_dword v15, v14, s[32:35], 0 offen sc1
v_cvt_pk_bf16_f32 v113, v114, v115
v_mfma_f32_16x16x32_bf16 v[56:59], v[44:47], v[248:251], v[56:59]
ds_read_b64_tr_b16 v[40:41], v6 offset:12288
ds_read_b64_tr_b16 v[42:43], v6 offset:12800
v_mfma_f32_16x16x32_bf16 v[60:63], v[44:47], v[252:255], v[60:63]
s_waitcnt lgkmcnt(6)
v_rcp_f32 v116, v116
v_mfma_f32_16x16x32_bf16 v[64:67], v[16:19], v[128:131], 0
ds_read_b64_tr_b16 v[44:45], v11 offset:12288
ds_read_b64_tr_b16 v[46:47], v11 offset:12800
v_mul_f32 v116, v116, v124
v_mfma_f32_16x16x32_bf16 v[68:71], v[16:19], v[132:135], 0
v_rcp_f32 v117, v117
v_mfma_f32_16x16x32_bf16 v[72:75], v[20:23], v[128:131], 0
ds_read_b64_tr_b16 v[16:17], v6 offset:16384
ds_read_b64_tr_b16 v[18:19], v6 offset:16896
v_mul_f32 v117, v117, v125
v_mfma_f32_16x16x32_bf16 v[76:79], v[20:23], v[132:135], 0
v_rcp_f32 v118, v118
v_cvt_pk_bf16_f32 v114, v116, v117
v_mfma_f32_16x16x32_bf16 v[64:67], v[24:27], v[136:139], v[64:67]
ds_read_b64_tr_b16 v[20:21], v11 offset:16384
ds_read_b64_tr_b16 v[22:23], v11 offset:16896
v_mul_f32 v118, v118, v126
v_mfma_f32_16x16x32_bf16 v[68:71], v[24:27], v[140:143], v[68:71]
v_exp_f32 v48, -v48
v_permlane16_swap_b32 v112, v114
v_mfma_f32_16x16x32_bf16 v[72:75], v[28:31], v[136:139], v[72:75]
ds_read_b64_tr_b16 v[24:25], v6 offset:20480
ds_read_b64_tr_b16 v[26:27], v6 offset:20992
v_add_f32 v48, 1.0, v48
v_mfma_f32_16x16x32_bf16 v[76:79], v[28:31], v[140:143], v[76:79]
s_waitcnt lgkmcnt(6)
v_exp_f32 v49, -v49
v_mfma_f32_16x16x32_bf16 v[64:67], v[32:35], v[144:147], v[64:67]
ds_read_b64_tr_b16 v[28:29], v11 offset:20480
ds_read_b64_tr_b16 v[30:31], v11 offset:20992
v_add_f32 v49, 1.0, v49
v_mfma_f32_16x16x32_bf16 v[68:71], v[32:35], v[148:151], v[68:71]
v_exp_f32 v50, -v50
v_mfma_f32_16x16x32_bf16 v[72:75], v[36:39], v[144:147], v[72:75]
ds_read_b64_tr_b16 v[32:33], v6 offset:24576
ds_read_b64_tr_b16 v[34:35], v6 offset:25088
v_add_f32 v50, 1.0, v50
v_mfma_f32_16x16x32_bf16 v[76:79], v[36:39], v[148:151], v[76:79]
v_exp_f32 v51, -v51
v_mfma_f32_16x16x32_bf16 v[64:67], v[40:43], v[152:155], v[64:67]
ds_read_b64_tr_b16 v[36:37], v11 offset:24576
ds_read_b64_tr_b16 v[38:39], v11 offset:25088
v_add_f32 v51, 1.0, v51
v_mfma_f32_16x16x32_bf16 v[68:71], v[40:43], v[156:159], v[68:71]
v_exp_f32 v52, -v52
v_mfma_f32_16x16x32_bf16 v[72:75], v[44:47], v[152:155], v[72:75]
ds_read_b64_tr_b16 v[40:41], v6 offset:28672
ds_read_b64_tr_b16 v[42:43], v6 offset:29184
v_add_f32 v52, 1.0, v52
v_mfma_f32_16x16x32_bf16 v[76:79], v[44:47], v[156:159], v[76:79]
s_waitcnt lgkmcnt(6)
v_exp_f32 v53, -v53
v_mfma_f32_16x16x32_bf16 v[64:67], v[16:19], v[160:163], v[64:67]
ds_read_b64_tr_b16 v[44:45], v11 offset:28672
ds_read_b64_tr_b16 v[46:47], v11 offset:29184
v_add_f32 v53, 1.0, v53
v_mfma_f32_16x16x32_bf16 v[68:71], v[16:19], v[164:167], v[68:71]
v_exp_f32 v54, -v54
v_mfma_f32_16x16x32_bf16 v[72:75], v[20:23], v[160:163], v[72:75]
ds_read_b64_tr_b16 v[16:17], v6 offset:32768
ds_read_b64_tr_b16 v[18:19], v6 offset:33280
v_add_f32 v54, 1.0, v54
v_mfma_f32_16x16x32_bf16 v[76:79], v[20:23], v[164:167], v[76:79]
v_rcp_f32 v119, v119
v_mfma_f32_16x16x32_bf16 v[64:67], v[24:27], v[168:171], v[64:67]
ds_read_b64_tr_b16 v[20:21], v11 offset:32768
ds_read_b64_tr_b16 v[22:23], v11 offset:33280
v_mul_f32 v119, v119, v127
v_mfma_f32_16x16x32_bf16 v[68:71], v[24:27], v[172:175], v[68:71]
s_add_u32 s96, s53, 7
s_waitcnt vmcnt(0)
v_cmp_ne_u32 vcc, s96, v15
v_mfma_f32_16x16x32_bf16 v[72:75], v[28:31], v[168:171], v[72:75]
ds_read_b64_tr_b16 v[24:25], v6 offset:36864
ds_read_b64_tr_b16 v[26:27], v6 offset:37376
v_cvt_pk_bf16_f32 v115, v118, v119
v_mfma_f32_16x16x32_bf16 v[76:79], v[28:31], v[172:175], v[76:79]
s_cbranch_vccnz HZ_78
HZb_79:
s_waitcnt lgkmcnt(6)
v_mfma_f32_16x16x32_bf16 v[64:67], v[32:35], v[176:179], v[64:67]
ds_read_b64_tr_b16 v[28:29], v11 offset:36864
ds_read_b64_tr_b16 v[30:31], v11 offset:37376
v_permlane16_swap_b32 v113, v115
v_mfma_f32_16x16x32_bf16 v[68:71], v[32:35], v[180:183], v[68:71]
s_mov_b32 s54, s82
buffer_load_dwordx4 v[128:131], v13, s[32:35], s54 offen offset:0 sc1
v_mfma_f32_16x16x32_bf16 v[72:75], v[36:39], v[176:179], v[72:75]
ds_read_b64_tr_b16 v[32:33], v6 offset:40960
ds_read_b64_tr_b16 v[34:35], v6 offset:41472
v_mfma_f32_16x16x32_bf16 v[76:79], v[36:39], v[180:183], v[76:79]
buffer_store_dwordx4 v[112:115], v8, s[32:35], s76 offen sc1
v_mfma_f32_16x16x32_bf16 v[64:67], v[40:43], v[184:187], v[64:67]
ds_read_b64_tr_b16 v[36:37], v11 offset:40960
ds_read_b64_tr_b16 v[38:39], v11 offset:41472
v_mfma_f32_16x16x32_bf16 v[68:71], v[40:43], v[188:191], v[68:71]
buffer_load_dwordx4 v[132:135], v13, s[32:35], s54 offen offset:256 sc1
v_mfma_f32_16x16x32_bf16 v[72:75], v[44:47], v[184:187], v[72:75]
ds_read_b64_tr_b16 v[40:41], v6 offset:45056
ds_read_b64_tr_b16 v[42:43], v6 offset:45568
v_mfma_f32_16x16x32_bf16 v[76:79], v[44:47], v[188:191], v[76:79]
s_waitcnt lgkmcnt(6)
v_exp_f32 v55, -v55
v_mfma_f32_16x16x32_bf16 v[64:67], v[16:19], v[192:195], v[64:67]
ds_read_b64_tr_b16 v[44:45], v11 offset:45056
ds_read_b64_tr_b16 v[46:47], v11 offset:45568
v_add_f32 v55, 1.0, v55
v_mfma_f32_16x16x32_bf16 v[68:71], v[16:19], v[196:199], v[68:71]
buffer_load_dwordx4 v[136:139], v13, s[32:35], s54 offen offset:2048 sc1
v_mfma_f32_16x16x32_bf16 v[72:75], v[20:23], v[192:195], v[72:75]
ds_read_b64_tr_b16 v[16:17], v6 offset:49152
ds_read_b64_tr_b16 v[18:19], v6 offset:49664
v_mfma_f32_16x16x32_bf16 v[76:79], v[20:23], v[196:199], v[76:79]
v_rcp_f32 v48, v48
v_mfma_f32_16x16x32_bf16 v[64:67], v[24:27], v[200:203], v[64:67]
ds_read_b64_tr_b16 v[20:21], v11 offset:49152
ds_read_b64_tr_b16 v[22:23], v11 offset:49664
v_mul_f32 v48, v48, v56
v_mfma_f32_16x16x32_bf16 v[68:71], v[24:27], v[204:207], v[68:71]
buffer_load_dwordx4 v[140:143], v13, s[32:35], s54 offen offset:2304 sc1
v_mfma_f32_16x16x32_bf16 v[72:75], v[28:31], v[200:203], v[72:75]
ds_read_b64_tr_b16 v[24:25], v6 offset:53248
ds_read_b64_tr_b16 v[26:27], v6 offset:53760
v_mfma_f32_16x16x32_bf16 v[76:79], v[28:31], v[204:207], v[76:79]
s_waitcnt lgkmcnt(6)
v_rcp_f32 v49, v49
v_mfma_f32_16x16x32_bf16 v[64:67], v[32:35], v[208:211], v[64:67]
ds_read_b64_tr_b16 v[28:29], v11 offset:53248
ds_read_b64_tr_b16 v[30:31], v11 offset:53760
v_mul_f32 v49, v49, v57
v_mfma_f32_16x16x32_bf16 v[68:71], v[32:35], v[212:215], v[68:71]
s_add_u32 s54, s54, 4096
buffer_load_dwordx4 v[144:147], v13, s[32:35], s54 offen offset:0 sc1
v_cvt_pk_bf16_f32 v48, v48, v49
v_mfma_f32_16x16x32_bf16 v[72:75], v[36:39], v[208:211], v[72:75]
ds_read_b64_tr_b16 v[32:33], v6 offset:57344
ds_read_b64_tr_b16 v[34:35], v6 offset:57856
v_mfma_f32_16x16x32_bf16 v[76:79], v[36:39], v[212:215], v[76:79]
v_rcp_f32 v50, v50
v_mfma_f32_16x16x32_bf16 v[64:67], v[40:43], v[216:219], v[64:67]
ds_read_b64_tr_b16 v[36:37], v11 offset:57344
ds_read_b64_tr_b16 v[38:39], v11 offset:57856
v_mul_f32 v50, v50, v58
v_mfma_f32_16x16x32_bf16 v[68:71], v[40:43], v[220:223], v[68:71]
buffer_load_dwordx4 v[148:151], v13, s[32:35], s54 offen offset:256 sc1
v_mfma_f32_16x16x32_bf16 v[72:75], v[44:47], v[216:219], v[72:75]
ds_read_b64_tr_b16 v[40:41], v6 offset:61440
ds_read_b64_tr_b16 v[42:43], v6 offset:61952
v_mfma_f32_16x16x32_bf16 v[76:79], v[44:47], v[220:223], v[76:79]
s_waitcnt lgkmcnt(6)
v_rcp_f32 v51, v51
v_mfma_f32_16x16x32_bf16 v[64:67], v[16:19], v[224:227], v[64:67]
ds_read_b64_tr_b16 v[44:45], v11 offset:61440
ds_read_b64_tr_b16 v[46:47], v11 offset:61952
v_mul_f32 v51, v51, v59
v_mfma_f32_16x16x32_bf16 v[68:71], v[16:19], v[228:231], v[68:71]
buffer_load_dwordx4 v[152:155], v13, s[32:35], s54 offen offset:2048 sc1
v_cvt_pk_bf16_f32 v49, v50, v51
v_mfma_f32_16x16x32_bf16 v[72:75], v[20:23], v[224:227], v[72:75]
v_rcp_f32 v52, v52
v_mfma_f32_16x16x32_bf16 v[76:79], v[20:23], v[228:231], v[76:79]
v_rcp_f32 v53, v53
v_mul_f32 v52, v52, v60
v_mfma_f32_16x16x32_bf16 v[64:67], v[24:27], v[232:235], v[64:67]
v_rcp_f32 v54, v54
v_mul_f32 v53, v53, v61
v_mfma_f32_16x16x32_bf16 v[68:71], v[24:27], v[236:239], v[68:71]
buffer_load_dwordx4 v[156:159], v13, s[32:35], s54 offen offset:2304 sc1
v_mul_f32 v54, v54, v62
v_mfma_f32_16x16x32_bf16 v[72:75], v[28:31], v[232:235], v[72:75]
v_rcp_f32 v55, v55
v_cvt_pk_bf16_f32 v50, v52, v53
v_mfma_f32_16x16x32_bf16 v[76:79], v[28:31], v[236:239], v[76:79]
s_waitcnt lgkmcnt(0)
v_mul_f32 v55, v55, v63
v_permlane16_swap_b32 v48, v50
v_mfma_f32_16x16x32_bf16 v[64:67], v[32:35], v[240:243], v[64:67]
v_cvt_pk_bf16_f32 v51, v54, v55
v_mfma_f32_16x16x32_bf16 v[68:71], v[32:35], v[244:247], v[68:71]
s_add_u32 s54, s54, 4096
buffer_load_dwordx4 v[160:163], v13, s[32:35], s54 offen offset:0 sc1
v_permlane16_swap_b32 v49, v51
v_mfma_f32_16x16x32_bf16 v[72:75], v[36:39], v[240:243], v[72:75]
buffer_store_dwordx4 v[48:51], v8, s[32:35], s77 offen sc1
v_mfma_f32_16x16x32_bf16 v[76:79], v[36:39], v[244:247], v[76:79]
v_mfma_f32_16x16x32_bf16 v[64:67], v[40:43], v[248:251], v[64:67]
v_mfma_f32_16x16x32_bf16 v[68:71], v[40:43], v[252:255], v[68:71]
buffer_load_dwordx4 v[164:167], v13, s[32:35], s54 offen offset:256 sc1
v_mfma_f32_16x16x32_bf16 v[72:75], v[44:47], v[248:251], v[72:75]
v_mfma_f32_16x16x32_bf16 v[76:79], v[44:47], v[252:255], v[76:79]
buffer_load_dwordx4 v[168:171], v13, s[32:35], s54 offen offset:2048 sc1
buffer_load_dwordx4 v[172:175], v13, s[32:35], s54 offen offset:2304 sc1
s_branch G1j_67
G1o_66:
ds_read_b64_tr_b16 v[16:17], v4 offset:0
ds_read_b64_tr_b16 v[18:19], v4 offset:512
ds_read_b64_tr_b16 v[20:21], v9 offset:0
ds_read_b64_tr_b16 v[22:23], v9 offset:512
ds_read_b64_tr_b16 v[24:25], v5 offset:0
ds_read_b64_tr_b16 v[26:27], v5 offset:512
ds_read_b64_tr_b16 v[28:29], v10 offset:0
ds_read_b64_tr_b16 v[30:31], v10 offset:512
ds_read_b64_tr_b16 v[32:33], v6 offset:0
ds_read_b64_tr_b16 v[34:35], v6 offset:512
ds_read_b64_tr_b16 v[36:37], v11 offset:0
ds_read_b64_tr_b16 v[38:39], v11 offset:512
ds_read_b64_tr_b16 v[40:41], v4 offset:4096
ds_read_b64_tr_b16 v[42:43], v4 offset:4608
s_waitcnt vmcnt(6) lgkmcnt(6)
v_mfma_f32_16x16x32_bf16 v[48:51], v[16:19], v[128:131], 0
ds_read_b64_tr_b16 v[44:45], v9 offset:4096
ds_read_b64_tr_b16 v[46:47], v9 offset:4608
v_mfma_f32_16x16x32_bf16 v[52:55], v[16:19], v[132:135], 0
s_add_u32 s54, s54, 4096
buffer_load_dwordx4 v[160:163], v13, s[32:35], s54 offen offset:0 sc1
v_mfma_f32_16x16x32_bf16 v[56:59], v[20:23], v[128:131], 0
ds_read_b64_tr_b16 v[16:17], v5 offset:4096
ds_read_b64_tr_b16 v[18:19], v5 offset:4608
v_mfma_f32_16x16x32_bf16 v[60:63], v[20:23], v[132:135], 0
v_mfma_f32_16x16x32_bf16 v[64:67], v[24:27], v[128:131], 0
ds_read_b64_tr_b16 v[20:21], v10 offset:4096
ds_read_b64_tr_b16 v[22:23], v10 offset:4608
v_mfma_f32_16x16x32_bf16 v[68:71], v[24:27], v[132:135], 0
buffer_load_dwordx4 v[164:167], v13, s[32:35], s54 offen offset:256 sc1
v_mfma_f32_16x16x32_bf16 v[72:75], v[28:31], v[128:131], 0
ds_read_b64_tr_b16 v[24:25], v6 offset:4096
ds_read_b64_tr_b16 v[26:27], v6 offset:4608
v_mfma_f32_16x16x32_bf16 v[76:79], v[28:31], v[132:135], 0
s_waitcnt lgkmcnt(6)
v_mfma_f32_16x16x32_bf16 v[80:83], v[32:35], v[128:131], 0
ds_read_b64_tr_b16 v[28:29], v11 offset:4096
ds_read_b64_tr_b16 v[30:31], v11 offset:4608
v_mfma_f32_16x16x32_bf16 v[84:87], v[32:35], v[132:135], 0
buffer_load_dwordx4 v[168:171], v13, s[32:35], s54 offen offset:2048 sc1
v_mfma_f32_16x16x32_bf16 v[88:91], v[36:39], v[128:131], 0
ds_read_b64_tr_b16 v[32:33], v4 offset:8192
ds_read_b64_tr_b16 v[34:35], v4 offset:8704
v_mfma_f32_16x16x32_bf16 v[92:95], v[36:39], v[132:135], 0
s_waitcnt vmcnt(7)
v_mfma_f32_16x16x32_bf16 v[48:51], v[40:43], v[136:139], v[48:51]
ds_read_b64_tr_b16 v[36:37], v9 offset:8192
ds_read_b64_tr_b16 v[38:39], v9 offset:8704
v_mfma_f32_16x16x32_bf16 v[52:55], v[40:43], v[140:143], v[52:55]
buffer_load_dwordx4 v[172:175], v13, s[32:35], s54 offen offset:2304 sc1
v_mfma_f32_16x16x32_bf16 v[56:59], v[44:47], v[136:139], v[56:59]
ds_read_b64_tr_b16 v[40:41], v5 offset:8192
ds_read_b64_tr_b16 v[42:43], v5 offset:8704
v_mfma_f32_16x16x32_bf16 v[60:63], v[44:47], v[140:143], v[60:63]
s_waitcnt lgkmcnt(6)
v_mfma_f32_16x16x32_bf16 v[64:67], v[16:19], v[136:139], v[64:67]
ds_read_b64_tr_b16 v[44:45], v10 offset:8192
ds_read_b64_tr_b16 v[46:47], v10 offset:8704
v_mfma_f32_16x16x32_bf16 v[68:71], v[16:19], v[140:143], v[68:71]
s_add_u32 s54, s54, 4096
buffer_load_dwordx4 v[176:179], v13, s[32:35], s54 offen offset:0 sc1
v_mfma_f32_16x16x32_bf16 v[72:75], v[20:23], v[136:139], v[72:75]
ds_read_b64_tr_b16 v[16:17], v6 offset:8192
ds_read_b64_tr_b16 v[18:19], v6 offset:8704
v_mfma_f32_16x16x32_bf16 v[76:79], v[20:23], v[140:143], v[76:79]
v_mfma_f32_16x16x32_bf16 v[80:83], v[24:27], v[136:139], v[80:83]
ds_read_b64_tr_b16 v[20:21], v11 offset:8192
ds_read_b64_tr_b16 v[22:23], v11 offset:8704
v_mfma_f32_16x16x32_bf16 v[84:87], v[24:27], v[140:143], v[84:87]
buffer_load_dwordx4 v[180:183], v13, s[32:35], s54 offen offset:256 sc1
v_mfma_f32_16x16x32_bf16 v[88:91], v[28:31], v[136:139], v[88:91]
ds_read_b64_tr_b16 v[24:25], v4 offset:12288
ds_read_b64_tr_b16 v[26:27], v4 offset:12800
v_mfma_f32_16x16x32_bf16 v[92:95], v[28:31], v[140:143], v[92:95]
s_waitcnt vmcnt(8) lgkmcnt(6)
v_mfma_f32_16x16x32_bf16 v[48:51], v[32:35], v[144:147], v[48:51]
ds_read_b64_tr_b16 v[28:29], v9 offset:12288
ds_read_b64_tr_b16 v[30:31], v9 offset:12800
v_mfma_f32_16x16x32_bf16 v[52:55], v[32:35], v[148:151], v[52:55]
s_add_u32 s96, s99, 8192
v_add_u32_e64 v2, s53, 6
s_cmp_eq_u32 s71, 1
s_cbranch_scc0 OS_81
buffer_store_dword v2, off, s[32:35], s96 offset:512
OSb_82:
v_mfma_f32_16x16x32_bf16 v[56:59], v[36:39], v[144:147], v[56:59]
ds_read_b64_tr_b16 v[32:33], v5 offset:12288
ds_read_b64_tr_b16 v[34:35], v5 offset:12800
v_mfma_f32_16x16x32_bf16 v[60:63], v[36:39], v[148:151], v[60:63]
buffer_load_dwordx4 v[184:187], v13, s[32:35], s54 offen offset:2048 sc1
v_mfma_f32_16x16x32_bf16 v[64:67], v[40:43], v[144:147], v[64:67]
ds_read_b64_tr_b16 v[36:37], v10 offset:12288
ds_read_b64_tr_b16 v[38:39], v10 offset:12800
v_mfma_f32_16x16x32_bf16 v[68:71], v[40:43], v[148:151], v[68:71]
v_mfma_f32_16x16x32_bf16 v[72:75], v[44:47], v[144:147], v[72:75]
ds_read_b64_tr_b16 v[40:41], v6 offset:12288
ds_read_b64_tr_b16 v[42:43], v6 offset:12800
v_mfma_f32_16x16x32_bf16 v[76:79], v[44:47], v[148:151], v[76:79]
buffer_load_dwordx4 v[188:191], v13, s[32:35], s54 offen offset:2304 sc1
s_waitcnt lgkmcnt(6)
v_mfma_f32_16x16x32_bf16 v[80:83], v[16:19], v[144:147], v[80:83]
ds_read_b64_tr_b16 v[44:45], v11 offset:12288
ds_read_b64_tr_b16 v[46:47], v11 offset:12800
v_mfma_f32_16x16x32_bf16 v[84:87], v[16:19], v[148:151], v[84:87]
v_mfma_f32_16x16x32_bf16 v[88:91], v[20:23], v[144:147], v[88:91]
ds_read_b64_tr_b16 v[16:17], v4 offset:16384
ds_read_b64_tr_b16 v[18:19], v4 offset:16896
v_mfma_f32_16x16x32_bf16 v[92:95], v[20:23], v[148:151], v[92:95]
s_add_u32 s54, s54, 4096
buffer_load_dwordx4 v[192:195], v13, s[32:35], s54 offen offset:0 sc1
s_waitcnt vmcnt(10)
v_mfma_f32_16x16x32_bf16 v[48:51], v[24:27], v[152:155], v[48:51]
ds_read_b64_tr_b16 v[20:21], v9 offset:16384
ds_read_b64_tr_b16 v[22:23], v9 offset:16896
v_mfma_f32_16x16x32_bf16 v[52:55], v[24:27], v[156:159], v[52:55]
v_mfma_f32_16x16x32_bf16 v[56:59], v[28:31], v[152:155], v[56:59]
ds_read_b64_tr_b16 v[24:25], v5 offset:16384
ds_read_b64_tr_b16 v[26:27], v5 offset:16896
v_mfma_f32_16x16x32_bf16 v[60:63], v[28:31], v[156:159], v[60:63]
buffer_load_dwordx4 v[196:199], v13, s[32:35], s54 offen offset:256 sc1
s_waitcnt lgkmcnt(6)
v_mfma_f32_16x16x32_bf16 v[64:67], v[32:35], v[152:155], v[64:67]
ds_read_b64_tr_b16 v[28:29], v10 offset:16384
ds_read_b64_tr_b16 v[30:31], v10 offset:16896
v_mfma_f32_16x16x32_bf16 v[68:71], v[32:35], v[156:159], v[68:71]
v_mfma_f32_16x16x32_bf16 v[72:75], v[36:39], v[152:155], v[72:75]
ds_read_b64_tr_b16 v[32:33], v6 offset:16384
ds_read_b64_tr_b16 v[34:35], v6 offset:16896
v_mfma_f32_16x16x32_bf16 v[76:79], v[36:39], v[156:159], v[76:79]
buffer_load_dwordx4 v[200:203], v13, s[32:35], s54 offen offset:2048 sc1
v_mfma_f32_16x16x32_bf16 v[80:83], v[40:43], v[152:155], v[80:83]
ds_read_b64_tr_b16 v[36:37], v11 offset:16384
ds_read_b64_tr_b16 v[38:39], v11 offset:16896
v_mfma_f32_16x16x32_bf16 v[84:87], v[40:43], v[156:159], v[84:87]
v_mfma_f32_16x16x32_bf16 v[88:91], v[44:47], v[152:155], v[88:91]
ds_read_b64_tr_b16 v[40:41], v4 offset:20480
ds_read_b64_tr_b16 v[42:43], v4 offset:20992
v_mfma_f32_16x16x32_bf16 v[92:95], v[44:47], v[156:159], v[92:95]
buffer_load_dwordx4 v[204:207], v13, s[32:35], s54 offen offset:2304 sc1
s_waitcnt vmcnt(11) lgkmcnt(6)
v_mfma_f32_16x16x32_bf16 v[48:51], v[16:19], v[160:163], v[48:51]
ds_read_b64_tr_b16 v[44:45], v9 offset:20480
ds_read_b64_tr_b16 v[46:47], v9 offset:20992
v_mfma_f32_16x16x32_bf16 v[52:55], v[16:19], v[164:167], v[52:55]
v_mfma_f32_16x16x32_bf16 v[56:59], v[20:23], v[160:163], v[56:59]
ds_read_b64_tr_b16 v[16:17], v5 offset:20480
ds_read_b64_tr_b16 v[18:19], v5 offset:20992
v_mfma_f32_16x16x32_bf16 v[60:63], v[20:23], v[164:167], v[60:63]
s_add_u32 s54, s54, 4096
buffer_load_dwordx4 v[208:211], v13, s[32:35], s54 offen offset:0 sc1
v_mfma_f32_16x16x32_bf16 v[64:67], v[24:27], v[160:163], v[64:67]
ds_read_b64_tr_b16 v[20:21], v10 offset:20480
ds_read_b64_tr_b16 v[22:23], v10 offset:20992
v_mfma_f32_16x16x32_bf16 v[68:71], v[24:27], v[164:167], v[68:71]
v_accvgpr_read_b32 v14, a247
buffer_load_dword v15, v14, s[32:35], 0 offen sc1
v_mfma_f32_16x16x32_bf16 v[72:75], v[28:31], v[160:163], v[72:75]
ds_read_b64_tr_b16 v[24:25], v6 offset:20480
ds_read_b64_tr_b16 v[26:27], v6 offset:20992
v_mfma_f32_16x16x32_bf16 v[76:79], v[28:31], v[164:167], v[76:79]
buffer_load_dwordx4 v[212:215], v13, s[32:35], s54 offen offset:256 sc1
s_waitcnt lgkmcnt(6)
v_mfma_f32_16x16x32_bf16 v[80:83], v[32:35], v[160:163], v[80:83]
ds_read_b64_tr_b16 v[28:29], v11 offset:20480
ds_read_b64_tr_b16 v[30:31], v11 offset:20992
v_mfma_f32_16x16x32_bf16 v[84:87], v[32:35], v[164:167], v[84:87]
v_mfma_f32_16x16x32_bf16 v[88:91], v[36:39], v[160:163], v[88:91]
ds_read_b64_tr_b16 v[32:33], v4 offset:24576
ds_read_b64_tr_b16 v[34:35], v4 offset:25088
v_mfma_f32_16x16x32_bf16 v[92:95], v[36:39], v[164:167], v[92:95]
buffer_load_dwordx4 v[216:219], v13, s[32:35], s54 offen offset:2048 sc1
s_waitcnt vmcnt(13)
v_mfma_f32_16x16x32_bf16 v[48:51], v[40:43], v[168:171], v[48:51]
ds_read_b64_tr_b16 v[36:37], v9 offset:24576
ds_read_b64_tr_b16 v[38:39], v9 offset:25088
v_mfma_f32_16x16x32_bf16 v[52:55], v[40:43], v[172:175], v[52:55]
v_mfma_f32_16x16x32_bf16 v[56:59], v[44:47], v[168:171], v[56:59]
ds_read_b64_tr_b16 v[40:41], v5 offset:24576
ds_read_b64_tr_b16 v[42:43], v5 offset:25088
v_mfma_f32_16x16x32_bf16 v[60:63], v[44:47], v[172:175], v[60:63]
buffer_load_dwordx4 v[220:223], v13, s[32:35], s54 offen offset:2304 sc1
s_waitcnt lgkmcnt(6)
v_mfma_f32_16x16x32_bf16 v[64:67], v[16:19], v[168:171], v[64:67]
ds_read_b64_tr_b16 v[44:45], v10 offset:24576
ds_read_b64_tr_b16 v[46:47], v10 offset:25088
v_mfma_f32_16x16x32_bf16 v[68:71], v[16:19], v[172:175], v[68:71]
v_mfma_f32_16x16x32_bf16 v[72:75], v[20:23], v[168:171], v[72:75]
ds_read_b64_tr_b16 v[16:17], v6 offset:24576
ds_read_b64_tr_b16 v[18:19], v6 offset:25088
v_mfma_f32_16x16x32_bf16 v[76:79], v[20:23], v[172:175], v[76:79]
s_add_u32 s54, s54, 4096
buffer_load_dwordx4 v[224:227], v13, s[32:35], s54 offen offset:0 sc1
v_mfma_f32_16x16x32_bf16 v[80:83], v[24:27], v[168:171], v[80:83]
ds_read_b64_tr_b16 v[20:21], v11 offset:24576
ds_read_b64_tr_b16 v[22:23], v11 offset:25088
v_mfma_f32_16x16x32_bf16 v[84:87], v[24:27], v[172:175], v[84:87]
v_mfma_f32_16x16x32_bf16 v[88:91], v[28:31], v[168:171], v[88:91]
ds_read_b64_tr_b16 v[24:25], v4 offset:28672
ds_read_b64_tr_b16 v[26:27], v4 offset:29184
v_mfma_f32_16x16x32_bf16 v[92:95], v[28:31], v[172:175], v[92:95]
buffer_load_dwordx4 v[228:231], v13, s[32:35], s54 offen offset:256 sc1
s_waitcnt vmcnt(14) lgkmcnt(6)
v_mfma_f32_16x16x32_bf16 v[48:51], v[32:35], v[176:179], v[48:51]
ds_read_b64_tr_b16 v[28:29], v9 offset:28672
ds_read_b64_tr_b16 v[30:31], v9 offset:29184
v_mfma_f32_16x16x32_bf16 v[52:55], v[32:35], v[180:183], v[52:55]
v_mfma_f32_16x16x32_bf16 v[56:59], v[36:39], v[176:179], v[56:59]
ds_read_b64_tr_b16 v[32:33], v5 offset:28672
ds_read_b64_tr_b16 v[34:35], v5 offset:29184
v_mfma_f32_16x16x32_bf16 v[60:63], v[36:39], v[180:183], v[60:63]
buffer_load_dwordx4 v[232:235], v13, s[32:35], s54 offen offset:2048 sc1
v_mfma_f32_16x16x32_bf16 v[64:67], v[40:43], v[176:179], v[64:67]
ds_read_b64_tr_b16 v[36:37], v10 offset:28672
ds_read_b64_tr_b16 v[38:39], v10 offset:29184
v_mfma_f32_16x16x32_bf16 v[68:71], v[40:43], v[180:183], v[68:71]
v_mfma_f32_16x16x32_bf16 v[72:75], v[44:47], v[176:179], v[72:75]
ds_read_b64_tr_b16 v[40:41], v6 offset:28672
ds_read_b64_tr_b16 v[42:43], v6 offset:29184
v_mfma_f32_16x16x32_bf16 v[76:79], v[44:47], v[180:183], v[76:79]
buffer_load_dwordx4 v[236:239], v13, s[32:35], s54 offen offset:2304 sc1
s_waitcnt lgkmcnt(6)
v_mfma_f32_16x16x32_bf16 v[80:83], v[16:19], v[176:179], v[80:83]
ds_read_b64_tr_b16 v[44:45], v11 offset:28672
ds_read_b64_tr_b16 v[46:47], v11 offset:29184
v_mfma_f32_16x16x32_bf16 v[84:87], v[16:19], v[180:183], v[84:87]
s_add_u32 s96, s53, 6
s_waitcnt vmcnt(7)
v_cmp_ne_u32 vcc, s96, v15
v_mfma_f32_16x16x32_bf16 v[88:91], v[20:23], v[176:179], v[88:91]
ds_read_b64_tr_b16 v[16:17], v4 offset:32768
ds_read_b64_tr_b16 v[18:19], v4 offset:33280
v_mfma_f32_16x16x32_bf16 v[92:95], v[20:23], v[180:183], v[92:95]
s_cbranch_vccnz HZ_83
HZb_84:
v_mfma_f32_16x16x32_bf16 v[48:51], v[24:27], v[184:187], v[48:51]
ds_read_b64_tr_b16 v[20:21], v9 offset:32768
ds_read_b64_tr_b16 v[22:23], v9 offset:33280
v_mfma_f32_16x16x32_bf16 v[52:55], v[24:27], v[188:191], v[52:55]
s_add_u32 s54, s54, 4096
buffer_load_dwordx4 v[240:243], v13, s[32:35], s54 offen offset:0 sc1
v_mfma_f32_16x16x32_bf16 v[56:59], v[28:31], v[184:187], v[56:59]
ds_read_b64_tr_b16 v[24:25], v5 offset:32768
ds_read_b64_tr_b16 v[26:27], v5 offset:33280
v_mfma_f32_16x16x32_bf16 v[60:63], v[28:31], v[188:191], v[60:63]
s_waitcnt lgkmcnt(6)
v_mfma_f32_16x16x32_bf16 v[64:67], v[32:35], v[184:187], v[64:67]
ds_read_b64_tr_b16 v[28:29], v10 offset:32768
ds_read_b64_tr_b16 v[30:31], v10 offset:33280
v_mfma_f32_16x16x32_bf16 v[68:71], v[32:35], v[188:191], v[68:71]
buffer_load_dwordx4 v[244:247], v13, s[32:35], s54 offen offset:256 sc1
v_mfma_f32_16x16x32_bf16 v[72:75], v[36:39], v[184:187], v[72:75]
ds_read_b64_tr_b16 v[32:33], v6 offset:32768
ds_read_b64_tr_b16 v[34:35], v6 offset:33280
v_mfma_f32_16x16x32_bf16 v[76:79], v[36:39], v[188:191], v[76:79]
v_mfma_f32_16x16x32_bf16 v[80:83], v[40:43], v[184:187], v[80:83]
ds_read_b64_tr_b16 v[36:37], v11 offset:32768
ds_read_b64_tr_b16 v[38:39], v11 offset:33280
v_mfma_f32_16x16x32_bf16 v[84:87], v[40:43], v[188:191], v[84:87]
buffer_load_dwordx4 v[248:251], v13, s[32:35], s54 offen offset:2048 sc1
v_mfma_f32_16x16x32_bf16 v[88:91], v[44:47], v[184:187], v[88:91]
ds_read_b64_tr_b16 v[40:41], v4 offset:36864
ds_read_b64_tr_b16 v[42:43], v4 offset:37376
v_mfma_f32_16x16x32_bf16 v[92:95], v[44:47], v[188:191], v[92:95]
s_waitcnt lgkmcnt(6)
v_mfma_f32_16x16x32_bf16 v[48:51], v[16:19], v[192:195], v[48:51]
ds_read_b64_tr_b16 v[44:45], v9 offset:36864
ds_read_b64_tr_b16 v[46:47], v9 offset:37376
v_mfma_f32_16x16x32_bf16 v[52:55], v[16:19], v[196:199], v[52:55]
buffer_load_dwordx4 v[252:255], v13, s[32:35], s54 offen offset:2304 sc1
v_mfma_f32_16x16x32_bf16 v[56:59], v[20:23], v[192:195], v[56:59]
ds_read_b64_tr_b16 v[16:17], v5 offset:36864
ds_read_b64_tr_b16 v[18:19], v5 offset:37376
v_mfma_f32_16x16x32_bf16 v[60:63], v[20:23], v[196:199], v[60:63]
v_mfma_f32_16x16x32_bf16 v[64:67], v[24:27], v[192:195], v[64:67]
ds_read_b64_tr_b16 v[20:21], v10 offset:36864
ds_read_b64_tr_b16 v[22:23], v10 offset:37376
v_mfma_f32_16x16x32_bf16 v[68:71], v[24:27], v[196:199], v[68:71]
s_mov_b32 s55, s81
buffer_load_dwordx4 v[128:131], v13, s[32:35], s55 offen offset:0 sc1
v_mfma_f32_16x16x32_bf16 v[72:75], v[28:31], v[192:195], v[72:75]
ds_read_b64_tr_b16 v[24:25], v6 offset:36864
ds_read_b64_tr_b16 v[26:27], v6 offset:37376
v_mfma_f32_16x16x32_bf16 v[76:79], v[28:31], v[196:199], v[76:79]
s_waitcnt lgkmcnt(6)
v_mfma_f32_16x16x32_bf16 v[80:83], v[32:35], v[192:195], v[80:83]
ds_read_b64_tr_b16 v[28:29], v11 offset:36864
ds_read_b64_tr_b16 v[30:31], v11 offset:37376
v_mfma_f32_16x16x32_bf16 v[84:87], v[32:35], v[196:199], v[84:87]
buffer_load_dwordx4 v[132:135], v13, s[32:35], s55 offen offset:256 sc1
v_mfma_f32_16x16x32_bf16 v[88:91], v[36:39], v[192:195], v[88:91]
ds_read_b64_tr_b16 v[32:33], v4 offset:40960
ds_read_b64_tr_b16 v[34:35], v4 offset:41472
v_mfma_f32_16x16x32_bf16 v[92:95], v[36:39], v[196:199], v[92:95]
v_mfma_f32_16x16x32_bf16 v[48:51], v[40:43], v[200:203], v[48:51]
ds_read_b64_tr_b16 v[36:37], v9 offset:40960
ds_read_b64_tr_b16 v[38:39], v9 offset:41472
v_mfma_f32_16x16x32_bf16 v[52:55], v[40:43], v[204:207], v[52:55]
buffer_load_dwordx4 v[136:139], v13, s[32:35], s55 offen offset:2048 sc1
v_mfma_f32_16x16x32_bf16 v[56:59], v[44:47], v[200:203], v[56:59]
ds_read_b64_tr_b16 v[40:41], v4 offset:45056
ds_read_b64_tr_b16 v[42:43], v4 offset:45568
v_mfma_f32_16x16x32_bf16 v[60:63], v[44:47], v[204:207], v[60:63]
s_waitcnt lgkmcnt(6)
v_mfma_f32_16x16x32_bf16 v[64:67], v[16:19], v[200:203], v[64:67]
ds_read_b64_tr_b16 v[44:45], v9 offset:45056
ds_read_b64_tr_b16 v[46:47], v9 offset:45568
v_mfma_f32_16x16x32_bf16 v[68:71], v[16:19], v[204:207], v[68:71]
buffer_load_dwordx4 v[140:143], v13, s[32:35], s55 offen offset:2304 sc1
v_mfma_f32_16x16x32_bf16 v[72:75], v[20:23], v[200:203], v[72:75]
ds_read_b64_tr_b16 v[16:17], v4 offset:49152
ds_read_b64_tr_b16 v[18:19], v4 offset:49664
v_mfma_f32_16x16x32_bf16 v[76:79], v[20:23], v[204:207], v[76:79]
v_mfma_f32_16x16x32_bf16 v[80:83], v[24:27], v[200:203], v[80:83]
ds_read_b64_tr_b16 v[20:21], v9 offset:49152
ds_read_b64_tr_b16 v[22:23], v9 offset:49664
v_mfma_f32_16x16x32_bf16 v[84:87], v[24:27], v[204:207], v[84:87]
s_add_u32 s55, s55, 4096
buffer_load_dwordx4 v[144:147], v13, s[32:35], s55 offen offset:0 sc1
v_mfma_f32_16x16x32_bf16 v[88:91], v[28:31], v[200:203], v[88:91]
ds_read_b64_tr_b16 v[24:25], v4 offset:53248
ds_read_b64_tr_b16 v[26:27], v4 offset:53760
v_mfma_f32_16x16x32_bf16 v[92:95], v[28:31], v[204:207], v[92:95]
s_waitcnt vmcnt(15) lgkmcnt(6)
v_mfma_f32_16x16x32_bf16 v[48:51], v[32:35], v[208:211], v[48:51]
ds_read_b64_tr_b16 v[28:29], v9 offset:53248
ds_read_b64_tr_b16 v[30:31], v9 offset:53760
v_mfma_f32_16x16x32_bf16 v[52:55], v[32:35], v[212:215], v[52:55]
buffer_load_dwordx4 v[148:151], v13, s[32:35], s55 offen offset:256 sc1
v_mfma_f32_16x16x32_bf16 v[56:59], v[36:39], v[208:211], v[56:59]
ds_read_b64_tr_b16 v[32:33], v4 offset:57344
ds_read_b64_tr_b16 v[34:35], v4 offset:57856
v_mfma_f32_16x16x32_bf16 v[60:63], v[36:39], v[212:215], v[60:63]
s_waitcnt vmcnt(14)
v_mfma_f32_16x16x32_bf16 v[48:51], v[40:43], v[216:219], v[48:51]
ds_read_b64_tr_b16 v[36:37], v9 offset:57344
ds_read_b64_tr_b16 v[38:39], v9 offset:57856
v_mfma_f32_16x16x32_bf16 v[52:55], v[40:43], v[220:223], v[52:55]
buffer_load_dwordx4 v[152:155], v13, s[32:35], s55 offen offset:2048 sc1
v_mfma_f32_16x16x32_bf16 v[56:59], v[44:47], v[216:219], v[56:59]
ds_read_b64_tr_b16 v[40:41], v4 offset:61440
ds_read_b64_tr_b16 v[42:43], v4 offset:61952
v_mfma_f32_16x16x32_bf16 v[60:63], v[44:47], v[220:223], v[60:63]
s_waitcnt vmcnt(13) lgkmcnt(6)
v_mfma_f32_16x16x32_bf16 v[48:51], v[16:19], v[224:227], v[48:51]
ds_read_b64_tr_b16 v[44:45], v9 offset:61440
ds_read_b64_tr_b16 v[46:47], v9 offset:61952
v_mfma_f32_16x16x32_bf16 v[52:55], v[16:19], v[228:231], v[52:55]
buffer_load_dwordx4 v[156:159], v13, s[32:35], s55 offen offset:2304 sc1
v_mfma_f32_16x16x32_bf16 v[56:59], v[20:23], v[224:227], v[56:59]
ds_read_b64_tr_b16 v[16:17], v5 offset:40960
ds_read_b64_tr_b16 v[18:19], v5 offset:41472
v_mfma_f32_16x16x32_bf16 v[60:63], v[20:23], v[228:231], v[60:63]
s_waitcnt vmcnt(12)
v_mfma_f32_16x16x32_bf16 v[48:51], v[24:27], v[232:235], v[48:51]
ds_read_b64_tr_b16 v[20:21], v10 offset:40960
ds_read_b64_tr_b16 v[22:23], v10 offset:41472
v_mfma_f32_16x16x32_bf16 v[52:55], v[24:27], v[236:239], v[52:55]
s_add_u32 s55, s55, 4096
buffer_load_dwordx4 v[160:163], v13, s[32:35], s55 offen offset:0 sc1
v_mfma_f32_16x16x32_bf16 v[56:59], v[28:31], v[232:235], v[56:59]
ds_read_b64_tr_b16 v[24:25], v5 offset:45056
ds_read_b64_tr_b16 v[26:27], v5 offset:45568
v_mfma_f32_16x16x32_bf16 v[60:63], v[28:31], v[236:239], v[60:63]
s_waitcnt vmcnt(11) lgkmcnt(6)
v_mfma_f32_16x16x32_bf16 v[48:51], v[32:35], v[240:243], v[48:51]
ds_read_b64_tr_b16 v[28:29], v10 offset:45056
ds_read_b64_tr_b16 v[30:31], v10 offset:45568
v_mfma_f32_16x16x32_bf16 v[52:55], v[32:35], v[244:247], v[52:55]
buffer_load_dwordx4 v[164:167], v13, s[32:35], s55 offen offset:256 sc1
v_mfma_f32_16x16x32_bf16 v[56:59], v[36:39], v[240:243], v[56:59]
ds_read_b64_tr_b16 v[32:33], v5 offset:49152
ds_read_b64_tr_b16 v[34:35], v5 offset:49664
v_mfma_f32_16x16x32_bf16 v[60:63], v[36:39], v[244:247], v[60:63]
s_waitcnt vmcnt(10)
v_mfma_f32_16x16x32_bf16 v[48:51], v[40:43], v[248:251], v[48:51]
ds_read_b64_tr_b16 v[36:37], v10 offset:49152
ds_read_b64_tr_b16 v[38:39], v10 offset:49664
v_mfma_f32_16x16x32_bf16 v[52:55], v[40:43], v[252:255], v[52:55]
buffer_load_dwordx4 v[168:171], v13, s[32:35], s55 offen offset:2048 sc1
v_mfma_f32_16x16x32_bf16 v[56:59], v[44:47], v[248:251], v[56:59]
ds_read_b64_tr_b16 v[40:41], v5 offset:53248
ds_read_b64_tr_b16 v[42:43], v5 offset:53760
v_mfma_f32_16x16x32_bf16 v[60:63], v[44:47], v[252:255], v[60:63]
s_waitcnt lgkmcnt(6)
v_mfma_f32_16x16x32_bf16 v[64:67], v[16:19], v[208:211], v[64:67]
ds_read_b64_tr_b16 v[44:45], v10 offset:53248
ds_read_b64_tr_b16 v[46:47], v10 offset:53760
v_mfma_f32_16x16x32_bf16 v[68:71], v[16:19], v[212:215], v[68:71]
buffer_load_dwordx4 v[172:175], v13, s[32:35], s55 offen offset:2304 sc1
v_mfma_f32_16x16x32_bf16 v[72:75], v[20:23], v[208:211], v[72:75]
ds_read_b64_tr_b16 v[16:17], v5 offset:57344
ds_read_b64_tr_b16 v[18:19], v5 offset:57856
v_mfma_f32_16x16x32_bf16 v[76:79], v[20:23], v[212:215], v[76:79]
v_mfma_f32_16x16x32_bf16 v[64:67], v[24:27], v[216:219], v[64:67]
ds_read_b64_tr_b16 v[20:21], v10 offset:57344
ds_read_b64_tr_b16 v[22:23], v10 offset:57856
v_mfma_f32_16x16x32_bf16 v[68:71], v[24:27], v[220:223], v[68:71]
s_add_u32 s55, s55, 4096
buffer_load_dwordx4 v[176:179], v13, s[32:35], s55 offen offset:0 sc1
v_mfma_f32_16x16x32_bf16 v[72:75], v[28:31], v[216:219], v[72:75]
ds_read_b64_tr_b16 v[24:25], v5 offset:61440
ds_read_b64_tr_b16 v[26:27], v5 offset:61952
v_mfma_f32_16x16x32_bf16 v[76:79], v[28:31], v[220:223], v[76:79]
s_waitcnt lgkmcnt(6)
v_exp_f32 v48, -v48
v_mfma_f32_16x16x32_bf16 v[64:67], v[32:35], v[224:227], v[64:67]
ds_read_b64_tr_b16 v[28:29], v10 offset:61440
ds_read_b64_tr_b16 v[30:31], v10 offset:61952
v_add_f32 v48, 1.0, v48
v_mfma_f32_16x16x32_bf16 v[68:71], v[32:35], v[228:231], v[68:71]
buffer_load_dwordx4 v[180:183], v13, s[32:35], s55 offen offset:256 sc1
v_exp_f32 v49, -v49
v_mfma_f32_16x16x32_bf16 v[72:75], v[36:39], v[224:227], v[72:75]
ds_read_b64_tr_b16 v[32:33], v6 offset:40960
ds_read_b64_tr_b16 v[34:35], v6 offset:41472
v_add_f32 v49, 1.0, v49
v_mfma_f32_16x16x32_bf16 v[76:79], v[36:39], v[228:231], v[76:79]
v_exp_f32 v50, -v50
v_mfma_f32_16x16x32_bf16 v[64:67], v[40:43], v[232:235], v[64:67]
ds_read_b64_tr_b16 v[36:37], v11 offset:40960
ds_read_b64_tr_b16 v[38:39], v11 offset:41472
v_add_f32 v50, 1.0, v50
v_mfma_f32_16x16x32_bf16 v[68:71], v[40:43], v[236:239], v[68:71]
buffer_load_dwordx4 v[184:187], v13, s[32:35], s55 offen offset:2048 sc1
v_exp_f32 v51, -v51
v_mfma_f32_16x16x32_bf16 v[72:75], v[44:47], v[232:235], v[72:75]
ds_read_b64_tr_b16 v[40:41], v6 offset:45056
ds_read_b64_tr_b16 v[42:43], v6 offset:45568
v_add_f32 v51, 1.0, v51
v_mfma_f32_16x16x32_bf16 v[76:79], v[44:47], v[236:239], v[76:79]
s_waitcnt lgkmcnt(6)
v_exp_f32 v52, -v52
v_mfma_f32_16x16x32_bf16 v[64:67], v[16:19], v[240:243], v[64:67]
ds_read_b64_tr_b16 v[44:45], v11 offset:45056
ds_read_b64_tr_b16 v[46:47], v11 offset:45568
v_add_f32 v52, 1.0, v52
v_mfma_f32_16x16x32_bf16 v[68:71], v[16:19], v[244:247], v[68:71]
buffer_load_dwordx4 v[188:191], v13, s[32:35], s55 offen offset:2304 sc1
v_exp_f32 v53, -v53
v_mfma_f32_16x16x32_bf16 v[72:75], v[20:23], v[240:243], v[72:75]
ds_read_b64_tr_b16 v[16:17], v6 offset:49152
ds_read_b64_tr_b16 v[18:19], v6 offset:49664
v_add_f32 v53, 1.0, v53
v_mfma_f32_16x16x32_bf16 v[76:79], v[20:23], v[244:247], v[76:79]
v_exp_f32 v54, -v54
v_mfma_f32_16x16x32_bf16 v[64:67], v[24:27], v[248:251], v[64:67]
ds_read_b64_tr_b16 v[20:21], v11 offset:49152
ds_read_b64_tr_b16 v[22:23], v11 offset:49664
v_add_f32 v54, 1.0, v54
v_mfma_f32_16x16x32_bf16 v[68:71], v[24:27], v[252:255], v[68:71]
s_add_u32 s55, s55, 4096
buffer_load_dwordx4 v[192:195], v13, s[32:35], s55 offen offset:0 sc1
v_mfma_f32_16x16x32_bf16 v[72:75], v[28:31], v[248:251], v[72:75]
ds_read_b64_tr_b16 v[24:25], v6 offset:53248
ds_read_b64_tr_b16 v[26:27], v6 offset:53760
v_mfma_f32_16x16x32_bf16 v[76:79], v[28:31], v[252:255], v[76:79]
s_waitcnt lgkmcnt(6)
v_exp_f32 v55, -v55
v_mfma_f32_16x16x32_bf16 v[80:83], v[32:35], v[208:211], v[80:83]
ds_read_b64_tr_b16 v[28:29], v11 offset:53248
ds_read_b64_tr_b16 v[30:31], v11 offset:53760
v_add_f32 v55, 1.0, v55
v_mfma_f32_16x16x32_bf16 v[84:87], v[32:35], v[212:215], v[84:87]
buffer_load_dwordx4 v[196:199], v13, s[32:35], s55 offen offset:256 sc1
v_rcp_f32 v48, v48
v_mfma_f32_16x16x32_bf16 v[88:91], v[36:39], v[208:211], v[88:91]
ds_read_b64_tr_b16 v[32:33], v6 offset:57344
ds_read_b64_tr_b16 v[34:35], v6 offset:57856
v_mul_f32 v48, v48, v56
v_mfma_f32_16x16x32_bf16 v[92:95], v[36:39], v[212:215], v[92:95]
v_rcp_f32 v49, v49
v_mfma_f32_16x16x32_bf16 v[80:83], v[40:43], v[216:219], v[80:83]
ds_read_b64_tr_b16 v[36:37], v11 offset:57344
ds_read_b64_tr_b16 v[38:39], v11 offset:57856
v_mul_f32 v49, v49, v57
v_mfma_f32_16x16x32_bf16 v[84:87], v[40:43], v[220:223], v[84:87]
buffer_load_dwordx4 v[200:203], v13, s[32:35], s55 offen offset:2048 sc1
v_exp_f32 v64, -v64
v_mfma_f32_16x16x32_bf16 v[88:91], v[44:47], v[216:219], v[88:91]
ds_read_b64_tr_b16 v[40:41], v6 offset:61440
ds_read_b64_tr_b16 v[42:43], v6 offset:61952
v_add_f32 v64, 1.0, v64
v_mfma_f32_16x16x32_bf16 v[92:95], v[44:47], v[220:223], v[92:95]
s_waitcnt lgkmcnt(6)
v_exp_f32 v65, -v65
v_mfma_f32_16x16x32_bf16 v[80:83], v[16:19], v[224:227], v[80:83]
ds_read_b64_tr_b16 v[44:45], v11 offset:61440
ds_read_b64_tr_b16 v[46:47], v11 offset:61952
v_add_f32 v65, 1.0, v65
v_mfma_f32_16x16x32_bf16 v[84:87], v[16:19], v[228:231], v[84:87]
buffer_load_dwordx4 v[204:207], v13, s[32:35], s55 offen offset:2304 sc1
v_rcp_f32 v50, v50
v_mfma_f32_16x16x32_bf16 v[88:91], v[20:23], v[224:227], v[88:91]
ds_read_b64_tr_b16 v[16:17], v4 offset:0
ds_read_b64_tr_b16 v[18:19], v4 offset:512
v_mul_f32 v50, v50, v58
v_mfma_f32_16x16x32_bf16 v[92:95], v[20:23], v[228:231], v[92:95]
v_exp_f32 v66, -v66
v_cvt_pk_bf16_f32 v48, v48, v49
v_mfma_f32_16x16x32_bf16 v[80:83], v[24:27], v[232:235], v[80:83]
ds_read_b64_tr_b16 v[20:21], v9 offset:0
ds_read_b64_tr_b16 v[22:23], v9 offset:512
v_add_f32 v66, 1.0, v66
v_mfma_f32_16x16x32_bf16 v[84:87], v[24:27], v[236:239], v[84:87]
s_add_u32 s55, s55, 4096
buffer_load_dwordx4 v[208:211], v13, s[32:35], s55 offen offset:0 sc1
v_mfma_f32_16x16x32_bf16 v[88:91], v[28:31], v[232:235], v[88:91]
ds_read_b64_tr_b16 v[24:25], v5 offset:0
ds_read_b64_tr_b16 v[26:27], v5 offset:512
v_mfma_f32_16x16x32_bf16 v[92:95], v[28:31], v[236:239], v[92:95]
s_waitcnt lgkmcnt(6)
v_rcp_f32 v51, v51
v_mfma_f32_16x16x32_bf16 v[80:83], v[32:35], v[240:243], v[80:83]
ds_read_b64_tr_b16 v[28:29], v10 offset:0
ds_read_b64_tr_b16 v[30:31], v10 offset:512
v_mul_f32 v51, v51, v59
v_mfma_f32_16x16x32_bf16 v[84:87], v[32:35], v[244:247], v[84:87]
buffer_load_dwordx4 v[212:215], v13, s[32:35], s55 offen offset:256 sc1
v_exp_f32 v67, -v67
v_mfma_f32_16x16x32_bf16 v[88:91], v[36:39], v[240:243], v[88:91]
ds_read_b64_tr_b16 v[32:33], v4 offset:4096
ds_read_b64_tr_b16 v[34:35], v4 offset:4608
v_add_f32 v67, 1.0, v67
v_mfma_f32_16x16x32_bf16 v[92:95], v[36:39], v[244:247], v[92:95]
v_rcp_f32 v52, v52
v_cvt_pk_bf16_f32 v49, v50, v51
v_mfma_f32_16x16x32_bf16 v[80:83], v[40:43], v[248:251], v[80:83]
ds_read_b64_tr_b16 v[36:37], v9 offset:4096
ds_read_b64_tr_b16 v[38:39], v9 offset:4608
v_mul_f32 v52, v52, v60
v_mfma_f32_16x16x32_bf16 v[84:87], v[40:43], v[252:255], v[84:87]
buffer_load_dwordx4 v[216:219], v13, s[32:35], s55 offen offset:2048 sc1
v_exp_f32 v68, -v68
v_mfma_f32_16x16x32_bf16 v[88:91], v[44:47], v[248:251], v[88:91]
ds_read_b64_tr_b16 v[40:41], v5 offset:4096
ds_read_b64_tr_b16 v[42:43], v5 offset:4608
v_add_f32 v68, 1.0, v68
v_mfma_f32_16x16x32_bf16 v[92:95], v[44:47], v[252:255], v[92:95]
s_waitcnt vmcnt(21) lgkmcnt(6)
v_rcp_f32 v53, v53
v_mfma_f32_16x16x32_bf16 v[96:99], v[16:19], v[128:131], 0
ds_read_b64_tr_b16 v[44:45], v10 offset:4096
ds_read_b64_tr_b16 v[46:47], v10 offset:4608
v_mul_f32 v53, v53, v61
v_mfma_f32_16x16x32_bf16 v[100:103], v[16:19], v[132:135], 0
buffer_load_dwordx4 v[220:223], v13, s[32:35], s55 offen offset:2304 sc1
v_exp_f32 v69, -v69
v_mfma_f32_16x16x32_bf16 v[104:107], v[20:23], v[128:131], 0
ds_read_b64_tr_b16 v[16:17], v4 offset:8192
ds_read_b64_tr_b16 v[18:19], v4 offset:8704
v_add_f32 v69, 1.0, v69
v_mfma_f32_16x16x32_bf16 v[108:111], v[20:23], v[132:135], 0
v_rcp_f32 v54, v54
v_cvt_pk_bf16_f32 v50, v52, v53
v_mfma_f32_16x16x32_bf16 v[112:115], v[24:27], v[128:131], 0
ds_read_b64_tr_b16 v[20:21], v9 offset:8192
ds_read_b64_tr_b16 v[22:23], v9 offset:8704
v_mul_f32 v54, v54, v62
v_mfma_f32_16x16x32_bf16 v[116:119], v[24:27], v[132:135], 0
s_add_u32 s55, s55, 4096
buffer_load_dwordx4 v[224:227], v13, s[32:35], s55 offen offset:0 sc1
v_permlane16_swap_b32 v48, v50
v_mfma_f32_16x16x32_bf16 v[120:123], v[28:31], v[128:131], 0
ds_read_b64_tr_b16 v[24:25], v5 offset:8192
ds_read_b64_tr_b16 v[26:27], v5 offset:8704
v_mfma_f32_16x16x32_bf16 v[124:127], v[28:31], v[132:135], 0
s_waitcnt vmcnt(21) lgkmcnt(6)
v_exp_f32 v70, -v70
v_mfma_f32_16x16x32_bf16 v[96:99], v[32:35], v[136:139], v[96:99]
ds_read_b64_tr_b16 v[28:29], v10 offset:8192
ds_read_b64_tr_b16 v[30:31], v10 offset:8704
v_add_f32 v70, 1.0, v70
v_mfma_f32_16x16x32_bf16 v[100:103], v[32:35], v[140:143], v[100:103]
buffer_load_dwordx4 v[228:231], v13, s[32:35], s55 offen offset:256 sc1
v_rcp_f32 v55, v55
v_mfma_f32_16x16x32_bf16 v[104:107], v[36:39], v[136:139], v[104:107]
ds_read_b64_tr_b16 v[32:33], v4 offset:12288
ds_read_b64_tr_b16 v[34:35], v4 offset:12800
v_mul_f32 v55, v55, v63
v_mfma_f32_16x16x32_bf16 v[108:111], v[36:39], v[140:143], v[108:111]
v_exp_f32 v71, -v71
v_cvt_pk_bf16_f32 v51, v54, v55
v_mfma_f32_16x16x32_bf16 v[112:115], v[40:43], v[136:139], v[112:115]
ds_read_b64_tr_b16 v[36:37], v9 offset:12288
ds_read_b64_tr_b16 v[38:39], v9 offset:12800
v_add_f32 v71, 1.0, v71
v_mfma_f32_16x16x32_bf16 v[116:119], v[40:43], v[140:143], v[116:119]
buffer_load_dwordx4 v[232:235], v13, s[32:35], s55 offen offset:2048 sc1
v_rcp_f32 v64, v64
v_mfma_f32_16x16x32_bf16 v[120:123], v[44:47], v[136:139], v[120:123]
ds_read_b64_tr_b16 v[40:41], v5 offset:12288
ds_read_b64_tr_b16 v[42:43], v5 offset:12800
v_mul_f32 v64, v64, v72
v_mfma_f32_16x16x32_bf16 v[124:127], v[44:47], v[140:143], v[124:127]
s_waitcnt vmcnt(21) lgkmcnt(6)
v_exp_f32 v80, -v80
v_mfma_f32_16x16x32_bf16 v[96:99], v[16:19], v[144:147], v[96:99]
ds_read_b64_tr_b16 v[44:45], v10 offset:12288
ds_read_b64_tr_b16 v[46:47], v10 offset:12800
v_add_f32 v80, 1.0, v80
v_mfma_f32_16x16x32_bf16 v[100:103], v[16:19], v[148:151], v[100:103]
buffer_load_dwordx4 v[236:239], v13, s[32:35], s55 offen offset:2304 sc1
v_rcp_f32 v65, v65
v_mfma_f32_16x16x32_bf16 v[104:107], v[20:23], v[144:147], v[104:107]
ds_read_b64_tr_b16 v[16:17], v4 offset:16384
ds_read_b64_tr_b16 v[18:19], v4 offset:16896
v_mul_f32 v65, v65, v73
v_mfma_f32_16x16x32_bf16 v[108:111], v[20:23], v[148:151], v[108:111]
v_exp_f32 v81, -v81
v_permlane16_swap_b32 v49, v51
v_mfma_f32_16x16x32_bf16 v[112:115], v[24:27], v[144:147], v[112:115]
ds_read_b64_tr_b16 v[20:21], v9 offset:16384
ds_read_b64_tr_b16 v[22:23], v9 offset:16896
v_add_f32 v81, 1.0, v81
v_mfma_f32_16x16x32_bf16 v[116:119], v[24:27], v[148:151], v[116:119]
s_add_u32 s55, s55, 4096
buffer_load_dwordx4 v[240:243], v13, s[32:35], s55 offen offset:0 sc1
v_cvt_pk_bf16_f32 v64, v64, v65
v_mfma_f32_16x16x32_bf16 v[120:123], v[28:31], v[144:147], v[120:123]
ds_read_b64_tr_b16 v[24:25], v5 offset:16384
ds_read_b64_tr_b16 v[26:27], v5 offset:16896
v_mfma_f32_16x16x32_bf16 v[124:127], v[28:31], v[148:151], v[124:127]
buffer_store_dwordx4 v[48:51], v8, s[32:35], s72 offen sc1
s_waitcnt vmcnt(22) lgkmcnt(6)
v_mfma_f32_16x16x32_bf16 v[96:99], v[32:35], v[152:155], v[96:99]
ds_read_b64_tr_b16 v[28:29], v10 offset:16384
ds_read_b64_tr_b16 v[30:31], v10 offset:16896
v_mfma_f32_16x16x32_bf16 v[100:103], v[32:35], v[156:159], v[100:103]
buffer_load_dwordx4 v[244:247], v13, s[32:35], s55 offen offset:256 sc1
v_rcp_f32 v66, v66
v_mfma_f32_16x16x32_bf16 v[104:107], v[36:39], v[152:155], v[104:107]
ds_read_b64_tr_b16 v[32:33], v4 offset:20480
ds_read_b64_tr_b16 v[34:35], v4 offset:20992
v_mul_f32 v66, v66, v74
v_mfma_f32_16x16x32_bf16 v[108:111], v[36:39], v[156:159], v[108:111]
v_exp_f32 v82, -v82
v_mfma_f32_16x16x32_bf16 v[112:115], v[40:43], v[152:155], v[112:115]
ds_read_b64_tr_b16 v[36:37], v9 offset:20480
ds_read_b64_tr_b16 v[38:39], v9 offset:20992
v_add_f32 v82, 1.0, v82
v_mfma_f32_16x16x32_bf16 v[116:119], v[40:43], v[156:159], v[116:119]
buffer_load_dwordx4 v[248:251], v13, s[32:35], s55 offen offset:2048 sc1
v_rcp_f32 v67, v67
v_mfma_f32_16x16x32_bf16 v[120:123], v[44:47], v[152:155], v[120:123]
ds_read_b64_tr_b16 v[40:41], v5 offset:20480
ds_read_b64_tr_b16 v[42:43], v5 offset:20992
v_mul_f32 v67, v67, v75
v_mfma_f32_16x16x32_bf16 v[124:127], v[44:47], v[156:159], v[124:127]
s_waitcnt vmcnt(22) lgkmcnt(6)
v_exp_f32 v83, -v83
v_mfma_f32_16x16x32_bf16 v[96:99], v[16:19], v[160:163], v[96:99]
ds_read_b64_tr_b16 v[44:45], v10 offset:20480
ds_read_b64_tr_b16 v[46:47], v10 offset:20992
v_add_f32 v83, 1.0, v83
v_mfma_f32_16x16x32_bf16 v[100:103], v[16:19], v[164:167], v[100:103]
buffer_load_dwordx4 v[252:255], v13, s[32:35], s55 offen offset:2304 sc1
v_rcp_f32 v68, v68
v_mfma_f32_16x16x32_bf16 v[104:107], v[20:23], v[160:163], v[104:107]
ds_read_b64_tr_b16 v[16:17], v4 offset:24576
ds_read_b64_tr_b16 v[18:19], v4 offset:25088
v_mul_f32 v68, v68, v76
v_mfma_f32_16x16x32_bf16 v[108:111], v[20:23], v[164:167], v[108:111]
v_exp_f32 v84, -v84
v_cvt_pk_bf16_f32 v65, v66, v67
v_mfma_f32_16x16x32_bf16 v[112:115], v[24:27], v[160:163], v[112:115]
ds_read_b64_tr_b16 v[20:21], v9 offset:24576
ds_read_b64_tr_b16 v[22:23], v9 offset:25088
v_add_f32 v84, 1.0, v84
v_mfma_f32_16x16x32_bf16 v[116:119], v[24:27], v[164:167], v[116:119]
v_rcp_f32 v69, v69
v_mfma_f32_16x16x32_bf16 v[120:123], v[28:31], v[160:163], v[120:123]
ds_read_b64_tr_b16 v[24:25], v5 offset:24576
ds_read_b64_tr_b16 v[26:27], v5 offset:25088
v_mul_f32 v69, v69, v77
v_mfma_f32_16x16x32_bf16 v[124:127], v[28:31], v[164:167], v[124:127]
s_waitcnt vmcnt(21) lgkmcnt(6)
v_exp_f32 v85, -v85
v_mfma_f32_16x16x32_bf16 v[96:99], v[32:35], v[168:171], v[96:99]
ds_read_b64_tr_b16 v[28:29], v10 offset:24576
ds_read_b64_tr_b16 v[30:31], v10 offset:25088
v_add_f32 v85, 1.0, v85
v_mfma_f32_16x16x32_bf16 v[100:103], v[32:35], v[172:175], v[100:103]
v_rcp_f32 v70, v70
v_cvt_pk_bf16_f32 v66, v68, v69
v_mfma_f32_16x16x32_bf16 v[104:107], v[36:39], v[168:171], v[104:107]
ds_read_b64_tr_b16 v[32:33], v4 offset:28672
ds_read_b64_tr_b16 v[34:35], v4 offset:29184
v_mul_f32 v70, v70, v78
v_mfma_f32_16x16x32_bf16 v[108:111], v[36:39], v[172:175], v[108:111]
v_exp_f32 v86, -v86
v_permlane16_swap_b32 v64, v66
v_mfma_f32_16x16x32_bf16 v[112:115], v[40:43], v[168:171], v[112:115]
ds_read_b64_tr_b16 v[36:37], v9 offset:28672
ds_read_b64_tr_b16 v[38:39], v9 offset:29184
v_add_f32 v86, 1.0, v86
v_mfma_f32_16x16x32_bf16 v[116:119], v[40:43], v[172:175], v[116:119]
v_rcp_f32 v71, v71
v_mfma_f32_16x16x32_bf16 v[120:123], v[44:47], v[168:171], v[120:123]
ds_read_b64_tr_b16 v[40:41], v5 offset:28672
ds_read_b64_tr_b16 v[42:43], v5 offset:29184
v_mul_f32 v71, v71, v79
v_mfma_f32_16x16x32_bf16 v[124:127], v[44:47], v[172:175], v[124:127]
s_waitcnt vmcnt(19) lgkmcnt(6)
v_exp_f32 v87, -v87
v_mfma_f32_16x16x32_bf16 v[96:99], v[16:19], v[176:179], v[96:99]
ds_read_b64_tr_b16 v[44:45], v10 offset:28672
ds_read_b64_tr_b16 v[46:47], v10 offset:29184
v_add_f32 v87, 1.0, v87
v_mfma_f32_16x16x32_bf16 v[100:103], v[16:19], v[180:183], v[100:103]
v_rcp_f32 v80, v80
v_cvt_pk_bf16_f32 v67, v70, v71
v_mfma_f32_16x16x32_bf16 v[104:107], v[20:23], v[176:179], v[104:107]
ds_read_b64_tr_b16 v[16:17], v4 offset:32768
ds_read_b64_tr_b16 v[18:19], v4 offset:33280
v_mul_f32 v80, v80, v88
v_mfma_f32_16x16x32_bf16 v[108:111], v[20:23], v[180:183], v[108:111]
v_rcp_f32 v81, v81
v_permlane16_swap_b32 v65, v67
v_mfma_f32_16x16x32_bf16 v[112:115], v[24:27], v[176:179], v[112:115]
ds_read_b64_tr_b16 v[20:21], v9 offset:32768
ds_read_b64_tr_b16 v[22:23], v9 offset:33280
v_mul_f32 v81, v81, v89
v_mfma_f32_16x16x32_bf16 v[116:119], v[24:27], v[180:183], v[116:119]
buffer_store_dwordx4 v[64:67], v8, s[32:35], s73 offen sc1
v_cvt_pk_bf16_f32 v80, v80, v81
v_mfma_f32_16x16x32_bf16 v[120:123], v[28:31], v[176:179], v[120:123]
ds_read_b64_tr_b16 v[24:25], v5 offset:32768
ds_read_b64_tr_b16 v[26:27], v5 offset:33280
v_mfma_f32_16x16x32_bf16 v[124:127], v[28:31], v[180:183], v[124:127]
s_waitcnt vmcnt(18) lgkmcnt(6)
v_rcp_f32 v82, v82
v_mfma_f32_16x16x32_bf16 v[96:99], v[32:35], v[184:187], v[96:99]
ds_read_b64_tr_b16 v[28:29], v10 offset:32768
ds_read_b64_tr_b16 v[30:31], v10 offset:33280
v_mul_f32 v82, v82, v90
v_mfma_f32_16x16x32_bf16 v[100:103], v[32:35], v[188:191], v[100:103]
v_rcp_f32 v83, v83
v_mfma_f32_16x16x32_bf16 v[104:107], v[36:39], v[184:187], v[104:107]
ds_read_b64_tr_b16 v[32:33], v4 offset:36864
ds_read_b64_tr_b16 v[34:35], v4 offset:37376
v_mul_f32 v83, v83, v91
v_mfma_f32_16x16x32_bf16 v[108:111], v[36:39], v[188:191], v[108:111]
v_rcp_f32 v84, v84
v_cvt_pk_bf16_f32 v81, v82, v83
v_mfma_f32_16x16x32_bf16 v[112:115], v[40:43], v[184:187], v[112:115]
ds_read_b64_tr_b16 v[36:37], v9 offset:36864
ds_read_b64_tr_b16 v[38:39], v9 offset:37376
v_mul_f32 v84, v84, v92
v_mfma_f32_16x16x32_bf16 v[116:119], v[40:43], v[188:191], v[116:119]
v_rcp_f32 v85, v85
v_mfma_f32_16x16x32_bf16 v[120:123], v[44:47], v[184:187], v[120:123]
ds_read_b64_tr_b16 v[40:41], v5 offset:36864
ds_read_b64_tr_b16 v[42:43], v5 offset:37376
v_mul_f32 v85, v85, v93
v_mfma_f32_16x16x32_bf16 v[124:127], v[44:47], v[188:191], v[124:127]
s_waitcnt vmcnt(16) lgkmcnt(6)
v_rcp_f32 v86, v86
v_mfma_f32_16x16x32_bf16 v[96:99], v[16:19], v[192:195], v[96:99]
ds_read_b64_tr_b16 v[44:45], v10 offset:36864
ds_read_b64_tr_b16 v[46:47], v10 offset:37376
v_mul_f32 v86, v86, v94
v_mfma_f32_16x16x32_bf16 v[100:103], v[16:19], v[196:199], v[100:103]
v_rcp_f32 v87, v87
v_cvt_pk_bf16_f32 v82, v84, v85
v_mfma_f32_16x16x32_bf16 v[104:107], v[20:23], v[192:195], v[104:107]
ds_read_b64_tr_b16 v[16:17], v4 offset:40960
ds_read_b64_tr_b16 v[18:19], v4 offset:41472
v_mul_f32 v87, v87, v95
v_mfma_f32_16x16x32_bf16 v[108:111], v[20:23], v[196:199], v[108:111]
v_cvt_pk_bf16_f32 v83, v86, v87
v_permlane16_swap_b32 v80, v82
v_mfma_f32_16x16x32_bf16 v[112:115], v[24:27], v[192:195], v[112:115]
ds_read_b64_tr_b16 v[20:21], v9 offset:40960
ds_read_b64_tr_b16 v[22:23], v9 offset:41472
v_permlane16_swap_b32 v81, v83
v_mfma_f32_16x16x32_bf16 v[116:119], v[24:27], v[196:199], v[116:119]
buffer_store_dwordx4 v[80:83], v8, s[32:35], s74 offen sc1
v_mfma_f32_16x16x32_bf16 v[120:123], v[28:31], v[192:195], v[120:123]
ds_read_b64_tr_b16 v[24:25], v5 offset:40960
ds_read_b64_tr_b16 v[26:27], v5 offset:41472
v_mfma_f32_16x16x32_bf16 v[124:127], v[28:31], v[196:199], v[124:127]
s_waitcnt vmcnt(15) lgkmcnt(6)
v_mfma_f32_16x16x32_bf16 v[96:99], v[32:35], v[200:203], v[96:99]
ds_read_b64_tr_b16 v[28:29], v10 offset:40960
ds_read_b64_tr_b16 v[30:31], v10 offset:41472
v_mfma_f32_16x16x32_bf16 v[100:103], v[32:35], v[204:207], v[100:103]
v_mfma_f32_16x16x32_bf16 v[104:107], v[36:39], v[200:203], v[104:107]
ds_read_b64_tr_b16 v[32:33], v4 offset:45056
ds_read_b64_tr_b16 v[34:35], v4 offset:45568
v_mfma_f32_16x16x32_bf16 v[108:111], v[36:39], v[204:207], v[108:111]
v_mfma_f32_16x16x32_bf16 v[112:115], v[40:43], v[200:203], v[112:115]
ds_read_b64_tr_b16 v[36:37], v9 offset:45056
ds_read_b64_tr_b16 v[38:39], v9 offset:45568
v_mfma_f32_16x16x32_bf16 v[116:119], v[40:43], v[204:207], v[116:119]
v_mfma_f32_16x16x32_bf16 v[120:123], v[44:47], v[200:203], v[120:123]
ds_read_b64_tr_b16 v[40:41], v5 offset:45056
ds_read_b64_tr_b16 v[42:43], v5 offset:45568
v_mfma_f32_16x16x32_bf16 v[124:127], v[44:47], v[204:207], v[124:127]
s_waitcnt vmcnt(13) lgkmcnt(6)
v_mfma_f32_16x16x32_bf16 v[96:99], v[16:19], v[208:211], v[96:99]
ds_read_b64_tr_b16 v[44:45], v10 offset:45056
ds_read_b64_tr_b16 v[46:47], v10 offset:45568
v_mfma_f32_16x16x32_bf16 v[100:103], v[16:19], v[212:215], v[100:103]
v_mfma_f32_16x16x32_bf16 v[104:107], v[20:23], v[208:211], v[104:107]
ds_read_b64_tr_b16 v[16:17], v4 offset:49152
ds_read_b64_tr_b16 v[18:19], v4 offset:49664
v_mfma_f32_16x16x32_bf16 v[108:111], v[20:23], v[212:215], v[108:111]
v_mfma_f32_16x16x32_bf16 v[112:115], v[24:27], v[208:211], v[112:115]
ds_read_b64_tr_b16 v[20:21], v9 offset:49152
ds_read_b64_tr_b16 v[22:23], v9 offset:49664
v_mfma_f32_16x16x32_bf16 v[116:119], v[24:27], v[212:215], v[116:119]
v_mfma_f32_16x16x32_bf16 v[120:123], v[28:31], v[208:211], v[120:123]
ds_read_b64_tr_b16 v[24:25], v5 offset:49152
ds_read_b64_tr_b16 v[26:27], v5 offset:49664
v_mfma_f32_16x16x32_bf16 v[124:127], v[28:31], v[212:215], v[124:127]
s_waitcnt vmcnt(11) lgkmcnt(6)
v_mfma_f32_16x16x32_bf16 v[96:99], v[32:35], v[216:219], v[96:99]
ds_read_b64_tr_b16 v[28:29], v10 offset:49152
ds_read_b64_tr_b16 v[30:31], v10 offset:49664
v_mfma_f32_16x16x32_bf16 v[100:103], v[32:35], v[220:223], v[100:103]
v_mfma_f32_16x16x32_bf16 v[104:107], v[36:39], v[216:219], v[104:107]
ds_read_b64_tr_b16 v[32:33], v4 offset:53248
ds_read_b64_tr_b16 v[34:35], v4 offset:53760
v_mfma_f32_16x16x32_bf16 v[108:111], v[36:39], v[220:223], v[108:111]
v_mfma_f32_16x16x32_bf16 v[112:115], v[40:43], v[216:219], v[112:115]
ds_read_b64_tr_b16 v[36:37], v9 offset:53248
ds_read_b64_tr_b16 v[38:39], v9 offset:53760
v_mfma_f32_16x16x32_bf16 v[116:119], v[40:43], v[220:223], v[116:119]
v_mfma_f32_16x16x32_bf16 v[120:123], v[44:47], v[216:219], v[120:123]
ds_read_b64_tr_b16 v[40:41], v5 offset:53248
ds_read_b64_tr_b16 v[42:43], v5 offset:53760
v_mfma_f32_16x16x32_bf16 v[124:127], v[44:47], v[220:223], v[124:127]
s_waitcnt vmcnt(0)
v_add_u32_e64 v2, s53, 7
s_cmp_eq_u32 s71, 1
s_cbranch_scc0 OS_86
buffer_store_dword v2, off, s[32:35], s99 offset:0
OSb_87:
s_waitcnt lgkmcnt(6)
v_mfma_f32_16x16x32_bf16 v[96:99], v[16:19], v[224:227], v[96:99]
ds_read_b64_tr_b16 v[44:45], v10 offset:53248
ds_read_b64_tr_b16 v[46:47], v10 offset:53760
v_mfma_f32_16x16x32_bf16 v[100:103], v[16:19], v[228:231], v[100:103]
v_mfma_f32_16x16x32_bf16 v[104:107], v[20:23], v[224:227], v[104:107]
ds_read_b64_tr_b16 v[16:17], v4 offset:57344
ds_read_b64_tr_b16 v[18:19], v4 offset:57856
v_mfma_f32_16x16x32_bf16 v[108:111], v[20:23], v[228:231], v[108:111]
v_mfma_f32_16x16x32_bf16 v[112:115], v[24:27], v[224:227], v[112:115]
ds_read_b64_tr_b16 v[20:21], v9 offset:57344
ds_read_b64_tr_b16 v[22:23], v9 offset:57856
v_mfma_f32_16x16x32_bf16 v[116:119], v[24:27], v[228:231], v[116:119]
v_mfma_f32_16x16x32_bf16 v[120:123], v[28:31], v[224:227], v[120:123]
ds_read_b64_tr_b16 v[24:25], v5 offset:57344
ds_read_b64_tr_b16 v[26:27], v5 offset:57856
v_mfma_f32_16x16x32_bf16 v[124:127], v[28:31], v[228:231], v[124:127]
s_waitcnt lgkmcnt(6)
v_mfma_f32_16x16x32_bf16 v[96:99], v[32:35], v[232:235], v[96:99]
ds_read_b64_tr_b16 v[28:29], v10 offset:57344
ds_read_b64_tr_b16 v[30:31], v10 offset:57856
v_mfma_f32_16x16x32_bf16 v[100:103], v[32:35], v[236:239], v[100:103]
v_mfma_f32_16x16x32_bf16 v[104:107], v[36:39], v[232:235], v[104:107]
ds_read_b64_tr_b16 v[32:33], v4 offset:61440
ds_read_b64_tr_b16 v[34:35], v4 offset:61952
v_mfma_f32_16x16x32_bf16 v[108:111], v[36:39], v[236:239], v[108:111]
v_mfma_f32_16x16x32_bf16 v[112:115], v[40:43], v[232:235], v[112:115]
ds_read_b64_tr_b16 v[36:37], v9 offset:61440
ds_read_b64_tr_b16 v[38:39], v9 offset:61952
v_mfma_f32_16x16x32_bf16 v[116:119], v[40:43], v[236:239], v[116:119]
v_mfma_f32_16x16x32_bf16 v[120:123], v[44:47], v[232:235], v[120:123]
ds_read_b64_tr_b16 v[40:41], v5 offset:61440
ds_read_b64_tr_b16 v[42:43], v5 offset:61952
v_mfma_f32_16x16x32_bf16 v[124:127], v[44:47], v[236:239], v[124:127]
s_waitcnt lgkmcnt(6)
v_mfma_f32_16x16x32_bf16 v[96:99], v[16:19], v[240:243], v[96:99]
ds_read_b64_tr_b16 v[44:45], v10 offset:61440
ds_read_b64_tr_b16 v[46:47], v10 offset:61952
v_mfma_f32_16x16x32_bf16 v[100:103], v[16:19], v[244:247], v[100:103]
v_mfma_f32_16x16x32_bf16 v[104:107], v[20:23], v[240:243], v[104:107]
ds_read_b64_tr_b16 v[16:17], v6 offset:0
ds_read_b64_tr_b16 v[18:19], v6 offset:512
v_mfma_f32_16x16x32_bf16 v[108:111], v[20:23], v[244:247], v[108:111]
v_mfma_f32_16x16x32_bf16 v[112:115], v[24:27], v[240:243], v[112:115]
ds_read_b64_tr_b16 v[20:21], v11 offset:0
ds_read_b64_tr_b16 v[22:23], v11 offset:512
v_mfma_f32_16x16x32_bf16 v[116:119], v[24:27], v[244:247], v[116:119]
v_mfma_f32_16x16x32_bf16 v[120:123], v[28:31], v[240:243], v[120:123]
ds_read_b64_tr_b16 v[24:25], v6 offset:4096
ds_read_b64_tr_b16 v[26:27], v6 offset:4608
v_mfma_f32_16x16x32_bf16 v[124:127], v[28:31], v[244:247], v[124:127]
s_waitcnt lgkmcnt(6)
v_mfma_f32_16x16x32_bf16 v[96:99], v[32:35], v[248:251], v[96:99]
ds_read_b64_tr_b16 v[28:29], v11 offset:4096
ds_read_b64_tr_b16 v[30:31], v11 offset:4608
v_mfma_f32_16x16x32_bf16 v[100:103], v[32:35], v[252:255], v[100:103]
v_mfma_f32_16x16x32_bf16 v[104:107], v[36:39], v[248:251], v[104:107]
ds_read_b64_tr_b16 v[32:33], v6 offset:8192
ds_read_b64_tr_b16 v[34:35], v6 offset:8704
v_mfma_f32_16x16x32_bf16 v[108:111], v[36:39], v[252:255], v[108:111]
v_mfma_f32_16x16x32_bf16 v[112:115], v[40:43], v[248:251], v[112:115]
ds_read_b64_tr_b16 v[36:37], v11 offset:8192
ds_read_b64_tr_b16 v[38:39], v11 offset:8704
v_mfma_f32_16x16x32_bf16 v[116:119], v[40:43], v[252:255], v[116:119]
v_mfma_f32_16x16x32_bf16 v[120:123], v[44:47], v[248:251], v[120:123]
ds_read_b64_tr_b16 v[40:41], v6 offset:12288
ds_read_b64_tr_b16 v[42:43], v6 offset:12800
v_mfma_f32_16x16x32_bf16 v[124:127], v[44:47], v[252:255], v[124:127]
s_waitcnt lgkmcnt(6)
v_mfma_f32_16x16x32_bf16 v[48:51], v[16:19], v[128:131], 0
ds_read_b64_tr_b16 v[44:45], v11 offset:12288
ds_read_b64_tr_b16 v[46:47], v11 offset:12800
v_mfma_f32_16x16x32_bf16 v[52:55], v[16:19], v[132:135], 0
v_exp_f32 v96, -v96
v_mfma_f32_16x16x32_bf16 v[56:59], v[20:23], v[128:131], 0
ds_read_b64_tr_b16 v[16:17], v6 offset:16384
ds_read_b64_tr_b16 v[18:19], v6 offset:16896
v_add_f32 v96, 1.0, v96
v_mfma_f32_16x16x32_bf16 v[60:63], v[20:23], v[132:135], 0
v_exp_f32 v97, -v97
v_mfma_f32_16x16x32_bf16 v[48:51], v[24:27], v[136:139], v[48:51]
ds_read_b64_tr_b16 v[20:21], v11 offset:16384
ds_read_b64_tr_b16 v[22:23], v11 offset:16896
v_add_f32 v97, 1.0, v97
v_mfma_f32_16x16x32_bf16 v[52:55], v[24:27], v[140:143], v[52:55]
v_exp_f32 v98, -v98
v_mfma_f32_16x16x32_bf16 v[56:59], v[28:31], v[136:139], v[56:59]
ds_read_b64_tr_b16 v[24:25], v6 offset:20480
ds_read_b64_tr_b16 v[26:27], v6 offset:20992
v_add_f32 v98, 1.0, v98
v_mfma_f32_16x16x32_bf16 v[60:63], v[28:31], v[140:143], v[60:63]
s_waitcnt lgkmcnt(6)
v_exp_f32 v99, -v99
v_mfma_f32_16x16x32_bf16 v[48:51], v[32:35], v[144:147], v[48:51]
ds_read_b64_tr_b16 v[28:29], v11 offset:20480
ds_read_b64_tr_b16 v[30:31], v11 offset:20992
v_add_f32 v99, 1.0, v99
v_mfma_f32_16x16x32_bf16 v[52:55], v[32:35], v[148:151], v[52:55]
s_cmp_eq_u32 s31, 31
s_cbranch_scc1 WBo_90
WB_88:
buffer_load_dword v3, off, s[32:35], 0
WBj_89:
v_mfma_f32_16x16x32_bf16 v[56:59], v[36:39], v[144:147], v[56:59]
ds_read_b64_tr_b16 v[32:33], v6 offset:24576
ds_read_b64_tr_b16 v[34:35], v6 offset:25088
v_mfma_f32_16x16x32_bf16 v[60:63], v[36:39], v[148:151], v[60:63]
v_exp_f32 v100, -v100
v_mfma_f32_16x16x32_bf16 v[48:51], v[40:43], v[152:155], v[48:51]
ds_read_b64_tr_b16 v[36:37], v11 offset:24576
ds_read_b64_tr_b16 v[38:39], v11 offset:25088
v_add_f32 v100, 1.0, v100
v_mfma_f32_16x16x32_bf16 v[52:55], v[40:43], v[156:159], v[52:55]
v_exp_f32 v101, -v101
v_mfma_f32_16x16x32_bf16 v[56:59], v[44:47], v[152:155], v[56:59]
ds_read_b64_tr_b16 v[40:41], v6 offset:28672
ds_read_b64_tr_b16 v[42:43], v6 offset:29184
v_add_f32 v101, 1.0, v101
v_mfma_f32_16x16x32_bf16 v[60:63], v[44:47], v[156:159], v[60:63]
s_waitcnt lgkmcnt(6)
v_exp_f32 v102, -v102
v_mfma_f32_16x16x32_bf16 v[48:51], v[16:19], v[160:163], v[48:51]
ds_read_b64_tr_b16 v[44:45], v11 offset:28672
ds_read_b64_tr_b16 v[46:47], v11 offset:29184
v_add_f32 v102, 1.0, v102
v_mfma_f32_16x16x32_bf16 v[52:55], v[16:19], v[164:167], v[52:55]
v_exp_f32 v103, -v103
v_mfma_f32_16x16x32_bf16 v[56:59], v[20:23], v[160:163], v[56:59]
ds_read_b64_tr_b16 v[16:17], v6 offset:32768
ds_read_b64_tr_b16 v[18:19], v6 offset:33280
v_add_f32 v103, 1.0, v103
v_mfma_f32_16x16x32_bf16 v[60:63], v[20:23], v[164:167], v[60:63]
v_rcp_f32 v96, v96
v_mfma_f32_16x16x32_bf16 v[48:51], v[24:27], v[168:171], v[48:51]
ds_read_b64_tr_b16 v[20:21], v11 offset:32768
ds_read_b64_tr_b16 v[22:23], v11 offset:33280
v_mul_f32 v96, v96, v104
v_mfma_f32_16x16x32_bf16 v[52:55], v[24:27], v[172:175], v[52:55]
v_exp_f32 v112, -v112
v_mfma_f32_16x16x32_bf16 v[56:59], v[28:31], v[168:171], v[56:59]
ds_read_b64_tr_b16 v[24:25], v6 offset:36864
ds_read_b64_tr_b16 v[26:27], v6 offset:37376
v_add_f32 v112, 1.0, v112
v_mfma_f32_16x16x32_bf16 v[60:63], v[28:31], v[172:175], v[60:63]
s_waitcnt lgkmcnt(6)
v_rcp_f32 v97, v97
v_mfma_f32_16x16x32_bf16 v[48:51], v[32:35], v[176:179], v[48:51]
ds_read_b64_tr_b16 v[28:29], v11 offset:36864
ds_read_b64_tr_b16 v[30:31], v11 offset:37376
v_mul_f32 v97, v97, v105
v_mfma_f32_16x16x32_bf16 v[52:55], v[32:35], v[180:183], v[52:55]
v_exp_f32 v113, -v113
v_cvt_pk_bf16_f32 v96, v96, v97
v_mfma_f32_16x16x32_bf16 v[56:59], v[36:39], v[176:179], v[56:59]
ds_read_b64_tr_b16 v[32:33], v6 offset:40960
ds_read_b64_tr_b16 v[34:35], v6 offset:41472
v_add_f32 v113, 1.0, v113
v_mfma_f32_16x16x32_bf16 v[60:63], v[36:39], v[180:183], v[60:63]
v_rcp_f32 v98, v98
v_mfma_f32_16x16x32_bf16 v[48:51], v[40:43], v[184:187], v[48:51]
ds_read_b64_tr_b16 v[36:37], v11 offset:40960
ds_read_b64_tr_b16 v[38:39], v11 offset:41472
v_mul_f32 v98, v98, v106
v_mfma_f32_16x16x32_bf16 v[52:55], v[40:43], v[188:191], v[52:55]
v_exp_f32 v114, -v114
v_mfma_f32_16x16x32_bf16 v[56:59], v[44:47], v[184:187], v[56:59]
ds_read_b64_tr_b16 v[40:41], v6 offset:45056
ds_read_b64_tr_b16 v[42:43], v6 offset:45568
v_add_f32 v114, 1.0, v114
v_mfma_f32_16x16x32_bf16 v[60:63], v[44:47], v[188:191], v[60:63]
s_waitcnt lgkmcnt(6)
v_rcp_f32 v99, v99
v_mfma_f32_16x16x32_bf16 v[48:51], v[16:19], v[192:195], v[48:51]
ds_read_b64_tr_b16 v[44:45], v11 offset:45056
ds_read_b64_tr_b16 v[46:47], v11 offset:45568
v_mul_f32 v99, v99, v107
v_mfma_f32_16x16x32_bf16 v[52:55], v[16:19], v[196:199], v[52:55]
v_exp_f32 v115, -v115
v_cvt_pk_bf16_f32 v97, v98, v99
v_mfma_f32_16x16x32_bf16 v[56:59], v[20:23], v[192:195], v[56:59]
ds_read_b64_tr_b16 v[16:17], v6 offset:49152
ds_read_b64_tr_b16 v[18:19], v6 offset:49664
v_add_f32 v115, 1.0, v115
v_mfma_f32_16x16x32_bf16 v[60:63], v[20:23], v[196:199], v[60:63]
v_rcp_f32 v100, v100
v_mfma_f32_16x16x32_bf16 v[48:51], v[24:27], v[200:203], v[48:51]
ds_read_b64_tr_b16 v[20:21], v11 offset:49152
ds_read_b64_tr_b16 v[22:23], v11 offset:49664
v_mul_f32 v100, v100, v108
v_mfma_f32_16x16x32_bf16 v[52:55], v[24:27], v[204:207], v[52:55]
v_exp_f32 v116, -v116
v_mfma_f32_16x16x32_bf16 v[56:59], v[28:31], v[200:203], v[56:59]
ds_read_b64_tr_b16 v[24:25], v6 offset:53248
ds_read_b64_tr_b16 v[26:27], v6 offset:53760
v_add_f32 v116, 1.0, v116
v_mfma_f32_16x16x32_bf16 v[60:63], v[28:31], v[204:207], v[60:63]
s_waitcnt lgkmcnt(6)
v_rcp_f32 v101, v101
v_mfma_f32_16x16x32_bf16 v[48:51], v[32:35], v[208:211], v[48:51]
ds_read_b64_tr_b16 v[28:29], v11 offset:53248
ds_read_b64_tr_b16 v[30:31], v11 offset:53760
v_mul_f32 v101, v101, v109
v_mfma_f32_16x16x32_bf16 v[52:55], v[32:35], v[212:215], v[52:55]
v_exp_f32 v117, -v117
v_cvt_pk_bf16_f32 v98, v100, v101
v_mfma_f32_16x16x32_bf16 v[56:59], v[36:39], v[208:211], v[56:59]
ds_read_b64_tr_b16 v[32:33], v6 offset:57344
ds_read_b64_tr_b16 v[34:35], v6 offset:57856
v_add_f32 v117, 1.0, v117
v_mfma_f32_16x16x32_bf16 v[60:63], v[36:39], v[212:215], v[60:63]
v_rcp_f32 v102, v102
v_permlane16_swap_b32 v96, v98
v_mfma_f32_16x16x32_bf16 v[48:51], v[40:43], v[216:219], v[48:51]
ds_read_b64_tr_b16 v[36:37], v11 offset:57344
ds_read_b64_tr_b16 v[38:39], v11 offset:57856
v_mul_f32 v102, v102, v110
v_mfma_f32_16x16x32_bf16 v[52:55], v[40:43], v[220:223], v[52:55]
v_exp_f32 v118, -v118
v_mfma_f32_16x16x32_bf16 v[56:59], v[44:47], v[216:219], v[56:59]
ds_read_b64_tr_b16 v[40:41], v6 offset:61440
ds_read_b64_tr_b16 v[42:43], v6 offset:61952
v_add_f32 v118, 1.0, v118
v_mfma_f32_16x16x32_bf16 v[60:63], v[44:47], v[220:223], v[60:63]
s_waitcnt lgkmcnt(6)
v_rcp_f32 v103, v103
v_mfma_f32_16x16x32_bf16 v[48:51], v[16:19], v[224:227], v[48:51]
ds_read_b64_tr_b16 v[44:45], v11 offset:61440
ds_read_b64_tr_b16 v[46:47], v11 offset:61952
v_mul_f32 v103, v103, v111
v_mfma_f32_16x16x32_bf16 v[52:55], v[16:19], v[228:231], v[52:55]
v_exp_f32 v119, -v119
v_cvt_pk_bf16_f32 v99, v102, v103
v_mfma_f32_16x16x32_bf16 v[56:59], v[20:23], v[224:227], v[56:59]
ds_read_b64_tr_b16 v[16:17], v7 offset:0
ds_read_b64_tr_b16 v[18:19], v7 offset:512
v_add_f32 v119, 1.0, v119
v_mfma_f32_16x16x32_bf16 v[60:63], v[20:23], v[228:231], v[60:63]
v_rcp_f32 v112, v112
v_permlane16_swap_b32 v97, v99
v_mfma_f32_16x16x32_bf16 v[48:51], v[24:27], v[232:235], v[48:51]
ds_read_b64_tr_b16 v[20:21], v12 offset:0
ds_read_b64_tr_b16 v[22:23], v12 offset:512
v_mul_f32 v112, v112, v120
v_mfma_f32_16x16x32_bf16 v[52:55], v[24:27], v[236:239], v[52:55]
buffer_store_dwordx4 v[96:99], v8, s[32:35], s75 offen sc1
v_mfma_f32_16x16x32_bf16 v[56:59], v[28:31], v[232:235], v[56:59]
ds_read_b64_tr_b16 v[24:25], v7 offset:4096
ds_read_b64_tr_b16 v[26:27], v7 offset:4608
v_mfma_f32_16x16x32_bf16 v[60:63], v[28:31], v[236:239], v[60:63]
s_waitcnt lgkmcnt(6)
v_rcp_f32 v113, v113
v_mfma_f32_16x16x32_bf16 v[48:51], v[32:35], v[240:243], v[48:51]
ds_read_b64_tr_b16 v[28:29], v12 offset:4096
ds_read_b64_tr_b16 v[30:31], v12 offset:4608
v_mul_f32 v113, v113, v121
v_mfma_f32_16x16x32_bf16 v[52:55], v[32:35], v[244:247], v[52:55]
v_rcp_f32 v114, v114
v_cvt_pk_bf16_f32 v112, v112, v113
v_mfma_f32_16x16x32_bf16 v[56:59], v[36:39], v[240:243], v[56:59]
ds_read_b64_tr_b16 v[32:33], v7 offset:8192
ds_read_b64_tr_b16 v[34:35], v7 offset:8704
v_mul_f32 v114, v114, v122
v_mfma_f32_16x16x32_bf16 v[60:63], v[36:39], v[244:247], v[60:63]
v_rcp_f32 v115, v115
v_mfma_f32_16x16x32_bf16 v[48:51], v[40:43], v[248:251], v[48:51]
ds_read_b64_tr_b16 v[36:37], v12 offset:8192
ds_read_b64_tr_b16 v[38:39], v12 offset:8704
v_mul_f32 v115, v115, v123
v_mfma_f32_16x16x32_bf16 v[52:55], v[40:43], v[252:255], v[52:55]
v_accvgpr_read_b32 v14, a244
buffer_load_dword v15, v14, s[32:35], 0 offen sc1
v_cvt_pk_bf16_f32 v113, v114, v115
v_mfma_f32_16x16x32_bf16 v[56:59], v[44:47], v[248:251], v[56:59]
ds_read_b64_tr_b16 v[40:41], v7 offset:12288
ds_read_b64_tr_b16 v[42:43], v7 offset:12800
v_mfma_f32_16x16x32_bf16 v[60:63], v[44:47], v[252:255], v[60:63]
s_waitcnt lgkmcnt(6)
v_rcp_f32 v116, v116
v_mfma_f32_16x16x32_bf16 v[64:67], v[16:19], v[128:131], 0
ds_read_b64_tr_b16 v[44:45], v12 offset:12288
ds_read_b64_tr_b16 v[46:47], v12 offset:12800
v_mul_f32 v116, v116, v124
v_mfma_f32_16x16x32_bf16 v[68:71], v[16:19], v[132:135], 0
v_rcp_f32 v117, v117
v_mfma_f32_16x16x32_bf16 v[72:75], v[20:23], v[128:131], 0
ds_read_b64_tr_b16 v[16:17], v7 offset:16384
ds_read_b64_tr_b16 v[18:19], v7 offset:16896
v_mul_f32 v117, v117, v125
v_mfma_f32_16x16x32_bf16 v[76:79], v[20:23], v[132:135], 0
v_rcp_f32 v118, v118
v_cvt_pk_bf16_f32 v114, v116, v117
v_mfma_f32_16x16x32_bf16 v[64:67], v[24:27], v[136:139], v[64:67]
ds_read_b64_tr_b16 v[20:21], v12 offset:16384
ds_read_b64_tr_b16 v[22:23], v12 offset:16896
v_mul_f32 v118, v118, v126
v_mfma_f32_16x16x32_bf16 v[68:71], v[24:27], v[140:143], v[68:71]
v_exp_f32 v48, -v48
v_permlane16_swap_b32 v112, v114
v_mfma_f32_16x16x32_bf16 v[72:75], v[28:31], v[136:139], v[72:75]
ds_read_b64_tr_b16 v[24:25], v7 offset:20480
ds_read_b64_tr_b16 v[26:27], v7 offset:20992
v_add_f32 v48, 1.0, v48
v_mfma_f32_16x16x32_bf16 v[76:79], v[28:31], v[140:143], v[76:79]
s_waitcnt lgkmcnt(6)
v_exp_f32 v49, -v49
v_mfma_f32_16x16x32_bf16 v[64:67], v[32:35], v[144:147], v[64:67]
ds_read_b64_tr_b16 v[28:29], v12 offset:20480
ds_read_b64_tr_b16 v[30:31], v12 offset:20992
v_add_f32 v49, 1.0, v49
v_mfma_f32_16x16x32_bf16 v[68:71], v[32:35], v[148:151], v[68:71]
v_exp_f32 v50, -v50
v_mfma_f32_16x16x32_bf16 v[72:75], v[36:39], v[144:147], v[72:75]
ds_read_b64_tr_b16 v[32:33], v7 offset:24576
ds_read_b64_tr_b16 v[34:35], v7 offset:25088
v_add_f32 v50, 1.0, v50
v_mfma_f32_16x16x32_bf16 v[76:79], v[36:39], v[148:151], v[76:79]
v_exp_f32 v51, -v51
v_mfma_f32_16x16x32_bf16 v[64:67], v[40:43], v[152:155], v[64:67]
ds_read_b64_tr_b16 v[36:37], v12 offset:24576
ds_read_b64_tr_b16 v[38:39], v12 offset:25088
v_add_f32 v51, 1.0, v51
v_mfma_f32_16x16x32_bf16 v[68:71], v[40:43], v[156:159], v[68:71]
v_exp_f32 v52, -v52
v_mfma_f32_16x16x32_bf16 v[72:75], v[44:47], v[152:155], v[72:75]
ds_read_b64_tr_b16 v[40:41], v7 offset:28672
ds_read_b64_tr_b16 v[42:43], v7 offset:29184
v_add_f32 v52, 1.0, v52
v_mfma_f32_16x16x32_bf16 v[76:79], v[44:47], v[156:159], v[76:79]
s_waitcnt lgkmcnt(6)
v_exp_f32 v53, -v53
v_mfma_f32_16x16x32_bf16 v[64:67], v[16:19], v[160:163], v[64:67]
ds_read_b64_tr_b16 v[44:45], v12 offset:28672
ds_read_b64_tr_b16 v[46:47], v12 offset:29184
v_add_f32 v53, 1.0, v53
v_mfma_f32_16x16x32_bf16 v[68:71], v[16:19], v[164:167], v[68:71]
v_exp_f32 v54, -v54
v_mfma_f32_16x16x32_bf16 v[72:75], v[20:23], v[160:163], v[72:75]
ds_read_b64_tr_b16 v[16:17], v7 offset:32768
ds_read_b64_tr_b16 v[18:19], v7 offset:33280
v_add_f32 v54, 1.0, v54
v_mfma_f32_16x16x32_bf16 v[76:79], v[20:23], v[164:167], v[76:79]
v_rcp_f32 v119, v119
v_mfma_f32_16x16x32_bf16 v[64:67], v[24:27], v[168:171], v[64:67]
ds_read_b64_tr_b16 v[20:21], v12 offset:32768
ds_read_b64_tr_b16 v[22:23], v12 offset:33280
v_mul_f32 v119, v119, v127
v_mfma_f32_16x16x32_bf16 v[68:71], v[24:27], v[172:175], v[68:71]
s_add_u32 s96, s53, 7
s_waitcnt vmcnt(0)
v_cmp_ne_u32 vcc, s96, v15
v_mfma_f32_16x16x32_bf16 v[72:75], v[28:31], v[168:171], v[72:75]
ds_read_b64_tr_b16 v[24:25], v7 offset:36864
ds_read_b64_tr_b16 v[26:27], v7 offset:37376
v_cvt_pk_bf16_f32 v115, v118, v119
v_mfma_f32_16x16x32_bf16 v[76:79], v[28:31], v[172:175], v[76:79]
s_cbranch_vccnz HZ_91
HZb_92:
s_waitcnt lgkmcnt(6)
v_mfma_f32_16x16x32_bf16 v[64:67], v[32:35], v[176:179], v[64:67]
ds_read_b64_tr_b16 v[28:29], v12 offset:36864
ds_read_b64_tr_b16 v[30:31], v12 offset:37376
v_permlane16_swap_b32 v113, v115
v_mfma_f32_16x16x32_bf16 v[68:71], v[32:35], v[180:183], v[68:71]
s_mov_b32 s54, s82
buffer_load_dwordx4 v[128:131], v13, s[32:35], s54 offen offset:0 sc1
v_mfma_f32_16x16x32_bf16 v[72:75], v[36:39], v[176:179], v[72:75]
ds_read_b64_tr_b16 v[32:33], v7 offset:40960
ds_read_b64_tr_b16 v[34:35], v7 offset:41472
v_mfma_f32_16x16x32_bf16 v[76:79], v[36:39], v[180:183], v[76:79]
buffer_store_dwordx4 v[112:115], v8, s[32:35], s76 offen sc1
v_mfma_f32_16x16x32_bf16 v[64:67], v[40:43], v[184:187], v[64:67]
ds_read_b64_tr_b16 v[36:37], v12 offset:40960
ds_read_b64_tr_b16 v[38:39], v12 offset:41472
v_mfma_f32_16x16x32_bf16 v[68:71], v[40:43], v[188:191], v[68:71]
buffer_load_dwordx4 v[132:135], v13, s[32:35], s54 offen offset:256 sc1
v_mfma_f32_16x16x32_bf16 v[72:75], v[44:47], v[184:187], v[72:75]
ds_read_b64_tr_b16 v[40:41], v7 offset:45056
ds_read_b64_tr_b16 v[42:43], v7 offset:45568
v_mfma_f32_16x16x32_bf16 v[76:79], v[44:47], v[188:191], v[76:79]
s_waitcnt lgkmcnt(6)
v_exp_f32 v55, -v55
v_mfma_f32_16x16x32_bf16 v[64:67], v[16:19], v[192:195], v[64:67]
ds_read_b64_tr_b16 v[44:45], v12 offset:45056
ds_read_b64_tr_b16 v[46:47], v12 offset:45568
v_add_f32 v55, 1.0, v55
v_mfma_f32_16x16x32_bf16 v[68:71], v[16:19], v[196:199], v[68:71]
buffer_load_dwordx4 v[136:139], v13, s[32:35], s54 offen offset:2048 sc1
v_mfma_f32_16x16x32_bf16 v[72:75], v[20:23], v[192:195], v[72:75]
ds_read_b64_tr_b16 v[16:17], v7 offset:49152
ds_read_b64_tr_b16 v[18:19], v7 offset:49664
v_mfma_f32_16x16x32_bf16 v[76:79], v[20:23], v[196:199], v[76:79]
v_rcp_f32 v48, v48
v_mfma_f32_16x16x32_bf16 v[64:67], v[24:27], v[200:203], v[64:67]
ds_read_b64_tr_b16 v[20:21], v12 offset:49152
ds_read_b64_tr_b16 v[22:23], v12 offset:49664
v_mul_f32 v48, v48, v56
v_mfma_f32_16x16x32_bf16 v[68:71], v[24:27], v[204:207], v[68:71]
buffer_load_dwordx4 v[140:143], v13, s[32:35], s54 offen offset:2304 sc1
v_mfma_f32_16x16x32_bf16 v[72:75], v[28:31], v[200:203], v[72:75]
ds_read_b64_tr_b16 v[24:25], v7 offset:53248
ds_read_b64_tr_b16 v[26:27], v7 offset:53760
v_mfma_f32_16x16x32_bf16 v[76:79], v[28:31], v[204:207], v[76:79]
s_waitcnt lgkmcnt(6)
v_rcp_f32 v49, v49
v_mfma_f32_16x16x32_bf16 v[64:67], v[32:35], v[208:211], v[64:67]
ds_read_b64_tr_b16 v[28:29], v12 offset:53248
ds_read_b64_tr_b16 v[30:31], v12 offset:53760
v_mul_f32 v49, v49, v57
v_mfma_f32_16x16x32_bf16 v[68:71], v[32:35], v[212:215], v[68:71]
s_add_u32 s54, s54, 4096
buffer_load_dwordx4 v[144:147], v13, s[32:35], s54 offen offset:0 sc1
v_cvt_pk_bf16_f32 v48, v48, v49
v_mfma_f32_16x16x32_bf16 v[72:75], v[36:39], v[208:211], v[72:75]
ds_read_b64_tr_b16 v[32:33], v7 offset:57344
ds_read_b64_tr_b16 v[34:35], v7 offset:57856
v_mfma_f32_16x16x32_bf16 v[76:79], v[36:39], v[212:215], v[76:79]
v_rcp_f32 v50, v50
v_mfma_f32_16x16x32_bf16 v[64:67], v[40:43], v[216:219], v[64:67]
ds_read_b64_tr_b16 v[36:37], v12 offset:57344
ds_read_b64_tr_b16 v[38:39], v12 offset:57856
v_mul_f32 v50, v50, v58
v_mfma_f32_16x16x32_bf16 v[68:71], v[40:43], v[220:223], v[68:71]
buffer_load_dwordx4 v[148:151], v13, s[32:35], s54 offen offset:256 sc1
v_mfma_f32_16x16x32_bf16 v[72:75], v[44:47], v[216:219], v[72:75]
ds_read_b64_tr_b16 v[40:41], v7 offset:61440
ds_read_b64_tr_b16 v[42:43], v7 offset:61952
v_mfma_f32_16x16x32_bf16 v[76:79], v[44:47], v[220:223], v[76:79]
s_waitcnt lgkmcnt(6)
v_rcp_f32 v51, v51
v_mfma_f32_16x16x32_bf16 v[64:67], v[16:19], v[224:227], v[64:67]
ds_read_b64_tr_b16 v[44:45], v12 offset:61440
ds_read_b64_tr_b16 v[46:47], v12 offset:61952
v_mul_f32 v51, v51, v59
v_mfma_f32_16x16x32_bf16 v[68:71], v[16:19], v[228:231], v[68:71]
buffer_load_dwordx4 v[152:155], v13, s[32:35], s54 offen offset:2048 sc1
v_cvt_pk_bf16_f32 v49, v50, v51
v_mfma_f32_16x16x32_bf16 v[72:75], v[20:23], v[224:227], v[72:75]
v_rcp_f32 v52, v52
v_mfma_f32_16x16x32_bf16 v[76:79], v[20:23], v[228:231], v[76:79]
v_rcp_f32 v53, v53
v_mul_f32 v52, v52, v60
v_mfma_f32_16x16x32_bf16 v[64:67], v[24:27], v[232:235], v[64:67]
v_rcp_f32 v54, v54
v_mul_f32 v53, v53, v61
v_mfma_f32_16x16x32_bf16 v[68:71], v[24:27], v[236:239], v[68:71]
buffer_load_dwordx4 v[156:159], v13, s[32:35], s54 offen offset:2304 sc1
v_mul_f32 v54, v54, v62
v_mfma_f32_16x16x32_bf16 v[72:75], v[28:31], v[232:235], v[72:75]
v_rcp_f32 v55, v55
v_cvt_pk_bf16_f32 v50, v52, v53
v_mfma_f32_16x16x32_bf16 v[76:79], v[28:31], v[236:239], v[76:79]
s_waitcnt lgkmcnt(0)
v_mul_f32 v55, v55, v63
v_permlane16_swap_b32 v48, v50
v_mfma_f32_16x16x32_bf16 v[64:67], v[32:35], v[240:243], v[64:67]
v_cvt_pk_bf16_f32 v51, v54, v55
v_mfma_f32_16x16x32_bf16 v[68:71], v[32:35], v[244:247], v[68:71]
s_add_u32 s54, s54, 4096
buffer_load_dwordx4 v[160:163], v13, s[32:35], s54 offen offset:0 sc1
v_permlane16_swap_b32 v49, v51
v_mfma_f32_16x16x32_bf16 v[72:75], v[36:39], v[240:243], v[72:75]
buffer_store_dwordx4 v[48:51], v8, s[32:35], s77 offen sc1
v_mfma_f32_16x16x32_bf16 v[76:79], v[36:39], v[244:247], v[76:79]
v_mfma_f32_16x16x32_bf16 v[64:67], v[40:43], v[248:251], v[64:67]
v_mfma_f32_16x16x32_bf16 v[68:71], v[40:43], v[252:255], v[68:71]
buffer_load_dwordx4 v[164:167], v13, s[32:35], s54 offen offset:256 sc1
v_mfma_f32_16x16x32_bf16 v[72:75], v[44:47], v[248:251], v[72:75]
v_mfma_f32_16x16x32_bf16 v[76:79], v[44:47], v[252:255], v[76:79]
buffer_load_dwordx4 v[168:171], v13, s[32:35], s54 offen offset:2048 sc1
buffer_load_dwordx4 v[172:175], v13, s[32:35], s54 offen offset:2304 sc1
G1j_67:
s_nop 1
v_exp_f32 v64, -v64
v_exp_f32 v65, -v65
v_exp_f32 v66, -v66
v_exp_f32 v67, -v67
v_exp_f32 v68, -v68
v_exp_f32 v69, -v69
v_exp_f32 v70, -v70
v_exp_f32 v71, -v71
v_add_f32 v64, 1.0, v64
v_add_f32 v65, 1.0, v65
v_add_f32 v66, 1.0, v66
v_add_f32 v67, 1.0, v67
v_add_f32 v68, 1.0, v68
v_add_f32 v69, 1.0, v69
v_add_f32 v70, 1.0, v70
v_add_f32 v71, 1.0, v71
v_rcp_f32 v64, v64
v_rcp_f32 v65, v65
v_rcp_f32 v66, v66
v_rcp_f32 v67, v67
v_rcp_f32 v68, v68
v_rcp_f32 v69, v69
v_rcp_f32 v70, v70
v_rcp_f32 v71, v71
v_mul_f32 v64, v64, v72
v_mul_f32 v65, v65, v73
v_mul_f32 v66, v66, v74
v_mul_f32 v67, v67, v75
v_mul_f32 v68, v68, v76
v_mul_f32 v69, v69, v77
v_mul_f32 v70, v70, v78
v_mul_f32 v71, v71, v79
v_cvt_pk_bf16_f32 v64, v64, v65
v_cvt_pk_bf16_f32 v65, v66, v67
v_cvt_pk_bf16_f32 v66, v68, v69
v_cvt_pk_bf16_f32 v67, v70, v71
s_nop 0
v_permlane16_swap_b32 v64, v66
v_permlane16_swap_b32 v65, v67
buffer_store_dwordx4 v[64:67], v8, s[32:35], s78 offen sc1
s_lshl_b32 s96, s52, 13
s_add_u32 s96, s96, 131072
v_lshrrev_b32 v12, 5, v1
v_lshlrev_b32 v13, 10, v12
v_bfe_u32 v14, v1, 4, 1
v_lshl_add_u32 v13, v14, 9, v13
v_and_b32 v14, 15, v1
v_lshl_add_u32 v5, v14, 4, v13
v_lshlrev_b32 v12, 7, v12
v_xor_b32 v12, v12, v5
v_add_u32 v4, s96, v12
v_and_b32 v12, 7, v1
v_lshrrev_b32 v13, 3, v1
s_lshl_b32 s96, s52, 7
v_lshl_add_u32 v6, v12, 4, s96
v_bfe_u32 v14, v13, 1, 1
v_lshlrev_b32 v14, 7, v14
v_xor_b32 v6, v6, v14
v_lshrrev_b32 v14, 1, v13
v_lshl_add_u32 v6, v14, 10, v6
v_and_b32 v14, 1, v13
v_lshl_add_u32 v6, v14, 9, v6
v_add_u32 v6, 131072, v6
v_lshlrev_b32 v9, 10, v12
v_lshl_add_u32 v9, v13, 3, v9
s_mov_b32 s57, s83
s_add_u32 s58, s57, 131072
s_mov_b32 s59, 0xffff0000
s_mov_b32 s60, 0x3f317218
s_mov_b32 s61, 0x3f317218
s_waitcnt vmcnt(12)
v_mfma_f32_16x16x32_bf16 v[16:19], a[0:3], v[128:131], 0
s_add_u32 s54, s54, 4096
buffer_load_dwordx4 v[176:179], v5, s[32:35], s54 offen offset:0 sc1
v_mfma_f32_16x16x32_bf16 v[20:23], a[0:3], v[132:135], 0
v_mfma_f32_16x16x32_bf16 v[32:35], a[8:11], v[128:131], 0
buffer_load_dwordx4 v[180:183], v5, s[32:35], s54 offen offset:256 sc1
v_mfma_f32_16x16x32_bf16 v[36:39], a[8:11], v[132:135], 0
v_mfma_f32_16x16x32_bf16 v[24:27], a[4:7], v[128:131], 0
v_mfma_f32_16x16x32_bf16 v[28:31], a[4:7], v[132:135], 0
v_mfma_f32_16x16x32_bf16 v[40:43], a[12:15], v[128:131], 0
v_mfma_f32_16x16x32_bf16 v[44:47], a[12:15], v[132:135], 0
s_waitcnt vmcnt(12)
v_mfma_f32_16x16x32_bf16 v[16:19], a[16:19], v[136:139], v[16:19]
buffer_load_dwordx4 v[184:187], v5, s[32:35], s54 offen offset:2048 sc1
v_mfma_f32_16x16x32_bf16 v[20:23], a[16:19], v[140:143], v[20:23]
s_waitcnt vmcnt(3)
v_add_u32_e64 v2, s53, 7
s_cmp_eq_u32 s71, 1
s_cbranch_scc0 OS_94
buffer_store_dword v2, off, s[32:35], s99 offset:512
OSb_95:
v_mfma_f32_16x16x32_bf16 v[32:35], a[24:27], v[136:139], v[32:35]
buffer_load_dwordx4 v[188:191], v5, s[32:35], s54 offen offset:2304 sc1
v_mfma_f32_16x16x32_bf16 v[36:39], a[24:27], v[140:143], v[36:39]
v_mfma_f32_16x16x32_bf16 v[24:27], a[20:23], v[136:139], v[24:27]
v_mfma_f32_16x16x32_bf16 v[28:31], a[20:23], v[140:143], v[28:31]
v_mfma_f32_16x16x32_bf16 v[40:43], a[28:31], v[136:139], v[40:43]
v_mfma_f32_16x16x32_bf16 v[44:47], a[28:31], v[140:143], v[44:47]
v_mfma_f32_16x16x32_bf16 v[16:19], a[32:35], v[144:147], v[16:19]
s_add_u32 s54, s54, 4096
buffer_load_dwordx4 v[112:115], v5, s[32:35], s54 offen offset:0 sc1
v_mfma_f32_16x16x32_bf16 v[20:23], a[32:35], v[148:151], v[20:23]
v_mfma_f32_16x16x32_bf16 v[32:35], a[40:43], v[144:147], v[32:35]
buffer_load_dwordx4 v[116:119], v5, s[32:35], s54 offen offset:256 sc1
v_mfma_f32_16x16x32_bf16 v[36:39], a[40:43], v[148:151], v[36:39]
v_mfma_f32_16x16x32_bf16 v[24:27], a[36:39], v[144:147], v[24:27]
v_mfma_f32_16x16x32_bf16 v[28:31], a[36:39], v[148:151], v[28:31]
v_mfma_f32_16x16x32_bf16 v[40:43], a[44:47], v[144:147], v[40:43]
v_mfma_f32_16x16x32_bf16 v[44:47], a[44:47], v[148:151], v[44:47]
v_mfma_f32_16x16x32_bf16 v[16:19], a[48:51], v[152:155], v[16:19]
buffer_load_dwordx4 v[120:123], v5, s[32:35], s54 offen offset:2048 sc1
v_mfma_f32_16x16x32_bf16 v[20:23], a[48:51], v[156:159], v[20:23]
v_mfma_f32_16x16x32_bf16 v[32:35], a[56:59], v[152:155], v[32:35]
buffer_load_dwordx4 v[124:127], v5, s[32:35], s54 offen offset:2304 sc1
v_mfma_f32_16x16x32_bf16 v[36:39], a[56:59], v[156:159], v[36:39]
v_mfma_f32_16x16x32_bf16 v[24:27], a[52:55], v[152:155], v[24:27]
v_mfma_f32_16x16x32_bf16 v[28:31], a[52:55], v[156:159], v[28:31]
v_mfma_f32_16x16x32_bf16 v[40:43], a[60:63], v[152:155], v[40:43]
v_mfma_f32_16x16x32_bf16 v[44:47], a[60:63], v[156:159], v[44:47]
v_mfma_f32_16x16x32_bf16 v[16:19], a[64:67], v[160:163], v[16:19]
s_add_u32 s54, s54, 4096
buffer_load_dwordx4 v[192:195], v5, s[32:35], s54 offen offset:0 sc1
v_mfma_f32_16x16x32_bf16 v[20:23], a[64:67], v[164:167], v[20:23]
v_mfma_f32_16x16x32_bf16 v[32:35], a[72:75], v[160:163], v[32:35]
buffer_load_dwordx4 v[196:199], v5, s[32:35], s54 offen offset:256 sc1
v_mfma_f32_16x16x32_bf16 v[36:39], a[72:75], v[164:167], v[36:39]
v_mfma_f32_16x16x32_bf16 v[24:27], a[68:71], v[160:163], v[24:27]
v_mfma_f32_16x16x32_bf16 v[28:31], a[68:71], v[164:167], v[28:31]
v_mfma_f32_16x16x32_bf16 v[40:43], a[76:79], v[160:163], v[40:43]
v_mfma_f32_16x16x32_bf16 v[44:47], a[76:79], v[164:167], v[44:47]
v_mfma_f32_16x16x32_bf16 v[16:19], a[80:83], v[168:171], v[16:19]
buffer_load_dwordx4 v[200:203], v5, s[32:35], s54 offen offset:2048 sc1
v_mfma_f32_16x16x32_bf16 v[20:23], a[80:83], v[172:175], v[20:23]
v_mfma_f32_16x16x32_bf16 v[32:35], a[88:91], v[168:171], v[32:35]
buffer_load_dwordx4 v[204:207], v5, s[32:35], s54 offen offset:2304 sc1
v_mfma_f32_16x16x32_bf16 v[36:39], a[88:91], v[172:175], v[36:39]
v_mfma_f32_16x16x32_bf16 v[24:27], a[84:87], v[168:171], v[24:27]
v_mfma_f32_16x16x32_bf16 v[28:31], a[84:87], v[172:175], v[28:31]
v_mfma_f32_16x16x32_bf16 v[40:43], a[92:95], v[168:171], v[40:43]
v_mfma_f32_16x16x32_bf16 v[44:47], a[92:95], v[172:175], v[44:47]
s_waitcnt vmcnt(11)
v_mfma_f32_16x16x32_bf16 v[16:19], a[96:99], v[176:179], v[16:19]
s_add_u32 s54, s54, 4096
buffer_load_dwordx4 v[208:211], v5, s[32:35], s54 offen offset:0 sc1
v_mfma_f32_16x16x32_bf16 v[20:23], a[96:99], v[180:183], v[20:23]
v_mfma_f32_16x16x32_bf16 v[32:35], a[104:107], v[176:179], v[32:35]
buffer_load_dwordx4 v[212:215], v5, s[32:35], s54 offen offset:256 sc1
v_mfma_f32_16x16x32_bf16 v[36:39], a[104:107], v[180:183], v[36:39]
v_mfma_f32_16x16x32_bf16 v[24:27], a[100:103], v[176:179], v[24:27]
v_accvgpr_read_b32 v14, a245
buffer_load_dword v15, v14, s[32:35], 0 offen sc1
v_mfma_f32_16x16x32_bf16 v[28:31], a[100:103], v[180:183], v[28:31]
v_mfma_f32_16x16x32_bf16 v[40:43], a[108:111], v[176:179], v[40:43]
buffer_load_dwordx4 v[216:219], v5, s[32:35], s54 offen offset:2048 sc1
v_mfma_f32_16x16x32_bf16 v[44:47], a[108:111], v[180:183], v[44:47]
s_waitcnt vmcnt(12)
v_mfma_f32_16x16x32_bf16 v[16:19], a[112:115], v[184:187], v[16:19]
buffer_load_dwordx4 v[220:223], v5, s[32:35], s54 offen offset:2304 sc1
v_mfma_f32_16x16x32_bf16 v[20:23], a[112:115], v[188:191], v[20:23]
v_mfma_f32_16x16x32_bf16 v[32:35], a[120:123], v[184:187], v[32:35]
v_mfma_f32_16x16x32_bf16 v[36:39], a[120:123], v[188:191], v[36:39]
v_mfma_f32_16x16x32_bf16 v[24:27], a[116:119], v[184:187], v[24:27]
v_mfma_f32_16x16x32_bf16 v[28:31], a[116:119], v[188:191], v[28:31]
v_mfma_f32_16x16x32_bf16 v[40:43], a[124:127], v[184:187], v[40:43]
v_mfma_f32_16x16x32_bf16 v[44:47], a[124:127], v[188:191], v[44:47]
s_waitcnt vmcnt(11)
v_mfma_f32_16x16x32_bf16 v[16:19], a[128:131], v[112:115], v[16:19]
v_mfma_f32_16x16x32_bf16 v[20:23], a[128:131], v[116:119], v[20:23]
v_mfma_f32_16x16x32_bf16 v[32:35], a[136:139], v[112:115], v[32:35]
v_mfma_f32_16x16x32_bf16 v[36:39], a[136:139], v[116:119], v[36:39]
v_mfma_f32_16x16x32_bf16 v[24:27], a[132:135], v[112:115], v[24:27]
v_mfma_f32_16x16x32_bf16 v[28:31], a[132:135], v[116:119], v[28:31]
v_mfma_f32_16x16x32_bf16 v[40:43], a[140:143], v[112:115], v[40:43]
v_mfma_f32_16x16x32_bf16 v[44:47], a[140:143], v[116:119], v[44:47]
s_waitcnt vmcnt(9)
v_mfma_f32_16x16x32_bf16 v[16:19], a[144:147], v[120:123], v[16:19]
v_mfma_f32_16x16x32_bf16 v[20:23], a[144:147], v[124:127], v[20:23]
v_mfma_f32_16x16x32_bf16 v[32:35], a[152:155], v[120:123], v[32:35]
v_mfma_f32_16x16x32_bf16 v[36:39], a[152:155], v[124:127], v[36:39]
v_mfma_f32_16x16x32_bf16 v[24:27], a[148:151], v[120:123], v[24:27]
s_add_u32 s96, s53, 7
s_waitcnt vmcnt(2)
v_cmp_ne_u32 vcc, s96, v15
v_mfma_f32_16x16x32_bf16 v[28:31], a[148:151], v[124:127], v[28:31]
v_mfma_f32_16x16x32_bf16 v[40:43], a[156:159], v[120:123], v[40:43]
s_cbranch_vccnz HZ_96
HZb_97:
s_add_u32 s54, s82, 458752
buffer_load_dwordx4 v[224:227], v5, s[32:35], s54 offen offset:0 sc1
v_mfma_f32_16x16x32_bf16 v[44:47], a[156:159], v[124:127], v[44:47]
v_mfma_f32_16x16x32_bf16 v[16:19], a[160:163], v[192:195], v[16:19]
buffer_load_dwordx4 v[228:231], v5, s[32:35], s54 offen offset:256 sc1
v_mfma_f32_16x16x32_bf16 v[20:23], a[160:163], v[196:199], v[20:23]
v_mfma_f32_16x16x32_bf16 v[32:35], a[168:171], v[192:195], v[32:35]
buffer_load_dwordx4 v[232:235], v5, s[32:35], s54 offen offset:2048 sc1
v_mfma_f32_16x16x32_bf16 v[36:39], a[168:171], v[196:199], v[36:39]
v_mfma_f32_16x16x32_bf16 v[24:27], a[164:167], v[192:195], v[24:27]
buffer_load_dwordx4 v[236:239], v5, s[32:35], s54 offen offset:2304 sc1
v_mfma_f32_16x16x32_bf16 v[28:31], a[164:167], v[196:199], v[28:31]
v_mfma_f32_16x16x32_bf16 v[40:43], a[172:175], v[192:195], v[40:43]
s_add_u32 s54, s54, 4096
buffer_load_dwordx4 v[240:243], v5, s[32:35], s54 offen offset:0 sc1
v_mfma_f32_16x16x32_bf16 v[44:47], a[172:175], v[196:199], v[44:47]
v_mfma_f32_16x16x32_bf16 v[16:19], a[176:179], v[200:203], v[16:19]
buffer_load_dwordx4 v[244:247], v5, s[32:35], s54 offen offset:256 sc1
v_mfma_f32_16x16x32_bf16 v[20:23], a[176:179], v[204:207], v[20:23]
v_mfma_f32_16x16x32_bf16 v[32:35], a[184:187], v[200:203], v[32:35]
buffer_load_dwordx4 v[248:251], v5, s[32:35], s54 offen offset:2048 sc1
v_mfma_f32_16x16x32_bf16 v[36:39], a[184:187], v[204:207], v[36:39]
v_mfma_f32_16x16x32_bf16 v[24:27], a[180:183], v[200:203], v[24:27]
buffer_load_dwordx4 v[252:255], v5, s[32:35], s54 offen offset:2304 sc1
v_mfma_f32_16x16x32_bf16 v[28:31], a[180:183], v[204:207], v[28:31]
v_mfma_f32_16x16x32_bf16 v[40:43], a[188:191], v[200:203], v[40:43]
v_mfma_f32_16x16x32_bf16 v[44:47], a[188:191], v[204:207], v[44:47]
v_mfma_f32_16x16x32_bf16 v[16:19], a[192:195], v[208:211], v[16:19]
s_add_u32 s54, s54, 4096
buffer_load_dwordx4 v[128:131], v5, s[32:35], s54 offen offset:0 sc1
v_mfma_f32_16x16x32_bf16 v[20:23], a[192:195], v[212:215], v[20:23]
v_mfma_f32_16x16x32_bf16 v[24:27], a[196:199], v[208:211], v[24:27]
buffer_load_dwordx4 v[132:135], v5, s[32:35], s54 offen offset:256 sc1
v_mfma_f32_16x16x32_bf16 v[28:31], a[196:199], v[212:215], v[28:31]
s_waitcnt vmcnt(10)
v_mfma_f32_16x16x32_bf16 v[16:19], a[208:211], v[216:219], v[16:19]
v_mfma_f32_16x16x32_bf16 v[20:23], a[208:211], v[220:223], v[20:23]
v_mfma_f32_16x16x32_bf16 v[24:27], a[212:215], v[216:219], v[24:27]
v_mfma_f32_16x16x32_bf16 v[28:31], a[212:215], v[220:223], v[28:31]
v_mfma_f32_16x16x32_bf16 v[32:35], a[200:203], v[208:211], v[32:35]
buffer_load_dwordx4 v[136:139], v5, s[32:35], s54 offen offset:2048 sc1
v_mfma_f32_16x16x32_bf16 v[36:39], a[200:203], v[212:215], v[36:39]
v_mfma_f32_16x16x32_bf16 v[40:43], a[204:207], v[208:211], v[40:43]
buffer_load_dwordx4 v[140:143], v5, s[32:35], s54 offen offset:2304 sc1
v_mfma_f32_16x16x32_bf16 v[44:47], a[204:207], v[212:215], v[44:47]
ds_write_b128 v4, v[16:19] offset:0
v_mfma_f32_16x16x32_bf16 v[32:35], a[216:219], v[216:219], v[32:35]
v_mfma_f32_16x16x32_bf16 v[36:39], a[216:219], v[220:223], v[36:39]
v_mfma_f32_16x16x32_bf16 v[40:43], a[220:223], v[216:219], v[40:43]
v_mfma_f32_16x16x32_bf16 v[44:47], a[220:223], v[220:223], v[44:47]
ds_write_b128 v4, v[20:23] offset:256
s_waitcnt vmcnt(10)
v_mfma_f32_16x16x32_bf16 v[48:51], a[0:3], v[224:227], 0
s_add_u32 s54, s54, 4096
buffer_load_dwordx4 v[144:147], v5, s[32:35], s54 offen offset:0 sc1
v_mfma_f32_16x16x32_bf16 v[52:55], a[0:3], v[228:231], 0
v_accvgpr_read_b32 v192, a224
v_accvgpr_read_b32 v193, a225
v_accvgpr_read_b32 v194, a226
v_accvgpr_read_b32 v195, a227
v_mfma_f32_16x16x32_bf16 v[64:67], a[8:11], v[224:227], 0
buffer_load_dwordx4 v[148:151], v5, s[32:35], s54 offen offset:256 sc1
v_mfma_f32_16x16x32_bf16 v[68:71], a[8:11], v[228:231], 0
ds_write_b128 v4, v[24:27] offset:2048
v_accvgpr_read_b32 v196, a228
v_mfma_f32_16x16x32_bf16 v[56:59], a[4:7], v[224:227], 0
v_accvgpr_read_b32 v197, a229
v_accvgpr_read_b32 v198, a230
v_mfma_f32_16x16x32_bf16 v[60:63], a[4:7], v[228:231], 0
v_accvgpr_read_b32 v199, a231
v_mfma_f32_16x16x32_bf16 v[72:75], a[12:15], v[224:227], 0
v_mfma_f32_16x16x32_bf16 v[76:79], a[12:15], v[228:231], 0
ds_write_b128 v4, v[28:31] offset:2304
s_waitcnt vmcnt(10)
v_mfma_f32_16x16x32_bf16 v[48:51], a[16:19], v[232:235], v[48:51]
buffer_load_dwordx4 v[152:155], v5, s[32:35], s54 offen offset:2048 sc1
v_mfma_f32_16x16x32_bf16 v[52:55], a[16:19], v[236:239], v[52:55]
v_mfma_f32_16x16x32_bf16 v[64:67], a[24:27], v[232:235], v[64:67]
buffer_load_dwordx4 v[156:159], v5, s[32:35], s54 offen offset:2304 sc1
v_mfma_f32_16x16x32_bf16 v[68:71], a[24:27], v[236:239], v[68:71]
ds_write_b128 v4, v[32:35] offset:4096
v_mfma_f32_16x16x32_bf16 v[56:59], a[20:23], v[232:235], v[56:59]
v_mfma_f32_16x16x32_bf16 v[60:63], a[20:23], v[236:239], v[60:63]
v_mfma_f32_16x16x32_bf16 v[72:75], a[28:31], v[232:235], v[72:75]
v_mfma_f32_16x16x32_bf16 v[76:79], a[28:31], v[236:239], v[76:79]
ds_write_b128 v4, v[36:39] offset:4352
s_waitcnt vmcnt(10)
v_mfma_f32_16x16x32_bf16 v[48:51], a[32:35], v[240:243], v[48:51]
s_add_u32 s54, s54, 4096
buffer_load_dwordx4 v[160:163], v5, s[32:35], s54 offen offset:0 sc1
v_mfma_f32_16x16x32_bf16 v[52:55], a[32:35], v[244:247], v[52:55]
v_mfma_f32_16x16x32_bf16 v[64:67], a[40:43], v[240:243], v[64:67]
buffer_load_dwordx4 v[164:167], v5, s[32:35], s54 offen offset:256 sc1
v_mfma_f32_16x16x32_bf16 v[68:71], a[40:43], v[244:247], v[68:71]
ds_write_b128 v4, v[40:43] offset:6144
v_mfma_f32_16x16x32_bf16 v[56:59], a[36:39], v[240:243], v[56:59]
v_mfma_f32_16x16x32_bf16 v[60:63], a[36:39], v[244:247], v[60:63]
v_mfma_f32_16x16x32_bf16 v[72:75], a[44:47], v[240:243], v[72:75]
v_mfma_f32_16x16x32_bf16 v[76:79], a[44:47], v[244:247], v[76:79]
ds_write_b128 v4, v[44:47] offset:6400
s_waitcnt vmcnt(10)
v_mfma_f32_16x16x32_bf16 v[48:51], a[48:51], v[248:251], v[48:51]
buffer_load_dwordx4 v[168:171], v5, s[32:35], s54 offen offset:2048 sc1
v_mfma_f32_16x16x32_bf16 v[52:55], a[48:51], v[252:255], v[52:55]
v_mfma_f32_16x16x32_bf16 v[64:67], a[56:59], v[248:251], v[64:67]
buffer_load_dwordx4 v[172:175], v5, s[32:35], s54 offen offset:2304 sc1
v_mfma_f32_16x16x32_bf16 v[68:71], a[56:59], v[252:255], v[68:71]
s_waitcnt lgkmcnt(0)
s_barrier
v_mfma_f32_16x16x32_bf16 v[56:59], a[52:55], v[248:251], v[56:59]
v_mfma_f32_16x16x32_bf16 v[60:63], a[52:55], v[252:255], v[60:63]
ds_read_b128 v[80:83], v6 offset:0
v_mfma_f32_16x16x32_bf16 v[72:75], a[60:63], v[248:251], v[72:75]
v_mfma_f32_16x16x32_bf16 v[76:79], a[60:63], v[252:255], v[76:79]
ds_read_b128 v[84:87], v6 offset:8192
s_waitcnt vmcnt(10)
v_mfma_f32_16x16x32_bf16 v[48:51], a[64:67], v[128:131], v[48:51]
s_add_u32 s54, s54, 4096
buffer_load_dwordx4 v[176:179], v5, s[32:35], s54 offen offset:0 sc1
v_mfma_f32_16x16x32_bf16 v[52:55], a[64:67], v[132:135], v[52:55]
ds_read_b128 v[88:91], v6 offset:16384
v_mfma_f32_16x16x32_bf16 v[64:67], a[72:75], v[128:131], v[64:67]
buffer_load_dwordx4 v[180:183], v5, s[32:35], s54 offen offset:256 sc1
v_mfma_f32_16x16x32_bf16 v[68:71], a[72:75], v[132:135], v[68:71]
ds_read_b128 v[92:95], v6 offset:24576
v_mfma_f32_16x16x32_bf16 v[56:59], a[68:71], v[128:131], v[56:59]
buffer_load_dwordx4 v[184:187], v5, s[32:35], s54 offen offset:2048 sc1
v_mfma_f32_16x16x32_bf16 v[60:63], a[68:71], v[132:135], v[60:63]
ds_read_b128 v[96:99], v6 offset:4096
v_mfma_f32_16x16x32_bf16 v[72:75], a[76:79], v[128:131], v[72:75]
buffer_load_dwordx4 v[188:191], v5, s[32:35], s54 offen offset:2304 sc1
v_mfma_f32_16x16x32_bf16 v[76:79], a[76:79], v[132:135], v[76:79]
ds_read_b128 v[100:103], v6 offset:12288
s_waitcnt vmcnt(12)
v_mfma_f32_16x16x32_bf16 v[48:51], a[80:83], v[136:139], v[48:51]
s_add_u32 s54, s54, 4096
buffer_load_dwordx4 v[112:115], v5, s[32:35], s54 offen offset:0 sc1
v_mfma_f32_16x16x32_bf16 v[52:55], a[80:83], v[140:143], v[52:55]
ds_read_b128 v[104:107], v6 offset:20480
v_mfma_f32_16x16x32_bf16 v[64:67], a[88:91], v[136:139], v[64:67]
buffer_load_dwordx4 v[116:119], v5, s[32:35], s54 offen offset:256 sc1
v_mfma_f32_16x16x32_bf16 v[68:71], a[88:91], v[140:143], v[68:71]
ds_read_b128 v[108:111], v6 offset:28672
v_mfma_f32_16x16x32_bf16 v[56:59], a[84:87], v[136:139], v[56:59]
buffer_load_dwordx4 v[120:123], v5, s[32:35], s54 offen offset:2048 sc1
v_mfma_f32_16x16x32_bf16 v[60:63], a[84:87], v[140:143], v[60:63]
v_mfma_f32_16x16x32_bf16 v[72:75], a[92:95], v[136:139], v[72:75]
buffer_load_dwordx4 v[124:127], v5, s[32:35], s54 offen offset:2304 sc1
v_mfma_f32_16x16x32_bf16 v[76:79], a[92:95], v[140:143], v[76:79]
s_waitcnt vmcnt(14) lgkmcnt(0)
v_add_f32 v80, v80, v84
v_add_f32 v81, v81, v85
v_mfma_f32_16x16x32_bf16 v[48:51], a[96:99], v[144:147], v[48:51]
v_add_f32 v82, v82, v86
v_add_f32 v83, v83, v87
v_mfma_f32_16x16x32_bf16 v[52:55], a[96:99], v[148:151], v[52:55]
v_add_f32 v88, v88, v92
v_add_f32 v89, v89, v93
v_add_f32 v90, v90, v94
v_add_f32 v91, v91, v95
v_mfma_f32_16x16x32_bf16 v[64:67], a[104:107], v[144:147], v[64:67]
v_add_f32 v80, v80, v88
v_add_f32 v81, v81, v89
v_mfma_f32_16x16x32_bf16 v[68:71], a[104:107], v[148:151], v[68:71]
v_add_f32 v82, v82, v90
v_add_f32 v83, v83, v91
v_fma_f32 v192, v80, s60, v192
v_fma_f32 v193, v81, s60, v193
v_mfma_f32_16x16x32_bf16 v[56:59], a[100:103], v[144:147], v[56:59]
v_fma_f32 v194, v82, s60, v194
v_fma_f32 v195, v83, s60, v195
v_mfma_f32_16x16x32_bf16 v[60:63], a[100:103], v[148:151], v[60:63]
v_add_f32 v96, v96, v100
v_add_f32 v97, v97, v101
v_add_f32 v98, v98, v102
v_add_f32 v99, v99, v103
v_mfma_f32_16x16x32_bf16 v[72:75], a[108:111], v[144:147], v[72:75]
v_add_f32 v104, v104, v108
v_add_f32 v105, v105, v109
v_mfma_f32_16x16x32_bf16 v[76:79], a[108:111], v[148:151], v[76:79]
s_waitcnt vmcnt(12)
v_add_f32 v106, v106, v110
v_add_f32 v107, v107, v111
v_add_f32 v96, v96, v104
v_mfma_f32_16x16x32_bf16 v[48:51], a[112:115], v[152:155], v[48:51]
v_add_f32 v97, v97, v105
v_add_f32 v98, v98, v106
v_mfma_f32_16x16x32_bf16 v[52:55], a[112:115], v[156:159], v[52:55]
v_add_f32 v99, v99, v107
v_fma_f32 v196, v96, s60, v196
v_fma_f32 v197, v97, s60, v197
v_fma_f32 v198, v98, s60, v198
v_mfma_f32_16x16x32_bf16 v[64:67], a[120:123], v[152:155], v[64:67]
v_fma_f32 v199, v99, s60, v199
v_cvt_pk_bf16_f32 v200, v192, v193
v_mfma_f32_16x16x32_bf16 v[68:71], a[120:123], v[156:159], v[68:71]
v_cvt_pk_bf16_f32 v201, v194, v195
buffer_store_dwordx2 v[200:201], v9, s[40:43], s57 offen offset:0
v_cvt_pk_bf16_f32 v202, v196, v197
v_mfma_f32_16x16x32_bf16 v[56:59], a[116:119], v[152:155], v[56:59]
v_cvt_pk_bf16_f32 v203, v198, v199
v_mfma_f32_16x16x32_bf16 v[60:63], a[116:119], v[156:159], v[60:63]
buffer_store_dwordx2 v[202:203], v9, s[40:43], s57 offen offset:64
v_accvgpr_read_b32 v224, a232
v_accvgpr_read_b32 v225, a233
v_mfma_f32_16x16x32_bf16 v[72:75], a[124:127], v[152:155], v[72:75]
v_accvgpr_read_b32 v226, a234
v_accvgpr_read_b32 v227, a235
v_mfma_f32_16x16x32_bf16 v[76:79], a[124:127], v[156:159], v[76:79]
s_waitcnt vmcnt(12)
v_accvgpr_read_b32 v228, a236
v_accvgpr_read_b32 v229, a237
v_accvgpr_read_b32 v230, a238
v_mfma_f32_16x16x32_bf16 v[48:51], a[128:131], v[160:163], v[48:51]
v_accvgpr_read_b32 v231, a239
v_mfma_f32_16x16x32_bf16 v[52:55], a[128:131], v[164:167], v[52:55]
v_mfma_f32_16x16x32_bf16 v[64:67], a[136:139], v[160:163], v[64:67]
v_mfma_f32_16x16x32_bf16 v[68:71], a[136:139], v[164:167], v[68:71]
v_mfma_f32_16x16x32_bf16 v[56:59], a[132:135], v[160:163], v[56:59]
v_mfma_f32_16x16x32_bf16 v[60:63], a[132:135], v[164:167], v[60:63]
v_mfma_f32_16x16x32_bf16 v[72:75], a[140:143], v[160:163], v[72:75]
v_mfma_f32_16x16x32_bf16 v[76:79], a[140:143], v[164:167], v[76:79]
s_waitcnt vmcnt(10)
v_mfma_f32_16x16x32_bf16 v[48:51], a[144:147], v[168:171], v[48:51]
v_mfma_f32_16x16x32_bf16 v[52:55], a[144:147], v[172:175], v[52:55]
v_mfma_f32_16x16x32_bf16 v[64:67], a[152:155], v[168:171], v[64:67]
v_mfma_f32_16x16x32_bf16 v[68:71], a[152:155], v[172:175], v[68:71]
v_mfma_f32_16x16x32_bf16 v[56:59], a[148:151], v[168:171], v[56:59]
v_mfma_f32_16x16x32_bf16 v[60:63], a[148:151], v[172:175], v[60:63]
v_mfma_f32_16x16x32_bf16 v[72:75], a[156:159], v[168:171], v[72:75]
v_mfma_f32_16x16x32_bf16 v[76:79], a[156:159], v[172:175], v[76:79]
s_waitcnt vmcnt(8)
v_mfma_f32_16x16x32_bf16 v[48:51], a[160:163], v[176:179], v[48:51]
v_mfma_f32_16x16x32_bf16 v[52:55], a[160:163], v[180:183], v[52:55]
v_mfma_f32_16x16x32_bf16 v[56:59], a[164:167], v[176:179], v[56:59]
v_mfma_f32_16x16x32_bf16 v[60:63], a[164:167], v[180:183], v[60:63]
s_waitcnt vmcnt(6)
v_mfma_f32_16x16x32_bf16 v[48:51], a[176:179], v[184:187], v[48:51]
v_mfma_f32_16x16x32_bf16 v[52:55], a[176:179], v[188:191], v[52:55]
v_mfma_f32_16x16x32_bf16 v[56:59], a[180:183], v[184:187], v[56:59]
v_mfma_f32_16x16x32_bf16 v[60:63], a[180:183], v[188:191], v[60:63]
s_waitcnt vmcnt(4)
v_mfma_f32_16x16x32_bf16 v[48:51], a[192:195], v[112:115], v[48:51]
v_mfma_f32_16x16x32_bf16 v[52:55], a[192:195], v[116:119], v[52:55]
v_mfma_f32_16x16x32_bf16 v[56:59], a[196:199], v[112:115], v[56:59]
v_mfma_f32_16x16x32_bf16 v[60:63], a[196:199], v[116:119], v[60:63]
s_waitcnt vmcnt(2)
v_mfma_f32_16x16x32_bf16 v[48:51], a[208:211], v[120:123], v[48:51]
v_mfma_f32_16x16x32_bf16 v[52:55], a[208:211], v[124:127], v[52:55]
v_mfma_f32_16x16x32_bf16 v[56:59], a[212:215], v[120:123], v[56:59]
v_mfma_f32_16x16x32_bf16 v[60:63], a[212:215], v[124:127], v[60:63]
v_mfma_f32_16x16x32_bf16 v[64:67], a[168:171], v[176:179], v[64:67]
v_mfma_f32_16x16x32_bf16 v[68:71], a[168:171], v[180:183], v[68:71]
s_barrier
v_mfma_f32_16x16x32_bf16 v[72:75], a[172:175], v[176:179], v[72:75]
v_mfma_f32_16x16x32_bf16 v[76:79], a[172:175], v[180:183], v[76:79]
ds_write_b128 v4, v[48:51] offset:0
v_mfma_f32_16x16x32_bf16 v[64:67], a[184:187], v[184:187], v[64:67]
v_mfma_f32_16x16x32_bf16 v[68:71], a[184:187], v[188:191], v[68:71]
ds_write_b128 v4, v[52:55] offset:256
v_mfma_f32_16x16x32_bf16 v[72:75], a[188:191], v[184:187], v[72:75]
v_mfma_f32_16x16x32_bf16 v[76:79], a[188:191], v[188:191], v[76:79]
ds_write_b128 v4, v[56:59] offset:2048
v_mfma_f32_16x16x32_bf16 v[64:67], a[200:203], v[112:115], v[64:67]
v_mfma_f32_16x16x32_bf16 v[68:71], a[200:203], v[116:119], v[68:71]
ds_write_b128 v4, v[60:63] offset:2304
v_mfma_f32_16x16x32_bf16 v[72:75], a[204:207], v[112:115], v[72:75]
v_mfma_f32_16x16x32_bf16 v[76:79], a[204:207], v[116:119], v[76:79]
s_waitcnt lgkmcnt(0)
s_barrier
v_mfma_f32_16x16x32_bf16 v[64:67], a[216:219], v[120:123], v[64:67]
v_mfma_f32_16x16x32_bf16 v[68:71], a[216:219], v[124:127], v[68:71]
ds_read_b128 v[80:83], v6 offset:0
v_mfma_f32_16x16x32_bf16 v[72:75], a[220:223], v[120:123], v[72:75]
v_mfma_f32_16x16x32_bf16 v[76:79], a[220:223], v[124:127], v[76:79]
ds_read_b128 v[84:87], v6 offset:8192
ds_read_b128 v[88:91], v6 offset:16384
ds_read_b128 v[92:95], v6 offset:24576
s_nop 0
ds_write_b128 v4, v[64:67] offset:4096
ds_write_b128 v4, v[68:71] offset:4352
s_nop 0
ds_write_b128 v4, v[72:75] offset:6144
ds_write_b128 v4, v[76:79] offset:6400
s_waitcnt lgkmcnt(4)
v_pk_add_f32 v[80:81], v[80:81], v[84:85]
v_pk_add_f32 v[82:83], v[82:83], v[86:87]
v_pk_add_f32 v[88:89], v[88:89], v[92:93]
v_pk_add_f32 v[90:91], v[90:91], v[94:95]
v_pk_add_f32 v[80:81], v[80:81], v[88:89]
v_pk_add_f32 v[82:83], v[82:83], v[90:91]
v_pk_fma_f32 v[224:225], v[80:81], s[60:61], v[224:225]
v_pk_fma_f32 v[226:227], v[82:83], s[60:61], v[226:227]
v_cvt_pk_bf16_f32 v232, v224, v225
v_cvt_pk_bf16_f32 v233, v226, v227
buffer_store_dwordx2 v[232:233], v9, s[40:43], s58 offen offset:0
s_waitcnt lgkmcnt(0)
s_barrier
ds_read_b128 v[96:99], v6 offset:4096
ds_read_b128 v[100:103], v6 offset:12288
ds_read_b128 v[104:107], v6 offset:20480
ds_read_b128 v[108:111], v6 offset:28672
s_waitcnt lgkmcnt(0)
v_pk_add_f32 v[96:97], v[96:97], v[100:101]
v_pk_add_f32 v[98:99], v[98:99], v[102:103]
v_pk_add_f32 v[104:105], v[104:105], v[108:109]
v_pk_add_f32 v[106:107], v[106:107], v[110:111]
v_pk_add_f32 v[96:97], v[96:97], v[104:105]
v_pk_add_f32 v[98:99], v[98:99], v[106:107]
v_pk_fma_f32 v[228:229], v[96:97], s[60:61], v[228:229]
v_pk_fma_f32 v[230:231], v[98:99], s[60:61], v[230:231]
v_cvt_pk_bf16_f32 v234, v228, v229
v_cvt_pk_bf16_f32 v235, v230, v231
buffer_store_dwordx2 v[234:235], v9, s[40:43], s58 offen offset:64
L_fin:
L_end:
s_endpgm
OS_35:
buffer_wbl2 sc1
s_waitcnt vmcnt(0)
buffer_store_dword v2, off, s[32:35], s99 offset:0 sc1
s_branch OSb_36
OS_37:
buffer_wbl2 sc1
s_waitcnt vmcnt(0)
buffer_store_dword v2, off, s[32:35], s99 offset:0 sc1
s_branch OSb_38
HZ_39:
s_mov_b32 s97, 0
v_accvgpr_read_b32 v14, a244
HZq_41:
buffer_load_dword v15, v14, s[32:35], 0 offen sc1
s_waitcnt vmcnt(0)
v_cmp_ne_u32 vcc, s96, v15
s_nop 4
s_cbranch_vccz HZb_40
s_add_u32 s97, s97, 1
s_cmp_lt_u32 s97, 65536
s_cbranch_scc1 HZq_41
s_branch HZb_40
OS_42:
buffer_store_dword v2, off, s[32:35], s99 offset:512 sc1
s_branch OSb_43
HZ_44:
s_mov_b32 s97, 0
v_accvgpr_read_b32 v14, a245
HZq_46:
buffer_load_dword v15, v14, s[32:35], 0 offen sc1
s_waitcnt vmcnt(0)
v_cmp_ne_u32 vcc, s96, v15
s_nop 4
s_cbranch_vccz HZb_45
s_add_u32 s97, s97, 1
s_cmp_lt_u32 s97, 65536
s_cbranch_scc1 HZq_46
s_branch HZb_45
OS_49:
buffer_store_dwordx4 v[216:219], v10, s[32:35], s63 offen offset:0 sc1
s_branch OSb_50
OS_53:
buffer_store_dwordx4 v[248:251], v10, s[32:35], s63 offen offset:2048 sc1
s_branch OSb_54
SPo_57:
s_mov_b32 s62, 0
SPl_55:
buffer_load_dwordx4 v[16:19], v7, s[32:35], s93 offen offset:0 sc1
buffer_load_dwordx4 v[20:23], v7, s[32:35], s93 offen offset:512 sc1
s_waitcnt vmcnt(0)
v_cmp_eq_u32 vcc, s94, v19
v_cmp_eq_u32 s[64:65], s94, v23
s_nop 0
s_and_b64 vcc, vcc, s[64:65]
s_cmp_eq_u64 vcc, exec
s_cbranch_scc1 SPd_56
s_add_u32 s62, s62, 1
s_cmp_lt_u32 s62, 65536
s_cbranch_scc1 SPl_55
s_branch SPd_56
OS_61:
buffer_wbl2 sc1
s_waitcnt vmcnt(0)
buffer_store_dword v2, off, s[32:35], s96 offset:0 sc1
s_branch OSb_62
HZ_63:
s_mov_b32 s97, 0
v_accvgpr_read_b32 v14, a246
HZq_65:
buffer_load_dword v15, v14, s[32:35], 0 offen sc1
s_waitcnt vmcnt(0)
v_cmp_ne_u32 vcc, s96, v15
s_nop 4
s_cbranch_vccz HZb_64
s_add_u32 s97, s97, 1
s_cmp_lt_u32 s97, 65536
s_cbranch_scc1 HZq_65
s_branch HZb_64
OS_68:
buffer_wbl2 sc1
s_waitcnt vmcnt(0)
buffer_store_dword v2, off, s[32:35], s96 offset:512 sc1
s_branch OSb_69
HZ_70:
s_mov_b32 s97, 0
v_accvgpr_read_b32 v14, a247
HZq_72:
buffer_load_dword v15, v14, s[32:35], 0 offen sc1
s_waitcnt vmcnt(0)
v_cmp_ne_u32 vcc, s96, v15
s_nop 4
s_cbranch_vccz HZb_71
s_add_u32 s97, s97, 1
s_cmp_lt_u32 s97, 65536
s_cbranch_scc1 HZq_72
s_branch HZb_71
WBo_75:
s_cmp_lg_u32 s52, 0
s_cbranch_scc1 WB_73
buffer_wbl2 sc1
s_branch WBj_74
OS_76:
buffer_store_dword v2, off, s[32:35], s99 offset:0 sc1
s_branch OSb_77
HZ_78:
s_mov_b32 s97, 0
v_accvgpr_read_b32 v14, a244
HZq_80:
buffer_load_dword v15, v14, s[32:35], 0 offen sc1
s_waitcnt vmcnt(0)
v_cmp_ne_u32 vcc, s96, v15
s_nop 4
s_cbranch_vccz HZb_79
s_add_u32 s97, s97, 1
s_cmp_lt_u32 s97, 65536
s_cbranch_scc1 HZq_80
s_branch HZb_79
OS_81:
buffer_wbl2 sc1
s_waitcnt vmcnt(0)
buffer_store_dword v2, off, s[32:35], s96 offset:512 sc1
s_branch OSb_82
HZ_83:
s_mov_b32 s97, 0
v_accvgpr_read_b32 v14, a247
HZq_85:
buffer_load_dword v15, v14, s[32:35], 0 offen sc1
s_waitcnt vmcnt(0)
v_cmp_ne_u32 vcc, s96, v15
s_nop 4
s_cbranch_vccz HZb_84
s_add_u32 s97, s97, 1
s_cmp_lt_u32 s97, 65536
s_cbranch_scc1 HZq_85
s_branch HZb_84
OS_86:
buffer_store_dword v2, off, s[32:35], s99 offset:0 sc1
s_branch OSb_87
WBo_90:
s_cmp_lg_u32 s52, 0
s_cbranch_scc1 WB_88
buffer_wbl2 sc1
s_branch WBj_89
HZ_91:
s_mov_b32 s97, 0
v_accvgpr_read_b32 v14, a244
HZq_93:
buffer_load_dword v15, v14, s[32:35], 0 offen sc1
s_waitcnt vmcnt(0)
v_cmp_ne_u32 vcc, s96, v15
s_nop 4
s_cbranch_vccz HZb_92
s_add_u32 s97, s97, 1
s_cmp_lt_u32 s97, 65536
s_cbranch_scc1 HZq_93
s_branch HZb_92
OS_94:
buffer_store_dword v2, off, s[32:35], s99 offset:512 sc1
s_branch OSb_95
HZ_96:
s_mov_b32 s97, 0
v_accvgpr_read_b32 v14, a245
HZq_98:
buffer_load_dword v15, v14, s[32:35], 0 offen sc1
s_waitcnt vmcnt(0)
v_cmp_ne_u32 vcc, s96, v15
s_nop 4
s_cbranch_vccz HZb_97
s_add_u32 s97, s97, 1
s_cmp_lt_u32 s97, 65536
s_cbranch_scc1 HZq_98
s_branch HZb_97
s_endpgm
L_kend:

.section .rodata,"a"
.p2align 6
.amdhsa_kernel interleave_layers__ssm_conv_h3__glu_gated_glu__prompt_kernel
  .amdhsa_next_free_vgpr 512
  .amdhsa_next_free_sgpr 102
  .amdhsa_accum_offset 256
  .amdhsa_group_segment_fixed_size 0
  .amdhsa_kernarg_size 104
  .amdhsa_user_sgpr_count 2
  .amdhsa_user_sgpr_kernarg_segment_ptr 1
  .amdhsa_system_sgpr_workgroup_id_x 1
.end_amdhsa_kernel
```
